```python
import torch

def _softmax(x, axis=-1):
    return torch.softmax(x, dim=axis)
def _gelu(x):
    return torch.nn.functional.gelu(x, approximate="tanh")
def _silu(x):
    return torch.nn.functional.silu(x)
def _sigmoid(x):
    return torch.sigmoid(x)
def _layernorm(x, axis=-1, eps=1e-5):
    m = x.mean(dim=axis, keepdim=True)
    v = x.var(dim=axis, keepdim=True, unbiased=False)
    return (x - m) / torch.sqrt(v + eps)
def _scatter_add(tgt, idx, src, axis=0):
    return tgt.clone().index_add_(axis, idx, src)
def _segment_sum(src, seg, n):
    out = torch.zeros((n,) + src.shape[1:], dtype=src.dtype)
    return out.index_add_(0, seg, src)
def _pad(x, pw):
    flat = tuple(v for pair in reversed(pw) for v in pair)
    return torch.nn.functional.pad(x, flat)

kernel_name = 'standalone__gqa_block_cached__near_ridge'

def setup_inputs():

    _w = (lambda a: (lambda t: t.to(torch.bfloat16) if t.is_floating_point() else t)(torch.as_tensor(a)))
    B, Sq, D = 16, 240, 512
    Hq, Hkv, Sk, Dh = 32, 32, 512, 128
    assert Hq % Hkv == 0, (Hq, Hkv)
    return {
        "x": _w((lambda *s: torch.randn(*s, dtype=torch.bfloat16) * 0.8)(B, Sq, D)),
        "k_cache": _w((lambda *s: torch.randn(*s, dtype=torch.bfloat16) * 0.8)(B, Hkv, Sk, Dh)),
        "v_cache": _w((lambda *s: torch.randn(*s, dtype=torch.bfloat16) * 0.05)(B, Hkv, Sk, Dh)),
        "wq": _w((lambda *s: torch.randn(*s, dtype=torch.bfloat16) * 0.8)(D, Hq * Dh) * (D ** -0.5)),
        "wo": _w((lambda *s: torch.randn(*s, dtype=torch.bfloat16) * 0.05)(Hq * Dh, D) * ((Hq * Dh) ** -0.5)),
    }

def reference(x, k_cache, v_cache, wq, wo):
    B, Sq, D = x.shape
    Hq, Dh = 32, 128
    Hkv = k_cache.shape[1]
    rep = Hq // Hkv
    q = (lambda x, *d: x.permute(*d))((x @ wq).reshape(B, Sq, Hq, Dh), 0, 2, 1, 3)
    k = (lambda x, n, axis: torch.repeat_interleave(x, n, dim=axis))(k_cache, rep, axis=1)
    v = (lambda x, n, axis: torch.repeat_interleave(x, n, dim=axis))(v_cache, rep, axis=1)
    scores = torch.einsum("bhqd,bhkd->bhqk", q, k) * (Dh ** -0.5)
    p = _softmax(scores, axis=-1)
    o = torch.einsum("bhqk,bhkd->bhqd", p, v)
    return (lambda x, *d: x.permute(*d))(o, 0, 2, 1, 3).reshape(B, Sq, Hq * Dh) @ wo
```

```asm
; @launch grid=(256,1,1) block=(256,1,1) lds=163840
.amdgcn_target "amdgcn-amd-amdhsa--gfx950"
.text
.globl standalone__gqa_block_cached__near_ridge_kernel
.p2align 8
.type standalone__gqa_block_cached__near_ridge_kernel,@function
standalone__gqa_block_cached__near_ridge_kernel:
gqa_attn_kernel:
s_load_dwordx4 s[96:99], s[0:1], 40
s_cmp_ge_u32 s2, 256
s_cbranch_scc1 L_k1_done
s_load_dwordx8 s[64:71], s[0:1], 0
s_load_dwordx2 s[100:101], s[0:1], 32
s_load_dwordx2 s[56:57], s[0:1], 56
v_and_b32 v226, 63, v0
v_lshrrev_b32 v227, 6, v0
s_nop 0
v_readfirstlane_b32 s28, v227
v_lshrrev_b32 v227, 4, v226
v_and_b32 v228, 15, v226
v_lshrrev_b32 v229, 2, v228
v_and_b32 v230, 3, v228
v_lshlrev_b32 v214, 4, v226
s_getpc_b64 s[60:61]
L_pc:
s_sub_u32 s60, s60, L_pc-gqa_attn_kernel
s_subb_u32 s61, s61, 0
s_and_b32 s61, s61, 0xffff
s_mov_b32 s62, L_text_end-gqa_attn_kernel
s_mov_b32 s63, 0x20000
v_lshlrev_b32 v232, 7, v226
s_lshl_b32 s36, s28, 13
s_and_b32 s36, s2, 7
s_lshl_b32 s36, s36, 1
s_lshr_b32 s37, s2, 3
s_and_b32 s37, s37, 1
s_add_u32 s54, s36, s37
s_lshr_b32 s55, s2, 4
s_lshl_b32 s29, s28, 12
v_lshlrev_b32 v232, 2, v227
v_xor_b32 v232, v232, v228
v_lshlrev_b32 v232, 4, v232
v_lshl_add_u32 v223, v227, 13, v232
v_lshrrev_b32 v233, 3, v226
v_and_b32 v234, 7, v226
v_add_u32 v232, 0, v227
v_xor_b32 v232, v232, v234
v_lshlrev_b32 v232, 4, v232
v_lshl_add_u32 v224, v233, 10, v232
v_add_u32 v232, 4, v227
v_xor_b32 v232, v232, v234
v_lshlrev_b32 v232, 4, v232
v_lshl_add_u32 v225, v233, 10, v232
s_waitcnt lgkmcnt(0)
s_mul_i32 s36, s54, 245760
s_add_u32 s4, s64, s36
s_addc_u32 s5, s65, 0
s_and_b32 s5, s5, 0xffff
s_mov_b32 s6, 245760
s_mov_b32 s7, 0x20000
s_lshl_b32 s36, s55, 9
s_add_u32 s8, s70, s36
s_addc_u32 s9, s71, 0
s_and_b32 s9, s9, 0xffff
s_sub_u32 s10, 4194304, s36
s_mov_b32 s11, 0x20000
s_and_b32 s36, s28, 1
s_lshl_b32 s36, s36, 17
s_lshr_b32 s37, s28, 1
s_lshl_b32 s37, s37, 8
s_add_u32 s31, s36, s37
s_lshl_b32 s32, s28, 16
s_mov_b32 s30, 0
s_add_u32 m0, s30, s29
s_add_u32 s36, s31, 0
buffer_load_dwordx4 v223, s[8:11], s36 offen offset:0 lds
s_add_u32 s36, s31, 31744
buffer_load_dwordx4 v223, s[8:11], s36 offen offset:1024 lds
s_add_u32 s36, s31, 63488
buffer_load_dwordx4 v223, s[8:11], s36 offen offset:2048 lds
s_add_u32 s36, s31, 95232
buffer_load_dwordx4 v223, s[8:11], s36 offen offset:3072 lds
s_add_u32 s31, s31, 262144
s_add_u32 s30, s30, 16384
s_cmp_eq_u32 s30, 163840
s_cselect_b32 s30, 0, s30
s_add_u32 m0, s30, s29
s_add_u32 s36, s32, 0
buffer_load_dwordx4 v224, s[4:7], s36 offen offset:0 lds
s_add_u32 s36, s32, 7168
buffer_load_dwordx4 v225, s[4:7], s36 offen offset:1024 lds
s_add_u32 s36, s32, 14336
buffer_load_dwordx4 v224, s[4:7], s36 offen offset:2048 lds
s_add_u32 s36, s32, 21504
buffer_load_dwordx4 v225, s[4:7], s36 offen offset:3072 lds
s_add_u32 s30, s30, 16384
s_cmp_eq_u32 s30, 163840
s_cselect_b32 s30, 0, s30
s_add_u32 m0, s30, s29
s_add_u32 s36, s32, 32768
buffer_load_dwordx4 v224, s[4:7], s36 offen offset:0 lds
s_add_u32 s36, s32, 39936
buffer_load_dwordx4 v225, s[4:7], s36 offen offset:1024 lds
s_add_u32 s36, s32, 47104
buffer_load_dwordx4 v224, s[4:7], s36 offen offset:2048 lds
s_add_u32 s36, s32, 54272
buffer_load_dwordx4 v225, s[4:7], s36 offen offset:3072 lds
s_add_u32 s32, s32, 128
s_add_u32 s30, s30, 16384
s_cmp_eq_u32 s30, 163840
s_cselect_b32 s30, 0, s30
s_add_u32 m0, s30, s29
s_add_u32 s36, s31, 0
buffer_load_dwordx4 v223, s[8:11], s36 offen offset:0 lds
s_add_u32 s36, s31, 31744
buffer_load_dwordx4 v223, s[8:11], s36 offen offset:1024 lds
s_add_u32 s36, s31, 63488
buffer_load_dwordx4 v223, s[8:11], s36 offen offset:2048 lds
s_add_u32 s36, s31, 95232
buffer_load_dwordx4 v223, s[8:11], s36 offen offset:3072 lds
s_add_u32 s31, s31, 262144
s_add_u32 s30, s30, 16384
s_cmp_eq_u32 s30, 163840
s_cselect_b32 s30, 0, s30
v_add_u32 v232, 0, v227
v_xor_b32 v232, v232, v228
v_lshlrev_b32 v232, 4, v232
v_lshl_add_u32 v192, v228, 8, v232
v_add_u32 v232, 4, v227
v_xor_b32 v232, v232, v228
v_lshlrev_b32 v232, 4, v232
v_lshl_add_u32 v193, v228, 8, v232
v_add_u32 v232, 8, v227
v_xor_b32 v232, v232, v228
v_lshlrev_b32 v232, 4, v232
v_lshl_add_u32 v194, v228, 8, v232
v_add_u32 v232, 12, v227
v_xor_b32 v232, v232, v228
v_lshlrev_b32 v232, 4, v232
v_lshl_add_u32 v195, v228, 8, v232
v_lshl_add_u32 v233, v227, 2, v229
v_and_b32 v234, 7, v233
v_xor_b32 v232, 0, v234
v_lshlrev_b32 v232, 5, v232
v_lshl_add_u32 v232, v233, 8, v232
v_lshl_add_u32 v196, v230, 3, v232
v_xor_b32 v232, 1, v234
v_lshlrev_b32 v232, 5, v232
v_lshl_add_u32 v232, v233, 8, v232
v_lshl_add_u32 v197, v230, 3, v232
v_xor_b32 v232, 2, v234
v_lshlrev_b32 v232, 5, v232
v_lshl_add_u32 v232, v233, 8, v232
v_lshl_add_u32 v198, v230, 3, v232
v_xor_b32 v232, 3, v234
v_lshlrev_b32 v232, 5, v232
v_lshl_add_u32 v232, v233, 8, v232
v_lshl_add_u32 v199, v230, 3, v232
v_xor_b32 v232, 4, v234
v_lshlrev_b32 v232, 5, v232
v_lshl_add_u32 v232, v233, 8, v232
v_lshl_add_u32 v200, v230, 3, v232
v_xor_b32 v232, 5, v234
v_lshlrev_b32 v232, 5, v232
v_lshl_add_u32 v232, v233, 8, v232
v_lshl_add_u32 v201, v230, 3, v232
v_xor_b32 v232, 6, v234
v_lshlrev_b32 v232, 5, v232
v_lshl_add_u32 v232, v233, 8, v232
v_lshl_add_u32 v202, v230, 3, v232
v_xor_b32 v232, 7, v234
v_lshlrev_b32 v232, 5, v232
v_lshl_add_u32 v232, v233, 8, v232
v_lshl_add_u32 v203, v230, 3, v232
v_lshl_add_u32 v233, v227, 3, v229
v_xor_b32 v232, 0, v229
v_lshlrev_b32 v232, 6, v232
v_lshl_add_u32 v232, v233, 8, v232
v_lshl_add_u32 v215, v230, 4, v232
v_xor_b32 v232, 1, v229
v_lshlrev_b32 v232, 6, v232
v_lshl_add_u32 v232, v233, 8, v232
v_lshl_add_u32 v216, v230, 4, v232
v_xor_b32 v232, 2, v229
v_lshlrev_b32 v232, 6, v232
v_lshl_add_u32 v232, v233, 8, v232
v_lshl_add_u32 v217, v230, 4, v232
v_xor_b32 v232, 3, v229
v_lshlrev_b32 v232, 6, v232
v_lshl_add_u32 v232, v233, 8, v232
v_lshl_add_u32 v218, v230, 4, v232
v_lshrrev_b32 v233, 1, v228
v_add_u32 v232, 0, v227
v_xor_b32 v232, v232, v233
v_lshlrev_b32 v232, 4, v232
v_lshl_add_u32 v232, v228, 7, v232
v_add_u32 v219, s29, v232
v_add_u32 v232, 4, v227
v_xor_b32 v232, v232, v233
v_lshlrev_b32 v232, 4, v232
v_lshl_add_u32 v232, v228, 7, v232
v_add_u32 v220, s29, v232
v_add_u32 v232, 0, v227
v_xor_b32 v232, v232, v233
v_lshlrev_b32 v232, 4, v232
v_lshl_add_u32 v232, v228, 7, v232
v_add_u32 v221, s29, v232
v_add_u32 v232, 4, v227
v_xor_b32 v232, v232, v233
v_lshlrev_b32 v232, 4, v232
v_lshl_add_u32 v232, v228, 7, v232
v_add_u32 v222, s29, v232
v_add_u32 v232, 0, v227
v_xor_b32 v232, v232, v228
v_lshlrev_b32 v232, 4, v232
v_lshl_add_u32 v204, v227, 8, v232
v_add_u32 v232, 4, v227
v_xor_b32 v232, v232, v228
v_lshlrev_b32 v232, 4, v232
v_lshl_add_u32 v205, v227, 8, v232
v_add_u32 v232, 8, v227
v_xor_b32 v232, v232, v228
v_lshlrev_b32 v232, 4, v232
v_lshl_add_u32 v206, v227, 8, v232
v_add_u32 v232, 12, v227
v_xor_b32 v232, v232, v228
v_lshlrev_b32 v232, 4, v232
v_lshl_add_u32 v207, v227, 8, v232
v_add_u32 v232, 0, v227
v_lshlrev_b32 v232, 1, v232
v_xor_b32 v232, v232, v228
v_lshlrev_b32 v232, 4, v232
v_lshl_add_u32 v208, v227, 8, v232
v_add_u32 v232, 4, v227
v_lshlrev_b32 v232, 1, v232
v_xor_b32 v232, v232, v228
v_lshlrev_b32 v232, 4, v232
v_lshl_add_u32 v209, v227, 8, v232
s_lshl_b32 s36, s54, 22
s_lshl_b32 s37, s55, 18
s_add_u32 s36, s36, s37
s_add_u32 s12, s66, s36
s_addc_u32 s13, s67, 0
s_and_b32 s13, s13, 0xffff
s_mov_b32 s14, 262144
s_mov_b32 s15, 0x20000
s_add_u32 s16, s68, s36
s_addc_u32 s17, s69, 0
s_and_b32 s17, s17, 0xffff
s_mov_b32 s18, 262144
s_mov_b32 s19, 0x20000
s_mov_b32 s20, s56
s_and_b32 s21, s57, 0xffff
s_mov_b32 s22, 35684352
s_mov_b32 s23, 0x20000
s_mov_b32 s24, s100
s_and_b32 s25, s101, 0xffff
s_mov_b32 s26, 4194304
s_mov_b32 s27, 0x20000
s_mov_b32 s33, s29
s_mov_b32 s34, s29
s_mov_b32 s35, 0
s_mov_b32 s48, 0
s_mov_b32 s49, 0
s_mov_b32 s50, 0
s_mov_b32 s51, 0
s_mov_b32 s52, 0
s_mov_b32 s42, 0x3e0293ee
s_mov_b32 s58, 0x3e0293ee
s_mov_b32 s59, 0x3e0293ee
s_mul_i32 s36, s54, 15
s_lshl_b32 s37, s28, 2
s_add_u32 s36, s36, s37
s_mul_i32 s36, s36, 131072
s_lshl_b32 s37, s55, 13
s_add_u32 s44, s36, s37
s_add_u32 s45, s44, 131072
s_add_u32 s46, s44, 262144
s_add_u32 s47, s44, 393216
s_cmp_eq_u32 s28, 3
s_cselect_b32 s47, 0x7f000000, s47
v_lshrrev_b32 v232, 5, v226
v_and_b32 v233, 31, v226
v_lshlrev_b32 v233, 4, v233
v_lshl_add_u32 v250, v232, 10, v233
s_lshr_b32 s36, s2, 1
s_lshl_b32 s36, s36, 15
s_and_b32 s37, s2, 1
s_lshl_b32 s37, s37, 9
s_add_u32 s36, s36, s37
s_lshl_b32 s37, s28, 13
s_add_u32 s43, s36, s37
v_lshl_add_u32 v233, v227, 2, v229
v_lshlrev_b32 v233, 9, v233
v_lshl_add_u32 v233, v230, 4, v233
s_lshl_b32 s36, s28, 7
v_add_u32 v251, s36, v233
s_and_b32 s36, s2, 1
s_lshl_b32 s36, s36, 4
s_lshl_b32 s37, s28, 2
s_add_u32 s36, s36, s37
s_mul_i32 s36, s36, 131072
s_lshr_b32 s37, s2, 1
s_lshl_b32 s37, s37, 10
s_add_u32 s36, s36, s37
s_add_u32 s56, s36, 31457280
v_lshlrev_b32 v232, 3, v214
s_lshl_b32 s36, s28, 13
buffer_load_dword v238, v232, s[60:63], s36 offen
s_add_u32 s36, s36, 32768
buffer_load_dword v239, v232, s[60:63], s36 offen
s_add_u32 s36, s36, 32768
buffer_load_dword v240, v232, s[60:63], s36 offen
s_add_u32 s36, s36, 32768
s_lshl_b32 s36, s2, 7
s_add_u32 s36, s36, 35651584
v_mov_b32 v227, 0
v_mov_b32 v228, 0
v_mov_b32 v229, 0
buffer_store_dwordx2 v[228:229], v227, s[20:23], s36 offen sc1
s_cmp_eq_u32 s28, 3
s_mov_b32 s36, 0xff7fffff
s_cselect_b32 s53, 0x7149f2ca, s36
s_waitcnt vmcnt(8)
s_barrier
s_sub_u32 s37, s35, s50
s_mov_b32 s50, s35
s_add_u32 s35, s35, 16384
s_cmp_eq_u32 s35, 163840
s_cselect_b32 s35, 0, s35
v_add_u32 v215, s37, v215
v_add_u32 v216, s37, v216
v_add_u32 v217, s37, v217
v_add_u32 v218, s37, v218
s_sub_u32 s37, s35, s51
s_mov_b32 s51, s35
s_add_u32 s35, s35, 16384
s_cmp_eq_u32 s35, 163840
s_cselect_b32 s35, 0, s35
v_add_u32 v219, s37, v219
v_add_u32 v220, s37, v220
s_sub_u32 s37, s35, s52
s_mov_b32 s52, s35
s_add_u32 s35, s35, 16384
s_cmp_eq_u32 s35, 163840
s_cselect_b32 s35, 0, s35
v_add_u32 v221, s37, v221
v_add_u32 v222, s37, v222
ds_read_b128 v[160:163], v219 offset:0
ds_read_b128 v[164:167], v219 offset:2048
ds_read_b128 v[168:171], v221 offset:0
ds_read_b128 v[172:175], v221 offset:2048
ds_read_b64_tr_b16 v[128:129], v215 offset:0
ds_read_b64_tr_b16 v[130:131], v215 offset:1024
ds_read_b64_tr_b16 v[132:133], v215 offset:8
ds_read_b64_tr_b16 v[134:135], v215 offset:1032
ds_read_b64_tr_b16 v[136:137], v216 offset:0
ds_read_b64_tr_b16 v[138:139], v216 offset:1024
ds_read_b64_tr_b16 v[140:141], v216 offset:8
ds_read_b64_tr_b16 v[142:143], v216 offset:1032
ds_read_b64_tr_b16 v[144:145], v217 offset:0
ds_read_b64_tr_b16 v[146:147], v217 offset:1024
ds_read_b64_tr_b16 v[148:149], v217 offset:8
ds_read_b64_tr_b16 v[150:151], v217 offset:1032
ds_read_b64_tr_b16 v[152:153], v218 offset:0
ds_read_b64_tr_b16 v[154:155], v218 offset:1024
s_waitcnt lgkmcnt(12)
v_mfma_f32_16x16x32_bf16 v[0:3], v[128:131], v[160:163], 0
ds_read_b64_tr_b16 v[156:157], v218 offset:8
v_mfma_f32_16x16x32_bf16 v[4:7], v[128:131], v[164:167], 0
s_waitcnt vmcnt(4)
s_barrier
ds_read_b64_tr_b16 v[158:159], v218 offset:1032
v_mfma_f32_16x16x32_bf16 v[8:11], v[128:131], v[168:171], 0
s_sub_u32 s37, s35, s50
s_mov_b32 s50, s35
v_mfma_f32_16x16x32_bf16 v[12:15], v[128:131], v[172:175], 0
s_add_u32 s35, s35, 16384
s_add_u32 m0, s30, s29
s_waitcnt lgkmcnt(12)
v_mfma_f32_16x16x32_bf16 v[16:19], v[132:135], v[160:163], 0
ds_read_b64_tr_b16 v[128:129], v215 offset:8192
s_add_u32 s36, s31, 0
v_mfma_f32_16x16x32_bf16 v[20:23], v[132:135], v[164:167], 0
ds_read_b64_tr_b16 v[130:131], v215 offset:9216
v_mfma_f32_16x16x32_bf16 v[24:27], v[132:135], v[168:171], 0
s_cmp_eq_u32 s35, 163840
s_cselect_b32 s35, 0, s35
v_mfma_f32_16x16x32_bf16 v[28:31], v[132:135], v[172:175], 0
buffer_load_dwordx4 v223, s[8:11], s36 offen offset:0 lds
s_waitcnt lgkmcnt(12)
v_mfma_f32_16x16x32_bf16 v[32:35], v[136:139], v[160:163], 0
ds_read_b64_tr_b16 v[132:133], v215 offset:8200
s_add_u32 s36, s31, 31744
v_mfma_f32_16x16x32_bf16 v[36:39], v[136:139], v[164:167], 0
ds_read_b64_tr_b16 v[134:135], v215 offset:9224
v_mfma_f32_16x16x32_bf16 v[40:43], v[136:139], v[168:171], 0
buffer_load_dwordx4 v223, s[8:11], s36 offen offset:1024 lds
s_add_u32 s36, s31, 63488
v_mfma_f32_16x16x32_bf16 v[44:47], v[136:139], v[172:175], 0
buffer_load_dwordx4 v223, s[8:11], s36 offen offset:2048 lds
s_waitcnt lgkmcnt(12)
v_mfma_f32_16x16x32_bf16 v[48:51], v[140:143], v[160:163], 0
ds_read_b64_tr_b16 v[136:137], v216 offset:8192
s_add_u32 s36, s31, 95232
v_mfma_f32_16x16x32_bf16 v[52:55], v[140:143], v[164:167], 0
ds_read_b64_tr_b16 v[138:139], v216 offset:9216
v_mfma_f32_16x16x32_bf16 v[56:59], v[140:143], v[168:171], 0
buffer_load_dwordx4 v223, s[8:11], s36 offen offset:3072 lds
s_add_u32 s31, s31, 262144
v_mfma_f32_16x16x32_bf16 v[60:63], v[140:143], v[172:175], 0
s_add_u32 s30, s30, 16384
s_waitcnt lgkmcnt(12)
v_mfma_f32_16x16x32_bf16 v[64:67], v[144:147], v[160:163], 0
ds_read_b64_tr_b16 v[140:141], v216 offset:8200
v_mfma_f32_16x16x32_bf16 v[68:71], v[144:147], v[164:167], 0
ds_read_b64_tr_b16 v[142:143], v216 offset:9224
v_mfma_f32_16x16x32_bf16 v[72:75], v[144:147], v[168:171], 0
s_cmp_eq_u32 s30, 163840
s_cselect_b32 s30, 0, s30
s_add_u32 m0, s30, s29
v_mfma_f32_16x16x32_bf16 v[76:79], v[144:147], v[172:175], 0
s_add_u32 s36, s32, 0
s_waitcnt lgkmcnt(12)
v_mfma_f32_16x16x32_bf16 v[80:83], v[148:151], v[160:163], 0
ds_read_b64_tr_b16 v[144:145], v217 offset:8192
v_mfma_f32_16x16x32_bf16 v[84:87], v[148:151], v[164:167], 0
ds_read_b64_tr_b16 v[146:147], v217 offset:9216
v_mfma_f32_16x16x32_bf16 v[88:91], v[148:151], v[168:171], 0
buffer_load_dwordx4 v224, s[4:7], s36 offen offset:0 lds
s_add_u32 s36, s32, 7168
v_mfma_f32_16x16x32_bf16 v[92:95], v[148:151], v[172:175], 0
buffer_load_dwordx4 v225, s[4:7], s36 offen offset:1024 lds
s_waitcnt lgkmcnt(12)
v_mfma_f32_16x16x32_bf16 v[96:99], v[152:155], v[160:163], 0
ds_read_b64_tr_b16 v[148:149], v217 offset:8200
s_add_u32 s36, s32, 14336
v_mfma_f32_16x16x32_bf16 v[100:103], v[152:155], v[164:167], 0
ds_read_b64_tr_b16 v[150:151], v217 offset:9224
v_mfma_f32_16x16x32_bf16 v[104:107], v[152:155], v[168:171], 0
buffer_load_dwordx4 v224, s[4:7], s36 offen offset:2048 lds
s_add_u32 s36, s32, 21504
v_mfma_f32_16x16x32_bf16 v[108:111], v[152:155], v[172:175], 0
s_waitcnt lgkmcnt(12)
v_mfma_f32_16x16x32_bf16 v[112:115], v[156:159], v[160:163], 0
ds_read_b64_tr_b16 v[152:153], v218 offset:8192
v_mfma_f32_16x16x32_bf16 v[116:119], v[156:159], v[164:167], 0
ds_read_b64_tr_b16 v[154:155], v218 offset:9216
v_mfma_f32_16x16x32_bf16 v[120:123], v[156:159], v[168:171], 0
buffer_load_dwordx4 v225, s[4:7], s36 offen offset:3072 lds
s_add_u32 s30, s30, 16384
v_mfma_f32_16x16x32_bf16 v[124:127], v[156:159], v[172:175], 0
s_cmp_eq_u32 s30, 163840
s_cselect_b32 s30, 0, s30
s_waitcnt lgkmcnt(12)
v_mfma_f32_16x16x32_bf16 a[128:131], v[128:131], v[160:163], 0
ds_read_b64_tr_b16 v[156:157], v218 offset:8200
s_add_u32 m0, s30, s29
v_mfma_f32_16x16x32_bf16 a[132:135], v[128:131], v[164:167], 0
ds_read_b64_tr_b16 v[158:159], v218 offset:9224
s_add_u32 s36, s32, 32768
v_mfma_f32_16x16x32_bf16 a[136:139], v[128:131], v[168:171], 0
v_add_u32 v215, s37, v215
v_add_u32 v216, s37, v216
v_mfma_f32_16x16x32_bf16 a[140:143], v[128:131], v[172:175], 0
v_add_u32 v217, s37, v217
v_add_u32 v218, s37, v218
s_waitcnt lgkmcnt(12)
v_mfma_f32_16x16x32_bf16 a[144:147], v[132:135], v[160:163], 0
ds_read_b64_tr_b16 v[128:129], v215 offset:0
v_mfma_f32_16x16x32_bf16 a[148:151], v[132:135], v[164:167], 0
ds_read_b64_tr_b16 v[130:131], v215 offset:1024
v_mfma_f32_16x16x32_bf16 a[152:155], v[132:135], v[168:171], 0
buffer_load_dwordx4 v224, s[4:7], s36 offen offset:0 lds
s_add_u32 s36, s32, 39936
v_mfma_f32_16x16x32_bf16 a[156:159], v[132:135], v[172:175], 0
buffer_load_dwordx4 v225, s[4:7], s36 offen offset:1024 lds
s_waitcnt lgkmcnt(12)
v_mfma_f32_16x16x32_bf16 a[160:163], v[136:139], v[160:163], 0
ds_read_b64_tr_b16 v[132:133], v215 offset:8
s_add_u32 s36, s32, 47104
v_mfma_f32_16x16x32_bf16 a[164:167], v[136:139], v[164:167], 0
ds_read_b64_tr_b16 v[134:135], v215 offset:1032
v_mfma_f32_16x16x32_bf16 a[168:171], v[136:139], v[168:171], 0
ds_read_b128 v[176:179], v220 offset:0
v_mfma_f32_16x16x32_bf16 a[172:175], v[136:139], v[172:175], 0
buffer_load_dwordx4 v224, s[4:7], s36 offen offset:2048 lds
s_waitcnt lgkmcnt(13)
v_mfma_f32_16x16x32_bf16 a[176:179], v[140:143], v[160:163], 0
ds_read_b64_tr_b16 v[136:137], v216 offset:0
s_add_u32 s36, s32, 54272
v_mfma_f32_16x16x32_bf16 a[180:183], v[140:143], v[164:167], 0
ds_read_b64_tr_b16 v[138:139], v216 offset:1024
v_mfma_f32_16x16x32_bf16 a[184:187], v[140:143], v[168:171], 0
ds_read_b128 v[180:183], v220 offset:2048
v_mfma_f32_16x16x32_bf16 a[188:191], v[140:143], v[172:175], 0
buffer_load_dwordx4 v225, s[4:7], s36 offen offset:3072 lds
s_waitcnt lgkmcnt(14)
v_mfma_f32_16x16x32_bf16 a[192:195], v[144:147], v[160:163], 0
ds_read_b64_tr_b16 v[140:141], v216 offset:8
s_add_u32 s32, s32, 128
v_mfma_f32_16x16x32_bf16 a[196:199], v[144:147], v[164:167], 0
ds_read_b64_tr_b16 v[142:143], v216 offset:1032
s_add_u32 s30, s30, 16384
v_mfma_f32_16x16x32_bf16 a[200:203], v[144:147], v[168:171], 0
ds_read_b128 v[184:187], v222 offset:0
v_mfma_f32_16x16x32_bf16 a[204:207], v[144:147], v[172:175], 0
s_cmp_eq_u32 s30, 163840
s_cselect_b32 s30, 0, s30
s_waitcnt lgkmcnt(15)
v_mfma_f32_16x16x32_bf16 a[208:211], v[148:151], v[160:163], 0
ds_read_b64_tr_b16 v[144:145], v217 offset:0
s_add_u32 m0, s30, s29
v_mfma_f32_16x16x32_bf16 a[212:215], v[148:151], v[164:167], 0
ds_read_b64_tr_b16 v[146:147], v217 offset:1024
s_add_u32 s36, s31, 0
v_mfma_f32_16x16x32_bf16 a[216:219], v[148:151], v[168:171], 0
ds_read_b128 v[188:191], v222 offset:2048
v_mfma_f32_16x16x32_bf16 a[220:223], v[148:151], v[172:175], 0
buffer_load_dwordx4 v223, s[8:11], s36 offen offset:0 lds
s_waitcnt lgkmcnt(15)
v_mfma_f32_16x16x32_bf16 a[224:227], v[152:155], v[160:163], 0
ds_read_b64_tr_b16 v[148:149], v217 offset:8
s_add_u32 s36, s31, 31744
v_mfma_f32_16x16x32_bf16 a[228:231], v[152:155], v[164:167], 0
ds_read_b64_tr_b16 v[150:151], v217 offset:1032
v_mfma_f32_16x16x32_bf16 a[232:235], v[152:155], v[168:171], 0
buffer_load_dwordx4 v223, s[8:11], s36 offen offset:1024 lds
s_add_u32 s36, s31, 63488
v_mfma_f32_16x16x32_bf16 a[236:239], v[152:155], v[172:175], 0
buffer_load_dwordx4 v223, s[8:11], s36 offen offset:2048 lds
s_waitcnt lgkmcnt(15)
v_mfma_f32_16x16x32_bf16 a[240:243], v[156:159], v[160:163], 0
ds_read_b64_tr_b16 v[152:153], v218 offset:0
s_add_u32 s36, s31, 95232
v_mfma_f32_16x16x32_bf16 a[244:247], v[156:159], v[164:167], 0
ds_read_b64_tr_b16 v[154:155], v218 offset:1024
v_mfma_f32_16x16x32_bf16 a[248:251], v[156:159], v[168:171], 0
buffer_load_dwordx4 v223, s[8:11], s36 offen offset:3072 lds
s_add_u32 s31, s31, 262144
v_mfma_f32_16x16x32_bf16 a[252:255], v[156:159], v[172:175], 0
s_add_u32 s30, s30, 16384
s_waitcnt lgkmcnt(13)
v_mfma_f32_16x16x32_bf16 v[0:3], v[128:131], v[176:179], v[0:3]
ds_read_b64_tr_b16 v[156:157], v218 offset:8
s_waitcnt lgkmcnt(11)
v_mfma_f32_16x16x32_bf16 v[4:7], v[128:131], v[180:183], v[4:7]
s_waitcnt vmcnt(4)
s_barrier
ds_read_b64_tr_b16 v[158:159], v218 offset:1032
s_waitcnt lgkmcnt(9)
v_mfma_f32_16x16x32_bf16 v[8:11], v[128:131], v[184:187], v[8:11]
s_sub_u32 s37, s35, s50
s_mov_b32 s50, s35
s_waitcnt lgkmcnt(6)
v_mfma_f32_16x16x32_bf16 v[12:15], v[128:131], v[188:191], v[12:15]
s_add_u32 s35, s35, 16384
v_mfma_f32_16x16x32_bf16 v[16:19], v[132:135], v[176:179], v[16:19]
ds_read_b64_tr_b16 v[128:129], v215 offset:8192
v_mfma_f32_16x16x32_bf16 v[20:23], v[132:135], v[180:183], v[20:23]
ds_read_b64_tr_b16 v[130:131], v215 offset:9216
v_mfma_f32_16x16x32_bf16 v[24:27], v[132:135], v[184:187], v[24:27]
s_cmp_eq_u32 s35, 163840
s_cselect_b32 s35, 0, s35
s_sub_u32 s38, s35, s51
v_mfma_f32_16x16x32_bf16 v[28:31], v[132:135], v[188:191], v[28:31]
s_mov_b32 s51, s35
s_add_u32 s35, s35, 16384
v_mfma_f32_16x16x32_bf16 v[32:35], v[136:139], v[176:179], v[32:35]
ds_read_b64_tr_b16 v[132:133], v215 offset:8200
v_mfma_f32_16x16x32_bf16 v[36:39], v[136:139], v[180:183], v[36:39]
ds_read_b64_tr_b16 v[134:135], v215 offset:9224
v_mfma_f32_16x16x32_bf16 v[40:43], v[136:139], v[184:187], v[40:43]
s_cmp_eq_u32 s35, 163840
s_cselect_b32 s35, 0, s35
s_sub_u32 s39, s35, s52
v_mfma_f32_16x16x32_bf16 v[44:47], v[136:139], v[188:191], v[44:47]
s_mov_b32 s52, s35
s_add_u32 s35, s35, 16384
v_mfma_f32_16x16x32_bf16 v[48:51], v[140:143], v[176:179], v[48:51]
ds_read_b64_tr_b16 v[136:137], v216 offset:8192
v_mfma_f32_16x16x32_bf16 v[52:55], v[140:143], v[180:183], v[52:55]
ds_read_b64_tr_b16 v[138:139], v216 offset:9216
v_mfma_f32_16x16x32_bf16 v[56:59], v[140:143], v[184:187], v[56:59]
s_cmp_eq_u32 s35, 163840
s_cselect_b32 s35, 0, s35
v_mfma_f32_16x16x32_bf16 v[60:63], v[140:143], v[188:191], v[60:63]
s_cmp_eq_u32 s30, 163840
s_cselect_b32 s30, 0, s30
v_mfma_f32_16x16x32_bf16 v[64:67], v[144:147], v[176:179], v[64:67]
ds_read_b64_tr_b16 v[140:141], v216 offset:8200
s_add_u32 m0, s30, s29
v_mfma_f32_16x16x32_bf16 v[68:71], v[144:147], v[180:183], v[68:71]
ds_read_b64_tr_b16 v[142:143], v216 offset:9224
s_add_u32 s36, s31, 0
v_mfma_f32_16x16x32_bf16 v[72:75], v[144:147], v[184:187], v[72:75]
buffer_load_dwordx4 v223, s[8:11], s36 offen offset:0 lds
s_add_u32 s36, s31, 31744
v_mfma_f32_16x16x32_bf16 v[76:79], v[144:147], v[188:191], v[76:79]
buffer_load_dwordx4 v223, s[8:11], s36 offen offset:1024 lds
s_waitcnt lgkmcnt(12)
v_mfma_f32_16x16x32_bf16 v[80:83], v[148:151], v[176:179], v[80:83]
ds_read_b64_tr_b16 v[144:145], v217 offset:8192
s_add_u32 s36, s31, 63488
v_mfma_f32_16x16x32_bf16 v[84:87], v[148:151], v[180:183], v[84:87]
ds_read_b64_tr_b16 v[146:147], v217 offset:9216
v_mfma_f32_16x16x32_bf16 v[88:91], v[148:151], v[184:187], v[88:91]
buffer_load_dwordx4 v223, s[8:11], s36 offen offset:2048 lds
s_add_u32 s36, s31, 95232
v_mfma_f32_16x16x32_bf16 v[92:95], v[148:151], v[188:191], v[92:95]
s_waitcnt lgkmcnt(12)
v_mfma_f32_16x16x32_bf16 v[96:99], v[152:155], v[176:179], v[96:99]
ds_read_b64_tr_b16 v[148:149], v217 offset:8200
v_mfma_f32_16x16x32_bf16 v[100:103], v[152:155], v[180:183], v[100:103]
ds_read_b64_tr_b16 v[150:151], v217 offset:9224
v_mfma_f32_16x16x32_bf16 v[104:107], v[152:155], v[184:187], v[104:107]
buffer_load_dwordx4 v223, s[8:11], s36 offen offset:3072 lds
s_add_u32 s31, s31, 262144
v_mfma_f32_16x16x32_bf16 v[108:111], v[152:155], v[188:191], v[108:111]
s_add_u32 s30, s30, 16384
s_waitcnt lgkmcnt(12)
v_mfma_f32_16x16x32_bf16 v[112:115], v[156:159], v[176:179], v[112:115]
ds_read_b64_tr_b16 v[152:153], v218 offset:8192
v_mfma_f32_16x16x32_bf16 v[116:119], v[156:159], v[180:183], v[116:119]
ds_read_b64_tr_b16 v[154:155], v218 offset:9216
v_mfma_f32_16x16x32_bf16 v[120:123], v[156:159], v[184:187], v[120:123]
s_cmp_eq_u32 s30, 163840
s_cselect_b32 s30, 0, s30
s_add_u32 m0, s30, s29
v_mfma_f32_16x16x32_bf16 v[124:127], v[156:159], v[188:191], v[124:127]
s_add_u32 s36, s32, 0
s_waitcnt lgkmcnt(12)
v_mfma_f32_16x16x32_bf16 a[128:131], v[128:131], v[176:179], a[128:131]
ds_read_b64_tr_b16 v[156:157], v218 offset:8200
v_mfma_f32_16x16x32_bf16 a[132:135], v[128:131], v[180:183], a[132:135]
ds_read_b64_tr_b16 v[158:159], v218 offset:9224
v_mfma_f32_16x16x32_bf16 a[136:139], v[128:131], v[184:187], a[136:139]
v_add_u32 v215, s37, v215
v_add_u32 v216, s37, v216
v_mfma_f32_16x16x32_bf16 a[140:143], v[128:131], v[188:191], a[140:143]
v_add_u32 v217, s37, v217
v_add_u32 v218, s37, v218
s_waitcnt lgkmcnt(12)
v_mfma_f32_16x16x32_bf16 a[144:147], v[132:135], v[176:179], a[144:147]
ds_read_b64_tr_b16 v[128:129], v215 offset:0
v_mfma_f32_16x16x32_bf16 a[148:151], v[132:135], v[180:183], a[148:151]
ds_read_b64_tr_b16 v[130:131], v215 offset:1024
v_mfma_f32_16x16x32_bf16 a[152:155], v[132:135], v[184:187], a[152:155]
v_add_u32 v219, s38, v219
v_add_u32 v220, s38, v220
v_mfma_f32_16x16x32_bf16 a[156:159], v[132:135], v[188:191], a[156:159]
v_add_u32 v221, s39, v221
v_add_u32 v222, s39, v222
s_waitcnt lgkmcnt(12)
v_mfma_f32_16x16x32_bf16 a[160:163], v[136:139], v[176:179], a[160:163]
ds_read_b64_tr_b16 v[132:133], v215 offset:8
v_mfma_f32_16x16x32_bf16 a[164:167], v[136:139], v[180:183], a[164:167]
ds_read_b64_tr_b16 v[134:135], v215 offset:1032
v_mfma_f32_16x16x32_bf16 a[168:171], v[136:139], v[184:187], a[168:171]
ds_read_b128 v[160:163], v219 offset:0
v_mfma_f32_16x16x32_bf16 a[172:175], v[136:139], v[188:191], a[172:175]
buffer_load_dwordx4 v224, s[4:7], s36 offen offset:0 lds
s_waitcnt lgkmcnt(13)
v_mfma_f32_16x16x32_bf16 a[176:179], v[140:143], v[176:179], a[176:179]
ds_read_b64_tr_b16 v[136:137], v216 offset:0
s_add_u32 s36, s32, 7168
v_mfma_f32_16x16x32_bf16 a[180:183], v[140:143], v[180:183], a[180:183]
ds_read_b64_tr_b16 v[138:139], v216 offset:1024
v_mfma_f32_16x16x32_bf16 a[184:187], v[140:143], v[184:187], a[184:187]
ds_read_b128 v[164:167], v219 offset:2048
v_mfma_f32_16x16x32_bf16 a[188:191], v[140:143], v[188:191], a[188:191]
buffer_load_dwordx4 v225, s[4:7], s36 offen offset:1024 lds
s_waitcnt lgkmcnt(14)
v_mfma_f32_16x16x32_bf16 a[192:195], v[144:147], v[176:179], a[192:195]
ds_read_b64_tr_b16 v[140:141], v216 offset:8
s_add_u32 s36, s32, 14336
v_mfma_f32_16x16x32_bf16 a[196:199], v[144:147], v[180:183], a[196:199]
ds_read_b64_tr_b16 v[142:143], v216 offset:1032
v_mfma_f32_16x16x32_bf16 a[200:203], v[144:147], v[184:187], a[200:203]
ds_read_b128 v[168:171], v221 offset:0
v_mfma_f32_16x16x32_bf16 a[204:207], v[144:147], v[188:191], a[204:207]
buffer_load_dwordx4 v224, s[4:7], s36 offen offset:2048 lds
s_waitcnt lgkmcnt(15)
v_mfma_f32_16x16x32_bf16 a[208:211], v[148:151], v[176:179], a[208:211]
ds_read_b64_tr_b16 v[144:145], v217 offset:0
s_add_u32 s36, s32, 21504
v_mfma_f32_16x16x32_bf16 a[212:215], v[148:151], v[180:183], a[212:215]
ds_read_b64_tr_b16 v[146:147], v217 offset:1024
v_mfma_f32_16x16x32_bf16 a[216:219], v[148:151], v[184:187], a[216:219]
ds_read_b128 v[172:175], v221 offset:2048
v_mfma_f32_16x16x32_bf16 a[220:223], v[148:151], v[188:191], a[220:223]
buffer_load_dwordx4 v225, s[4:7], s36 offen offset:3072 lds
s_waitcnt lgkmcnt(15)
v_mfma_f32_16x16x32_bf16 a[224:227], v[152:155], v[176:179], a[224:227]
ds_read_b64_tr_b16 v[148:149], v217 offset:8
s_add_u32 s30, s30, 16384
v_mfma_f32_16x16x32_bf16 a[228:231], v[152:155], v[180:183], a[228:231]
ds_read_b64_tr_b16 v[150:151], v217 offset:1032
v_mfma_f32_16x16x32_bf16 a[232:235], v[152:155], v[184:187], a[232:235]
s_cmp_eq_u32 s30, 163840
s_cselect_b32 s30, 0, s30
v_mfma_f32_16x16x32_bf16 a[236:239], v[152:155], v[188:191], a[236:239]
s_waitcnt lgkmcnt(15)
v_mfma_f32_16x16x32_bf16 a[240:243], v[156:159], v[176:179], a[240:243]
ds_read_b64_tr_b16 v[152:153], v218 offset:0
v_mfma_f32_16x16x32_bf16 a[244:247], v[156:159], v[180:183], a[244:247]
ds_read_b64_tr_b16 v[154:155], v218 offset:1024
v_mfma_f32_16x16x32_bf16 a[248:251], v[156:159], v[184:187], a[248:251]
v_mfma_f32_16x16x32_bf16 a[252:255], v[156:159], v[188:191], a[252:255]
s_waitcnt lgkmcnt(13)
v_mfma_f32_16x16x32_bf16 v[0:3], v[128:131], v[160:163], v[0:3]
ds_read_b64_tr_b16 v[156:157], v218 offset:8
s_waitcnt lgkmcnt(11)
v_mfma_f32_16x16x32_bf16 v[4:7], v[128:131], v[164:167], v[4:7]
s_waitcnt vmcnt(8)
s_barrier
ds_read_b64_tr_b16 v[158:159], v218 offset:1032
s_waitcnt lgkmcnt(9)
v_mfma_f32_16x16x32_bf16 v[8:11], v[128:131], v[168:171], v[8:11]
s_sub_u32 s37, s35, s50
s_mov_b32 s50, s35
s_waitcnt lgkmcnt(6)
v_mfma_f32_16x16x32_bf16 v[12:15], v[128:131], v[172:175], v[12:15]
s_add_u32 s35, s35, 16384
s_add_u32 m0, s30, s29
v_mfma_f32_16x16x32_bf16 v[16:19], v[132:135], v[160:163], v[16:19]
ds_read_b64_tr_b16 v[128:129], v215 offset:8192
s_add_u32 s36, s32, 32768
v_mfma_f32_16x16x32_bf16 v[20:23], v[132:135], v[164:167], v[20:23]
ds_read_b64_tr_b16 v[130:131], v215 offset:9216
v_mfma_f32_16x16x32_bf16 v[24:27], v[132:135], v[168:171], v[24:27]
s_cmp_eq_u32 s35, 163840
s_cselect_b32 s35, 0, s35
v_mfma_f32_16x16x32_bf16 v[28:31], v[132:135], v[172:175], v[28:31]
buffer_load_dwordx4 v224, s[4:7], s36 offen offset:0 lds
v_mfma_f32_16x16x32_bf16 v[32:35], v[136:139], v[160:163], v[32:35]
ds_read_b64_tr_b16 v[132:133], v215 offset:8200
s_add_u32 s36, s32, 39936
v_mfma_f32_16x16x32_bf16 v[36:39], v[136:139], v[164:167], v[36:39]
ds_read_b64_tr_b16 v[134:135], v215 offset:9224
v_mfma_f32_16x16x32_bf16 v[40:43], v[136:139], v[168:171], v[40:43]
buffer_load_dwordx4 v225, s[4:7], s36 offen offset:1024 lds
s_add_u32 s36, s32, 47104
v_mfma_f32_16x16x32_bf16 v[44:47], v[136:139], v[172:175], v[44:47]
buffer_load_dwordx4 v224, s[4:7], s36 offen offset:2048 lds
v_mfma_f32_16x16x32_bf16 v[48:51], v[140:143], v[160:163], v[48:51]
ds_read_b64_tr_b16 v[136:137], v216 offset:8192
s_add_u32 s36, s32, 54272
v_mfma_f32_16x16x32_bf16 v[52:55], v[140:143], v[164:167], v[52:55]
ds_read_b64_tr_b16 v[138:139], v216 offset:9216
v_mfma_f32_16x16x32_bf16 v[56:59], v[140:143], v[168:171], v[56:59]
buffer_load_dwordx4 v225, s[4:7], s36 offen offset:3072 lds
s_add_u32 s32, s32, 128
v_mfma_f32_16x16x32_bf16 v[60:63], v[140:143], v[172:175], v[60:63]
s_add_u32 s30, s30, 16384
v_mfma_f32_16x16x32_bf16 v[64:67], v[144:147], v[160:163], v[64:67]
ds_read_b64_tr_b16 v[140:141], v216 offset:8200
v_mfma_f32_16x16x32_bf16 v[68:71], v[144:147], v[164:167], v[68:71]
ds_read_b64_tr_b16 v[142:143], v216 offset:9224
v_mfma_f32_16x16x32_bf16 v[72:75], v[144:147], v[168:171], v[72:75]
s_cmp_eq_u32 s30, 163840
s_cselect_b32 s30, 0, s30
s_add_u32 m0, s30, s29
v_mfma_f32_16x16x32_bf16 v[76:79], v[144:147], v[172:175], v[76:79]
s_add_u32 s36, s31, 0
s_waitcnt lgkmcnt(12)
v_mfma_f32_16x16x32_bf16 v[80:83], v[148:151], v[160:163], v[80:83]
ds_read_b64_tr_b16 v[144:145], v217 offset:8192
v_mfma_f32_16x16x32_bf16 v[84:87], v[148:151], v[164:167], v[84:87]
ds_read_b64_tr_b16 v[146:147], v217 offset:9216
v_mfma_f32_16x16x32_bf16 v[88:91], v[148:151], v[168:171], v[88:91]
buffer_load_dwordx4 v223, s[8:11], s36 offen offset:0 lds
s_add_u32 s36, s31, 31744
v_mfma_f32_16x16x32_bf16 v[92:95], v[148:151], v[172:175], v[92:95]
buffer_load_dwordx4 v223, s[8:11], s36 offen offset:1024 lds
s_waitcnt lgkmcnt(12)
v_mfma_f32_16x16x32_bf16 v[96:99], v[152:155], v[160:163], v[96:99]
ds_read_b64_tr_b16 v[148:149], v217 offset:8200
s_add_u32 s36, s31, 63488
v_mfma_f32_16x16x32_bf16 v[100:103], v[152:155], v[164:167], v[100:103]
ds_read_b64_tr_b16 v[150:151], v217 offset:9224
v_mfma_f32_16x16x32_bf16 v[104:107], v[152:155], v[168:171], v[104:107]
buffer_load_dwordx4 v223, s[8:11], s36 offen offset:2048 lds
s_add_u32 s36, s31, 95232
v_mfma_f32_16x16x32_bf16 v[108:111], v[152:155], v[172:175], v[108:111]
s_waitcnt lgkmcnt(12)
v_mfma_f32_16x16x32_bf16 v[112:115], v[156:159], v[160:163], v[112:115]
ds_read_b64_tr_b16 v[152:153], v218 offset:8192
v_mfma_f32_16x16x32_bf16 v[116:119], v[156:159], v[164:167], v[116:119]
ds_read_b64_tr_b16 v[154:155], v218 offset:9216
v_mfma_f32_16x16x32_bf16 v[120:123], v[156:159], v[168:171], v[120:123]
buffer_load_dwordx4 v223, s[8:11], s36 offen offset:3072 lds
s_add_u32 s31, s31, 262144
v_mfma_f32_16x16x32_bf16 v[124:127], v[156:159], v[172:175], v[124:127]
s_add_u32 s30, s30, 16384
s_waitcnt lgkmcnt(12)
v_mfma_f32_16x16x32_bf16 a[128:131], v[128:131], v[160:163], a[128:131]
ds_read_b64_tr_b16 v[156:157], v218 offset:8200
v_mfma_f32_16x16x32_bf16 a[132:135], v[128:131], v[164:167], a[132:135]
ds_read_b64_tr_b16 v[158:159], v218 offset:9224
v_mfma_f32_16x16x32_bf16 a[136:139], v[128:131], v[168:171], a[136:139]
v_add_u32 v215, s37, v215
v_add_u32 v216, s37, v216
v_mfma_f32_16x16x32_bf16 a[140:143], v[128:131], v[172:175], a[140:143]
v_add_u32 v217, s37, v217
v_add_u32 v218, s37, v218
s_waitcnt lgkmcnt(12)
v_mfma_f32_16x16x32_bf16 a[144:147], v[132:135], v[160:163], a[144:147]
ds_read_b64_tr_b16 v[128:129], v215 offset:0
v_mfma_f32_16x16x32_bf16 a[148:151], v[132:135], v[164:167], a[148:151]
ds_read_b64_tr_b16 v[130:131], v215 offset:1024
v_mfma_f32_16x16x32_bf16 a[152:155], v[132:135], v[168:171], a[152:155]
s_cmp_eq_u32 s30, 163840
s_cselect_b32 s30, 0, s30
s_add_u32 m0, s30, s29
v_mfma_f32_16x16x32_bf16 a[156:159], v[132:135], v[172:175], a[156:159]
s_add_u32 s36, s31, 0
s_waitcnt lgkmcnt(12)
v_mfma_f32_16x16x32_bf16 a[160:163], v[136:139], v[160:163], a[160:163]
ds_read_b64_tr_b16 v[132:133], v215 offset:8
v_mfma_f32_16x16x32_bf16 a[164:167], v[136:139], v[164:167], a[164:167]
ds_read_b64_tr_b16 v[134:135], v215 offset:1032
v_mfma_f32_16x16x32_bf16 a[168:171], v[136:139], v[168:171], a[168:171]
ds_read_b128 v[176:179], v220 offset:0
v_mfma_f32_16x16x32_bf16 a[172:175], v[136:139], v[172:175], a[172:175]
buffer_load_dwordx4 v223, s[8:11], s36 offen offset:0 lds
s_waitcnt lgkmcnt(13)
v_mfma_f32_16x16x32_bf16 a[176:179], v[140:143], v[160:163], a[176:179]
ds_read_b64_tr_b16 v[136:137], v216 offset:0
s_add_u32 s36, s31, 31744
v_mfma_f32_16x16x32_bf16 a[180:183], v[140:143], v[164:167], a[180:183]
ds_read_b64_tr_b16 v[138:139], v216 offset:1024
v_mfma_f32_16x16x32_bf16 a[184:187], v[140:143], v[168:171], a[184:187]
ds_read_b128 v[180:183], v220 offset:2048
v_mfma_f32_16x16x32_bf16 a[188:191], v[140:143], v[172:175], a[188:191]
buffer_load_dwordx4 v223, s[8:11], s36 offen offset:1024 lds
s_waitcnt lgkmcnt(14)
v_mfma_f32_16x16x32_bf16 a[192:195], v[144:147], v[160:163], a[192:195]
ds_read_b64_tr_b16 v[140:141], v216 offset:8
s_add_u32 s36, s31, 63488
v_mfma_f32_16x16x32_bf16 a[196:199], v[144:147], v[164:167], a[196:199]
ds_read_b64_tr_b16 v[142:143], v216 offset:1032
v_mfma_f32_16x16x32_bf16 a[200:203], v[144:147], v[168:171], a[200:203]
ds_read_b128 v[184:187], v222 offset:0
v_mfma_f32_16x16x32_bf16 a[204:207], v[144:147], v[172:175], a[204:207]
buffer_load_dwordx4 v223, s[8:11], s36 offen offset:2048 lds
s_waitcnt lgkmcnt(15)
v_mfma_f32_16x16x32_bf16 a[208:211], v[148:151], v[160:163], a[208:211]
ds_read_b64_tr_b16 v[144:145], v217 offset:0
s_add_u32 s36, s31, 95232
v_mfma_f32_16x16x32_bf16 a[212:215], v[148:151], v[164:167], a[212:215]
ds_read_b64_tr_b16 v[146:147], v217 offset:1024
v_mfma_f32_16x16x32_bf16 a[216:219], v[148:151], v[168:171], a[216:219]
ds_read_b128 v[188:191], v222 offset:2048
v_mfma_f32_16x16x32_bf16 a[220:223], v[148:151], v[172:175], a[220:223]
buffer_load_dwordx4 v223, s[8:11], s36 offen offset:3072 lds
s_waitcnt lgkmcnt(15)
v_mfma_f32_16x16x32_bf16 a[224:227], v[152:155], v[160:163], a[224:227]
ds_read_b64_tr_b16 v[148:149], v217 offset:8
s_add_u32 s31, s31, 262144
v_mfma_f32_16x16x32_bf16 a[228:231], v[152:155], v[164:167], a[228:231]
ds_read_b64_tr_b16 v[150:151], v217 offset:1032
s_add_u32 s30, s30, 16384
v_mfma_f32_16x16x32_bf16 a[232:235], v[152:155], v[168:171], a[232:235]
s_cmp_eq_u32 s30, 163840
s_cselect_b32 s30, 0, s30
s_add_u32 m0, s30, s29
v_mfma_f32_16x16x32_bf16 a[236:239], v[152:155], v[172:175], a[236:239]
s_add_u32 s36, s32, 0
s_waitcnt lgkmcnt(15)
v_mfma_f32_16x16x32_bf16 a[240:243], v[156:159], v[160:163], a[240:243]
ds_read_b64_tr_b16 v[152:153], v218 offset:0
v_mfma_f32_16x16x32_bf16 a[244:247], v[156:159], v[164:167], a[244:247]
ds_read_b64_tr_b16 v[154:155], v218 offset:1024
v_mfma_f32_16x16x32_bf16 a[248:251], v[156:159], v[168:171], a[248:251]
buffer_load_dwordx4 v224, s[4:7], s36 offen offset:0 lds
s_add_u32 s36, s32, 7168
v_mfma_f32_16x16x32_bf16 a[252:255], v[156:159], v[172:175], a[252:255]
buffer_load_dwordx4 v225, s[4:7], s36 offen offset:1024 lds
s_waitcnt lgkmcnt(13)
v_mfma_f32_16x16x32_bf16 v[0:3], v[128:131], v[176:179], v[0:3]
ds_read_b64_tr_b16 v[156:157], v218 offset:8
s_waitcnt lgkmcnt(11)
v_mfma_f32_16x16x32_bf16 v[4:7], v[128:131], v[180:183], v[4:7]
s_waitcnt vmcnt(10)
s_barrier
ds_read_b64_tr_b16 v[158:159], v218 offset:1032
s_waitcnt lgkmcnt(9)
v_mfma_f32_16x16x32_bf16 v[8:11], v[128:131], v[184:187], v[8:11]
s_sub_u32 s37, s35, s50
s_mov_b32 s50, s35
s_waitcnt lgkmcnt(6)
v_mfma_f32_16x16x32_bf16 v[12:15], v[128:131], v[188:191], v[12:15]
s_add_u32 s35, s35, 16384
s_add_u32 s36, s32, 14336
v_mfma_f32_16x16x32_bf16 v[16:19], v[132:135], v[176:179], v[16:19]
ds_read_b64_tr_b16 v[128:129], v215 offset:8192
v_mfma_f32_16x16x32_bf16 v[20:23], v[132:135], v[180:183], v[20:23]
ds_read_b64_tr_b16 v[130:131], v215 offset:9216
v_mfma_f32_16x16x32_bf16 v[24:27], v[132:135], v[184:187], v[24:27]
s_cmp_eq_u32 s35, 163840
s_cselect_b32 s35, 0, s35
s_sub_u32 s38, s35, s51
v_mfma_f32_16x16x32_bf16 v[28:31], v[132:135], v[188:191], v[28:31]
s_mov_b32 s51, s35
s_add_u32 s35, s35, 16384
v_mfma_f32_16x16x32_bf16 v[32:35], v[136:139], v[176:179], v[32:35]
ds_read_b64_tr_b16 v[132:133], v215 offset:8200
v_mfma_f32_16x16x32_bf16 v[36:39], v[136:139], v[180:183], v[36:39]
ds_read_b64_tr_b16 v[134:135], v215 offset:9224
v_mfma_f32_16x16x32_bf16 v[40:43], v[136:139], v[184:187], v[40:43]
s_cmp_eq_u32 s35, 163840
s_cselect_b32 s35, 0, s35
s_sub_u32 s39, s35, s52
v_mfma_f32_16x16x32_bf16 v[44:47], v[136:139], v[188:191], v[44:47]
s_mov_b32 s52, s35
s_add_u32 s35, s35, 16384
v_mfma_f32_16x16x32_bf16 v[48:51], v[140:143], v[176:179], v[48:51]
ds_read_b64_tr_b16 v[136:137], v216 offset:8192
v_mfma_f32_16x16x32_bf16 v[52:55], v[140:143], v[180:183], v[52:55]
ds_read_b64_tr_b16 v[138:139], v216 offset:9216
v_mfma_f32_16x16x32_bf16 v[56:59], v[140:143], v[184:187], v[56:59]
s_cmp_eq_u32 s35, 163840
s_cselect_b32 s35, 0, s35
v_mfma_f32_16x16x32_bf16 v[60:63], v[140:143], v[188:191], v[60:63]
buffer_load_dwordx4 v224, s[4:7], s36 offen offset:2048 lds
v_mfma_f32_16x16x32_bf16 v[64:67], v[144:147], v[176:179], v[64:67]
ds_read_b64_tr_b16 v[140:141], v216 offset:8200
s_add_u32 s36, s32, 21504
v_mfma_f32_16x16x32_bf16 v[68:71], v[144:147], v[180:183], v[68:71]
ds_read_b64_tr_b16 v[142:143], v216 offset:9224
v_mfma_f32_16x16x32_bf16 v[72:75], v[144:147], v[184:187], v[72:75]
buffer_load_dwordx4 v225, s[4:7], s36 offen offset:3072 lds
s_add_u32 s30, s30, 16384
v_mfma_f32_16x16x32_bf16 v[76:79], v[144:147], v[188:191], v[76:79]
s_cmp_eq_u32 s30, 163840
s_cselect_b32 s30, 0, s30
s_waitcnt lgkmcnt(12)
v_mfma_f32_16x16x32_bf16 v[80:83], v[148:151], v[176:179], v[80:83]
ds_read_b64_tr_b16 v[144:145], v217 offset:8192
s_add_u32 m0, s30, s29
v_mfma_f32_16x16x32_bf16 v[84:87], v[148:151], v[180:183], v[84:87]
ds_read_b64_tr_b16 v[146:147], v217 offset:9216
s_add_u32 s36, s32, 32768
v_mfma_f32_16x16x32_bf16 v[88:91], v[148:151], v[184:187], v[88:91]
buffer_load_dwordx4 v224, s[4:7], s36 offen offset:0 lds
s_add_u32 s36, s32, 39936
v_mfma_f32_16x16x32_bf16 v[92:95], v[148:151], v[188:191], v[92:95]
s_waitcnt lgkmcnt(12)
v_mfma_f32_16x16x32_bf16 v[96:99], v[152:155], v[176:179], v[96:99]
ds_read_b64_tr_b16 v[148:149], v217 offset:8200
v_mfma_f32_16x16x32_bf16 v[100:103], v[152:155], v[180:183], v[100:103]
ds_read_b64_tr_b16 v[150:151], v217 offset:9224
v_mfma_f32_16x16x32_bf16 v[104:107], v[152:155], v[184:187], v[104:107]
buffer_load_dwordx4 v225, s[4:7], s36 offen offset:1024 lds
s_add_u32 s36, s32, 47104
v_mfma_f32_16x16x32_bf16 v[108:111], v[152:155], v[188:191], v[108:111]
s_waitcnt lgkmcnt(12)
v_mfma_f32_16x16x32_bf16 v[112:115], v[156:159], v[176:179], v[112:115]
ds_read_b64_tr_b16 v[152:153], v218 offset:8192
v_mfma_f32_16x16x32_bf16 v[116:119], v[156:159], v[180:183], v[116:119]
ds_read_b64_tr_b16 v[154:155], v218 offset:9216
v_mfma_f32_16x16x32_bf16 v[120:123], v[156:159], v[184:187], v[120:123]
v_mfma_f32_16x16x32_bf16 v[124:127], v[156:159], v[188:191], v[124:127]
s_waitcnt lgkmcnt(12)
v_mfma_f32_16x16x32_bf16 a[128:131], v[128:131], v[176:179], a[128:131]
ds_read_b64_tr_b16 v[156:157], v218 offset:8200
v_mfma_f32_16x16x32_bf16 a[132:135], v[128:131], v[180:183], a[132:135]
ds_read_b64_tr_b16 v[158:159], v218 offset:9224
v_mfma_f32_16x16x32_bf16 a[136:139], v[128:131], v[184:187], a[136:139]
v_add_u32 v215, s37, v215
v_add_u32 v216, s37, v216
v_mfma_f32_16x16x32_bf16 a[140:143], v[128:131], v[188:191], a[140:143]
v_add_u32 v217, s37, v217
v_add_u32 v218, s37, v218
s_waitcnt lgkmcnt(12)
v_mfma_f32_16x16x32_bf16 a[144:147], v[132:135], v[176:179], a[144:147]
ds_read_b64_tr_b16 v[128:129], v215 offset:0
v_mfma_f32_16x16x32_bf16 a[148:151], v[132:135], v[180:183], a[148:151]
ds_read_b64_tr_b16 v[130:131], v215 offset:1024
v_mfma_f32_16x16x32_bf16 a[152:155], v[132:135], v[184:187], a[152:155]
v_add_u32 v219, s38, v219
v_add_u32 v220, s38, v220
v_mfma_f32_16x16x32_bf16 a[156:159], v[132:135], v[188:191], a[156:159]
v_add_u32 v221, s39, v221
v_add_u32 v222, s39, v222
s_waitcnt lgkmcnt(12)
v_mfma_f32_16x16x32_bf16 a[160:163], v[136:139], v[176:179], a[160:163]
ds_read_b64_tr_b16 v[132:133], v215 offset:8
v_mfma_f32_16x16x32_bf16 a[164:167], v[136:139], v[180:183], a[164:167]
ds_read_b64_tr_b16 v[134:135], v215 offset:1032
v_mfma_f32_16x16x32_bf16 a[168:171], v[136:139], v[184:187], a[168:171]
ds_read_b128 v[160:163], v219 offset:0
v_mfma_f32_16x16x32_bf16 a[172:175], v[136:139], v[188:191], a[172:175]
buffer_load_dwordx4 v224, s[4:7], s36 offen offset:2048 lds
s_waitcnt lgkmcnt(13)
v_mfma_f32_16x16x32_bf16 a[176:179], v[140:143], v[176:179], a[176:179]
ds_read_b64_tr_b16 v[136:137], v216 offset:0
s_add_u32 s36, s32, 54272
v_mfma_f32_16x16x32_bf16 a[180:183], v[140:143], v[180:183], a[180:183]
ds_read_b64_tr_b16 v[138:139], v216 offset:1024
v_mfma_f32_16x16x32_bf16 a[184:187], v[140:143], v[184:187], a[184:187]
ds_read_b128 v[164:167], v219 offset:2048
v_mfma_f32_16x16x32_bf16 a[188:191], v[140:143], v[188:191], a[188:191]
buffer_load_dwordx4 v225, s[4:7], s36 offen offset:3072 lds
s_waitcnt lgkmcnt(14)
v_mfma_f32_16x16x32_bf16 a[192:195], v[144:147], v[176:179], a[192:195]
ds_read_b64_tr_b16 v[140:141], v216 offset:8
s_add_u32 s32, s32, 128
v_mfma_f32_16x16x32_bf16 a[196:199], v[144:147], v[180:183], a[196:199]
ds_read_b64_tr_b16 v[142:143], v216 offset:1032
s_add_u32 s30, s30, 16384
v_mfma_f32_16x16x32_bf16 a[200:203], v[144:147], v[184:187], a[200:203]
ds_read_b128 v[168:171], v221 offset:0
v_mfma_f32_16x16x32_bf16 a[204:207], v[144:147], v[188:191], a[204:207]
s_cmp_eq_u32 s30, 163840
s_cselect_b32 s30, 0, s30
s_waitcnt lgkmcnt(15)
v_mfma_f32_16x16x32_bf16 a[208:211], v[148:151], v[176:179], a[208:211]
ds_read_b64_tr_b16 v[144:145], v217 offset:0
v_mfma_f32_16x16x32_bf16 a[212:215], v[148:151], v[180:183], a[212:215]
ds_read_b64_tr_b16 v[146:147], v217 offset:1024
v_mfma_f32_16x16x32_bf16 a[216:219], v[148:151], v[184:187], a[216:219]
ds_read_b128 v[172:175], v221 offset:2048
v_mfma_f32_16x16x32_bf16 a[220:223], v[148:151], v[188:191], a[220:223]
s_waitcnt lgkmcnt(15)
v_mfma_f32_16x16x32_bf16 a[224:227], v[152:155], v[176:179], a[224:227]
ds_read_b64_tr_b16 v[148:149], v217 offset:8
v_mfma_f32_16x16x32_bf16 a[228:231], v[152:155], v[180:183], a[228:231]
ds_read_b64_tr_b16 v[150:151], v217 offset:1032
v_mfma_f32_16x16x32_bf16 a[232:235], v[152:155], v[184:187], a[232:235]
v_mfma_f32_16x16x32_bf16 a[236:239], v[152:155], v[188:191], a[236:239]
s_waitcnt lgkmcnt(15)
v_mfma_f32_16x16x32_bf16 a[240:243], v[156:159], v[176:179], a[240:243]
ds_read_b64_tr_b16 v[152:153], v218 offset:0
v_mfma_f32_16x16x32_bf16 a[244:247], v[156:159], v[180:183], a[244:247]
ds_read_b64_tr_b16 v[154:155], v218 offset:1024
v_mfma_f32_16x16x32_bf16 a[248:251], v[156:159], v[184:187], a[248:251]
v_mfma_f32_16x16x32_bf16 a[252:255], v[156:159], v[188:191], a[252:255]
s_waitcnt lgkmcnt(13)
v_mfma_f32_16x16x32_bf16 v[0:3], v[128:131], v[160:163], v[0:3]
ds_read_b64_tr_b16 v[156:157], v218 offset:8
s_waitcnt lgkmcnt(11)
v_mfma_f32_16x16x32_bf16 v[4:7], v[128:131], v[164:167], v[4:7]
s_waitcnt vmcnt(12)
s_barrier
ds_read_b64_tr_b16 v[158:159], v218 offset:1032
s_waitcnt lgkmcnt(9)
v_mfma_f32_16x16x32_bf16 v[8:11], v[128:131], v[168:171], v[8:11]
s_sub_u32 s37, s35, s50
s_mov_b32 s50, s35
s_waitcnt lgkmcnt(6)
v_mfma_f32_16x16x32_bf16 v[12:15], v[128:131], v[172:175], v[12:15]
s_add_u32 s35, s35, 16384
s_add_u32 m0, s30, s29
v_mfma_f32_16x16x32_bf16 v[16:19], v[132:135], v[160:163], v[16:19]
ds_read_b64_tr_b16 v[128:129], v215 offset:8192
s_add_u32 s36, s31, 0
v_mfma_f32_16x16x32_bf16 v[20:23], v[132:135], v[164:167], v[20:23]
ds_read_b64_tr_b16 v[130:131], v215 offset:9216
v_mfma_f32_16x16x32_bf16 v[24:27], v[132:135], v[168:171], v[24:27]
s_cmp_eq_u32 s35, 163840
s_cselect_b32 s35, 0, s35
v_mfma_f32_16x16x32_bf16 v[28:31], v[132:135], v[172:175], v[28:31]
buffer_load_dwordx4 v223, s[8:11], s36 offen offset:0 lds
v_mfma_f32_16x16x32_bf16 v[32:35], v[136:139], v[160:163], v[32:35]
ds_read_b64_tr_b16 v[132:133], v215 offset:8200
s_add_u32 s36, s31, 31744
v_mfma_f32_16x16x32_bf16 v[36:39], v[136:139], v[164:167], v[36:39]
ds_read_b64_tr_b16 v[134:135], v215 offset:9224
v_mfma_f32_16x16x32_bf16 v[40:43], v[136:139], v[168:171], v[40:43]
buffer_load_dwordx4 v223, s[8:11], s36 offen offset:1024 lds
s_add_u32 s36, s31, 63488
v_mfma_f32_16x16x32_bf16 v[44:47], v[136:139], v[172:175], v[44:47]
v_mfma_f32_16x16x32_bf16 v[48:51], v[140:143], v[160:163], v[48:51]
ds_read_b64_tr_b16 v[136:137], v216 offset:8192
v_mfma_f32_16x16x32_bf16 v[52:55], v[140:143], v[164:167], v[52:55]
ds_read_b64_tr_b16 v[138:139], v216 offset:9216
v_mfma_f32_16x16x32_bf16 v[56:59], v[140:143], v[168:171], v[56:59]
v_mfma_f32_16x16x32_bf16 v[60:63], v[140:143], v[172:175], v[60:63]
v_mfma_f32_16x16x32_bf16 v[64:67], v[144:147], v[160:163], v[64:67]
ds_read_b64_tr_b16 v[140:141], v216 offset:8200
v_mfma_f32_16x16x32_bf16 v[68:71], v[144:147], v[164:167], v[68:71]
ds_read_b64_tr_b16 v[142:143], v216 offset:9224
v_mfma_f32_16x16x32_bf16 v[72:75], v[144:147], v[168:171], v[72:75]
buffer_load_dwordx4 v223, s[8:11], s36 offen offset:2048 lds
s_add_u32 s36, s31, 95232
v_mfma_f32_16x16x32_bf16 v[76:79], v[144:147], v[172:175], v[76:79]
s_waitcnt lgkmcnt(12)
v_mfma_f32_16x16x32_bf16 v[80:83], v[148:151], v[160:163], v[80:83]
ds_read_b64_tr_b16 v[144:145], v217 offset:8192
v_mfma_f32_16x16x32_bf16 v[84:87], v[148:151], v[164:167], v[84:87]
ds_read_b64_tr_b16 v[146:147], v217 offset:9216
v_mfma_f32_16x16x32_bf16 v[88:91], v[148:151], v[168:171], v[88:91]
v_mfma_f32_16x16x32_bf16 v[92:95], v[148:151], v[172:175], v[92:95]
s_waitcnt lgkmcnt(12)
v_mfma_f32_16x16x32_bf16 v[96:99], v[152:155], v[160:163], v[96:99]
ds_read_b64_tr_b16 v[148:149], v217 offset:8200
v_mfma_f32_16x16x32_bf16 v[100:103], v[152:155], v[164:167], v[100:103]
ds_read_b64_tr_b16 v[150:151], v217 offset:9224
v_mfma_f32_16x16x32_bf16 v[104:107], v[152:155], v[168:171], v[104:107]
buffer_load_dwordx4 v223, s[8:11], s36 offen offset:3072 lds
s_add_u32 s31, s31, 262144
v_mfma_f32_16x16x32_bf16 v[108:111], v[152:155], v[172:175], v[108:111]
s_add_u32 s30, s30, 16384
s_waitcnt lgkmcnt(12)
v_mfma_f32_16x16x32_bf16 v[112:115], v[156:159], v[160:163], v[112:115]
ds_read_b64_tr_b16 v[152:153], v218 offset:8192
v_mfma_f32_16x16x32_bf16 v[116:119], v[156:159], v[164:167], v[116:119]
ds_read_b64_tr_b16 v[154:155], v218 offset:9216
v_mfma_f32_16x16x32_bf16 v[120:123], v[156:159], v[168:171], v[120:123]
s_cmp_eq_u32 s30, 163840
s_cselect_b32 s30, 0, s30
s_add_u32 m0, s30, s29
v_mfma_f32_16x16x32_bf16 v[124:127], v[156:159], v[172:175], v[124:127]
s_add_u32 s36, s31, 0
s_waitcnt lgkmcnt(12)
v_mfma_f32_16x16x32_bf16 a[128:131], v[128:131], v[160:163], a[128:131]
ds_read_b64_tr_b16 v[156:157], v218 offset:8200
v_mfma_f32_16x16x32_bf16 a[132:135], v[128:131], v[164:167], a[132:135]
ds_read_b64_tr_b16 v[158:159], v218 offset:9224
v_mfma_f32_16x16x32_bf16 a[136:139], v[128:131], v[168:171], a[136:139]
v_add_u32 v215, s37, v215
v_add_u32 v216, s37, v216
v_mfma_f32_16x16x32_bf16 a[140:143], v[128:131], v[172:175], a[140:143]
v_add_u32 v217, s37, v217
v_add_u32 v218, s37, v218
s_waitcnt lgkmcnt(12)
v_mfma_f32_16x16x32_bf16 a[144:147], v[132:135], v[160:163], a[144:147]
ds_read_b64_tr_b16 v[128:129], v215 offset:0
v_mfma_f32_16x16x32_bf16 a[148:151], v[132:135], v[164:167], a[148:151]
ds_read_b64_tr_b16 v[130:131], v215 offset:1024
v_mfma_f32_16x16x32_bf16 a[152:155], v[132:135], v[168:171], a[152:155]
buffer_load_dwordx4 v223, s[8:11], s36 offen offset:0 lds
s_add_u32 s36, s31, 31744
v_mfma_f32_16x16x32_bf16 a[156:159], v[132:135], v[172:175], a[156:159]
buffer_load_dwordx4 v223, s[8:11], s36 offen offset:1024 lds
s_waitcnt lgkmcnt(12)
v_mfma_f32_16x16x32_bf16 a[160:163], v[136:139], v[160:163], a[160:163]
ds_read_b64_tr_b16 v[132:133], v215 offset:8
s_add_u32 s36, s31, 63488
v_mfma_f32_16x16x32_bf16 a[164:167], v[136:139], v[164:167], a[164:167]
ds_read_b64_tr_b16 v[134:135], v215 offset:1032
v_mfma_f32_16x16x32_bf16 a[168:171], v[136:139], v[168:171], a[168:171]
ds_read_b128 v[176:179], v220 offset:0
v_mfma_f32_16x16x32_bf16 a[172:175], v[136:139], v[172:175], a[172:175]
s_waitcnt lgkmcnt(13)
v_mfma_f32_16x16x32_bf16 a[176:179], v[140:143], v[160:163], a[176:179]
ds_read_b64_tr_b16 v[136:137], v216 offset:0
v_mfma_f32_16x16x32_bf16 a[180:183], v[140:143], v[164:167], a[180:183]
ds_read_b64_tr_b16 v[138:139], v216 offset:1024
v_mfma_f32_16x16x32_bf16 a[184:187], v[140:143], v[168:171], a[184:187]
ds_read_b128 v[180:183], v220 offset:2048
v_mfma_f32_16x16x32_bf16 a[188:191], v[140:143], v[172:175], a[188:191]
buffer_load_dwordx4 v223, s[8:11], s36 offen offset:2048 lds
s_waitcnt lgkmcnt(14)
v_mfma_f32_16x16x32_bf16 a[192:195], v[144:147], v[160:163], a[192:195]
ds_read_b64_tr_b16 v[140:141], v216 offset:8
s_add_u32 s36, s31, 95232
v_mfma_f32_16x16x32_bf16 a[196:199], v[144:147], v[164:167], a[196:199]
ds_read_b64_tr_b16 v[142:143], v216 offset:1032
v_mfma_f32_16x16x32_bf16 a[200:203], v[144:147], v[168:171], a[200:203]
ds_read_b128 v[184:187], v222 offset:0
v_mfma_f32_16x16x32_bf16 a[204:207], v[144:147], v[172:175], a[204:207]
s_waitcnt lgkmcnt(15)
v_mfma_f32_16x16x32_bf16 a[208:211], v[148:151], v[160:163], a[208:211]
ds_read_b64_tr_b16 v[144:145], v217 offset:0
v_mfma_f32_16x16x32_bf16 a[212:215], v[148:151], v[164:167], a[212:215]
ds_read_b64_tr_b16 v[146:147], v217 offset:1024
v_mfma_f32_16x16x32_bf16 a[216:219], v[148:151], v[168:171], a[216:219]
ds_read_b128 v[188:191], v222 offset:2048
v_mfma_f32_16x16x32_bf16 a[220:223], v[148:151], v[172:175], a[220:223]
buffer_load_dwordx4 v223, s[8:11], s36 offen offset:3072 lds
s_waitcnt lgkmcnt(15)
v_mfma_f32_16x16x32_bf16 a[224:227], v[152:155], v[160:163], a[224:227]
ds_read_b64_tr_b16 v[148:149], v217 offset:8
s_add_u32 s31, s31, 262144
v_mfma_f32_16x16x32_bf16 a[228:231], v[152:155], v[164:167], a[228:231]
ds_read_b64_tr_b16 v[150:151], v217 offset:1032
s_add_u32 s30, s30, 16384
v_mfma_f32_16x16x32_bf16 a[232:235], v[152:155], v[168:171], a[232:235]
s_cmp_eq_u32 s30, 163840
s_cselect_b32 s30, 0, s30
v_mfma_f32_16x16x32_bf16 a[236:239], v[152:155], v[172:175], a[236:239]
s_waitcnt lgkmcnt(15)
v_mfma_f32_16x16x32_bf16 a[240:243], v[156:159], v[160:163], a[240:243]
ds_read_b64_tr_b16 v[152:153], v218 offset:0
v_mfma_f32_16x16x32_bf16 a[244:247], v[156:159], v[164:167], a[244:247]
ds_read_b64_tr_b16 v[154:155], v218 offset:1024
v_mfma_f32_16x16x32_bf16 a[248:251], v[156:159], v[168:171], a[248:251]
v_mfma_f32_16x16x32_bf16 a[252:255], v[156:159], v[172:175], a[252:255]
s_mov_b32 s40, 3
L_loop0:
s_waitcnt lgkmcnt(13)
v_mfma_f32_16x16x32_bf16 v[0:3], v[128:131], v[176:179], v[0:3]
ds_read_b64_tr_b16 v[156:157], v218 offset:8
s_waitcnt lgkmcnt(11)
v_mfma_f32_16x16x32_bf16 v[4:7], v[128:131], v[180:183], v[4:7]
s_waitcnt vmcnt(8)
s_barrier
ds_read_b64_tr_b16 v[158:159], v218 offset:1032
s_waitcnt lgkmcnt(9)
v_mfma_f32_16x16x32_bf16 v[8:11], v[128:131], v[184:187], v[8:11]
s_sub_u32 s37, s35, s50
s_mov_b32 s50, s35
s_waitcnt lgkmcnt(6)
v_mfma_f32_16x16x32_bf16 v[12:15], v[128:131], v[188:191], v[12:15]
s_add_u32 s35, s35, 16384
s_add_u32 m0, s30, s29
v_mfma_f32_16x16x32_bf16 v[16:19], v[132:135], v[176:179], v[16:19]
ds_read_b64_tr_b16 v[128:129], v215 offset:8192
s_add_u32 s36, s32, 0
v_mfma_f32_16x16x32_bf16 v[20:23], v[132:135], v[180:183], v[20:23]
ds_read_b64_tr_b16 v[130:131], v215 offset:9216
v_mfma_f32_16x16x32_bf16 v[24:27], v[132:135], v[184:187], v[24:27]
s_cmp_eq_u32 s35, 163840
s_cselect_b32 s35, 0, s35
s_sub_u32 s38, s35, s51
v_mfma_f32_16x16x32_bf16 v[28:31], v[132:135], v[188:191], v[28:31]
s_mov_b32 s51, s35
s_add_u32 s35, s35, 16384
v_mfma_f32_16x16x32_bf16 v[32:35], v[136:139], v[176:179], v[32:35]
ds_read_b64_tr_b16 v[132:133], v215 offset:8200
v_mfma_f32_16x16x32_bf16 v[36:39], v[136:139], v[180:183], v[36:39]
ds_read_b64_tr_b16 v[134:135], v215 offset:9224
v_mfma_f32_16x16x32_bf16 v[40:43], v[136:139], v[184:187], v[40:43]
s_cmp_eq_u32 s35, 163840
s_cselect_b32 s35, 0, s35
s_sub_u32 s39, s35, s52
v_mfma_f32_16x16x32_bf16 v[44:47], v[136:139], v[188:191], v[44:47]
s_mov_b32 s52, s35
s_add_u32 s35, s35, 16384
v_mfma_f32_16x16x32_bf16 v[48:51], v[140:143], v[176:179], v[48:51]
ds_read_b64_tr_b16 v[136:137], v216 offset:8192
v_mfma_f32_16x16x32_bf16 v[52:55], v[140:143], v[180:183], v[52:55]
ds_read_b64_tr_b16 v[138:139], v216 offset:9216
v_mfma_f32_16x16x32_bf16 v[56:59], v[140:143], v[184:187], v[56:59]
s_cmp_eq_u32 s35, 163840
s_cselect_b32 s35, 0, s35
v_mfma_f32_16x16x32_bf16 v[60:63], v[140:143], v[188:191], v[60:63]
buffer_load_dwordx4 v224, s[4:7], s36 offen offset:0 lds
v_mfma_f32_16x16x32_bf16 v[64:67], v[144:147], v[176:179], v[64:67]
ds_read_b64_tr_b16 v[140:141], v216 offset:8200
s_add_u32 s36, s32, 7168
v_mfma_f32_16x16x32_bf16 v[68:71], v[144:147], v[180:183], v[68:71]
ds_read_b64_tr_b16 v[142:143], v216 offset:9224
v_mfma_f32_16x16x32_bf16 v[72:75], v[144:147], v[184:187], v[72:75]
buffer_load_dwordx4 v225, s[4:7], s36 offen offset:1024 lds
s_add_u32 s36, s32, 14336
v_mfma_f32_16x16x32_bf16 v[76:79], v[144:147], v[188:191], v[76:79]
buffer_load_dwordx4 v224, s[4:7], s36 offen offset:2048 lds
s_waitcnt lgkmcnt(12)
v_mfma_f32_16x16x32_bf16 v[80:83], v[148:151], v[176:179], v[80:83]
ds_read_b64_tr_b16 v[144:145], v217 offset:8192
s_add_u32 s36, s32, 21504
v_mfma_f32_16x16x32_bf16 v[84:87], v[148:151], v[180:183], v[84:87]
ds_read_b64_tr_b16 v[146:147], v217 offset:9216
v_mfma_f32_16x16x32_bf16 v[88:91], v[148:151], v[184:187], v[88:91]
v_mfma_f32_16x16x32_bf16 v[92:95], v[148:151], v[188:191], v[92:95]
s_waitcnt lgkmcnt(12)
v_mfma_f32_16x16x32_bf16 v[96:99], v[152:155], v[176:179], v[96:99]
ds_read_b64_tr_b16 v[148:149], v217 offset:8200
v_mfma_f32_16x16x32_bf16 v[100:103], v[152:155], v[180:183], v[100:103]
ds_read_b64_tr_b16 v[150:151], v217 offset:9224
v_mfma_f32_16x16x32_bf16 v[104:107], v[152:155], v[184:187], v[104:107]
buffer_load_dwordx4 v225, s[4:7], s36 offen offset:3072 lds
s_add_u32 s30, s30, 16384
v_mfma_f32_16x16x32_bf16 v[108:111], v[152:155], v[188:191], v[108:111]
s_cmp_eq_u32 s30, 163840
s_cselect_b32 s30, 0, s30
s_waitcnt lgkmcnt(12)
v_mfma_f32_16x16x32_bf16 v[112:115], v[156:159], v[176:179], v[112:115]
ds_read_b64_tr_b16 v[152:153], v218 offset:8192
s_add_u32 m0, s30, s29
v_mfma_f32_16x16x32_bf16 v[116:119], v[156:159], v[180:183], v[116:119]
ds_read_b64_tr_b16 v[154:155], v218 offset:9216
s_add_u32 s36, s32, 32768
v_mfma_f32_16x16x32_bf16 v[120:123], v[156:159], v[184:187], v[120:123]
v_mfma_f32_16x16x32_bf16 v[124:127], v[156:159], v[188:191], v[124:127]
s_waitcnt lgkmcnt(12)
v_mfma_f32_16x16x32_bf16 a[128:131], v[128:131], v[176:179], a[128:131]
ds_read_b64_tr_b16 v[156:157], v218 offset:8200
v_mfma_f32_16x16x32_bf16 a[132:135], v[128:131], v[180:183], a[132:135]
ds_read_b64_tr_b16 v[158:159], v218 offset:9224
v_mfma_f32_16x16x32_bf16 a[136:139], v[128:131], v[184:187], a[136:139]
v_add_u32 v215, s37, v215
v_add_u32 v216, s37, v216
v_mfma_f32_16x16x32_bf16 a[140:143], v[128:131], v[188:191], a[140:143]
v_add_u32 v217, s37, v217
v_add_u32 v218, s37, v218
s_waitcnt lgkmcnt(12)
v_mfma_f32_16x16x32_bf16 a[144:147], v[132:135], v[176:179], a[144:147]
ds_read_b64_tr_b16 v[128:129], v215 offset:0
v_mfma_f32_16x16x32_bf16 a[148:151], v[132:135], v[180:183], a[148:151]
ds_read_b64_tr_b16 v[130:131], v215 offset:1024
v_mfma_f32_16x16x32_bf16 a[152:155], v[132:135], v[184:187], a[152:155]
v_add_u32 v219, s38, v219
v_add_u32 v220, s38, v220
v_mfma_f32_16x16x32_bf16 a[156:159], v[132:135], v[188:191], a[156:159]
v_add_u32 v221, s39, v221
v_add_u32 v222, s39, v222
s_waitcnt lgkmcnt(12)
v_mfma_f32_16x16x32_bf16 a[160:163], v[136:139], v[176:179], a[160:163]
ds_read_b64_tr_b16 v[132:133], v215 offset:8
v_mfma_f32_16x16x32_bf16 a[164:167], v[136:139], v[180:183], a[164:167]
ds_read_b64_tr_b16 v[134:135], v215 offset:1032
v_mfma_f32_16x16x32_bf16 a[168:171], v[136:139], v[184:187], a[168:171]
ds_read_b128 v[160:163], v219 offset:0
v_mfma_f32_16x16x32_bf16 a[172:175], v[136:139], v[188:191], a[172:175]
buffer_load_dwordx4 v224, s[4:7], s36 offen offset:0 lds
s_waitcnt lgkmcnt(13)
v_mfma_f32_16x16x32_bf16 a[176:179], v[140:143], v[176:179], a[176:179]
ds_read_b64_tr_b16 v[136:137], v216 offset:0
s_add_u32 s36, s32, 39936
v_mfma_f32_16x16x32_bf16 a[180:183], v[140:143], v[180:183], a[180:183]
ds_read_b64_tr_b16 v[138:139], v216 offset:1024
v_mfma_f32_16x16x32_bf16 a[184:187], v[140:143], v[184:187], a[184:187]
ds_read_b128 v[164:167], v219 offset:2048
v_mfma_f32_16x16x32_bf16 a[188:191], v[140:143], v[188:191], a[188:191]
buffer_load_dwordx4 v225, s[4:7], s36 offen offset:1024 lds
s_waitcnt lgkmcnt(14)
v_mfma_f32_16x16x32_bf16 a[192:195], v[144:147], v[176:179], a[192:195]
ds_read_b64_tr_b16 v[140:141], v216 offset:8
s_add_u32 s36, s32, 47104
v_mfma_f32_16x16x32_bf16 a[196:199], v[144:147], v[180:183], a[196:199]
ds_read_b64_tr_b16 v[142:143], v216 offset:1032
v_mfma_f32_16x16x32_bf16 a[200:203], v[144:147], v[184:187], a[200:203]
ds_read_b128 v[168:171], v221 offset:0
v_mfma_f32_16x16x32_bf16 a[204:207], v[144:147], v[188:191], a[204:207]
buffer_load_dwordx4 v224, s[4:7], s36 offen offset:2048 lds
s_waitcnt lgkmcnt(15)
v_mfma_f32_16x16x32_bf16 a[208:211], v[148:151], v[176:179], a[208:211]
ds_read_b64_tr_b16 v[144:145], v217 offset:0
s_add_u32 s36, s32, 54272
v_mfma_f32_16x16x32_bf16 a[212:215], v[148:151], v[180:183], a[212:215]
ds_read_b64_tr_b16 v[146:147], v217 offset:1024
v_mfma_f32_16x16x32_bf16 a[216:219], v[148:151], v[184:187], a[216:219]
ds_read_b128 v[172:175], v221 offset:2048
v_mfma_f32_16x16x32_bf16 a[220:223], v[148:151], v[188:191], a[220:223]
buffer_load_dwordx4 v225, s[4:7], s36 offen offset:3072 lds
s_waitcnt lgkmcnt(15)
v_mfma_f32_16x16x32_bf16 a[224:227], v[152:155], v[176:179], a[224:227]
ds_read_b64_tr_b16 v[148:149], v217 offset:8
s_add_u32 s32, s32, 128
v_mfma_f32_16x16x32_bf16 a[228:231], v[152:155], v[180:183], a[228:231]
ds_read_b64_tr_b16 v[150:151], v217 offset:1032
s_add_u32 s30, s30, 16384
v_mfma_f32_16x16x32_bf16 a[232:235], v[152:155], v[184:187], a[232:235]
s_cmp_eq_u32 s30, 163840
s_cselect_b32 s30, 0, s30
v_mfma_f32_16x16x32_bf16 a[236:239], v[152:155], v[188:191], a[236:239]
s_waitcnt lgkmcnt(15)
v_mfma_f32_16x16x32_bf16 a[240:243], v[156:159], v[176:179], a[240:243]
ds_read_b64_tr_b16 v[152:153], v218 offset:0
v_mfma_f32_16x16x32_bf16 a[244:247], v[156:159], v[180:183], a[244:247]
ds_read_b64_tr_b16 v[154:155], v218 offset:1024
v_mfma_f32_16x16x32_bf16 a[248:251], v[156:159], v[184:187], a[248:251]
v_mfma_f32_16x16x32_bf16 a[252:255], v[156:159], v[188:191], a[252:255]
s_waitcnt lgkmcnt(13)
v_mfma_f32_16x16x32_bf16 v[0:3], v[128:131], v[160:163], v[0:3]
ds_read_b64_tr_b16 v[156:157], v218 offset:8
s_waitcnt lgkmcnt(11)
v_mfma_f32_16x16x32_bf16 v[4:7], v[128:131], v[164:167], v[4:7]
s_waitcnt vmcnt(12)
s_barrier
ds_read_b64_tr_b16 v[158:159], v218 offset:1032
s_waitcnt lgkmcnt(9)
v_mfma_f32_16x16x32_bf16 v[8:11], v[128:131], v[168:171], v[8:11]
s_sub_u32 s37, s35, s50
s_mov_b32 s50, s35
s_waitcnt lgkmcnt(6)
v_mfma_f32_16x16x32_bf16 v[12:15], v[128:131], v[172:175], v[12:15]
s_add_u32 s35, s35, 16384
s_add_u32 m0, s30, s29
v_mfma_f32_16x16x32_bf16 v[16:19], v[132:135], v[160:163], v[16:19]
ds_read_b64_tr_b16 v[128:129], v215 offset:8192
s_add_u32 s36, s31, 0
v_mfma_f32_16x16x32_bf16 v[20:23], v[132:135], v[164:167], v[20:23]
ds_read_b64_tr_b16 v[130:131], v215 offset:9216
v_mfma_f32_16x16x32_bf16 v[24:27], v[132:135], v[168:171], v[24:27]
s_cmp_eq_u32 s35, 163840
s_cselect_b32 s35, 0, s35
v_mfma_f32_16x16x32_bf16 v[28:31], v[132:135], v[172:175], v[28:31]
buffer_load_dwordx4 v223, s[8:11], s36 offen offset:0 lds
v_mfma_f32_16x16x32_bf16 v[32:35], v[136:139], v[160:163], v[32:35]
ds_read_b64_tr_b16 v[132:133], v215 offset:8200
s_add_u32 s36, s31, 31744
v_mfma_f32_16x16x32_bf16 v[36:39], v[136:139], v[164:167], v[36:39]
ds_read_b64_tr_b16 v[134:135], v215 offset:9224
v_mfma_f32_16x16x32_bf16 v[40:43], v[136:139], v[168:171], v[40:43]
buffer_load_dwordx4 v223, s[8:11], s36 offen offset:1024 lds
s_add_u32 s36, s31, 63488
v_mfma_f32_16x16x32_bf16 v[44:47], v[136:139], v[172:175], v[44:47]
v_mfma_f32_16x16x32_bf16 v[48:51], v[140:143], v[160:163], v[48:51]
ds_read_b64_tr_b16 v[136:137], v216 offset:8192
v_mfma_f32_16x16x32_bf16 v[52:55], v[140:143], v[164:167], v[52:55]
ds_read_b64_tr_b16 v[138:139], v216 offset:9216
v_mfma_f32_16x16x32_bf16 v[56:59], v[140:143], v[168:171], v[56:59]
v_mfma_f32_16x16x32_bf16 v[60:63], v[140:143], v[172:175], v[60:63]
v_mfma_f32_16x16x32_bf16 v[64:67], v[144:147], v[160:163], v[64:67]
ds_read_b64_tr_b16 v[140:141], v216 offset:8200
v_mfma_f32_16x16x32_bf16 v[68:71], v[144:147], v[164:167], v[68:71]
ds_read_b64_tr_b16 v[142:143], v216 offset:9224
v_mfma_f32_16x16x32_bf16 v[72:75], v[144:147], v[168:171], v[72:75]
buffer_load_dwordx4 v223, s[8:11], s36 offen offset:2048 lds
s_add_u32 s36, s31, 95232
v_mfma_f32_16x16x32_bf16 v[76:79], v[144:147], v[172:175], v[76:79]
s_waitcnt lgkmcnt(12)
v_mfma_f32_16x16x32_bf16 v[80:83], v[148:151], v[160:163], v[80:83]
ds_read_b64_tr_b16 v[144:145], v217 offset:8192
v_mfma_f32_16x16x32_bf16 v[84:87], v[148:151], v[164:167], v[84:87]
ds_read_b64_tr_b16 v[146:147], v217 offset:9216
v_mfma_f32_16x16x32_bf16 v[88:91], v[148:151], v[168:171], v[88:91]
v_mfma_f32_16x16x32_bf16 v[92:95], v[148:151], v[172:175], v[92:95]
s_waitcnt lgkmcnt(12)
v_mfma_f32_16x16x32_bf16 v[96:99], v[152:155], v[160:163], v[96:99]
ds_read_b64_tr_b16 v[148:149], v217 offset:8200
v_mfma_f32_16x16x32_bf16 v[100:103], v[152:155], v[164:167], v[100:103]
ds_read_b64_tr_b16 v[150:151], v217 offset:9224
v_mfma_f32_16x16x32_bf16 v[104:107], v[152:155], v[168:171], v[104:107]
buffer_load_dwordx4 v223, s[8:11], s36 offen offset:3072 lds
s_add_u32 s31, s31, 262144
v_mfma_f32_16x16x32_bf16 v[108:111], v[152:155], v[172:175], v[108:111]
s_add_u32 s30, s30, 16384
s_waitcnt lgkmcnt(12)
v_mfma_f32_16x16x32_bf16 v[112:115], v[156:159], v[160:163], v[112:115]
ds_read_b64_tr_b16 v[152:153], v218 offset:8192
v_mfma_f32_16x16x32_bf16 v[116:119], v[156:159], v[164:167], v[116:119]
ds_read_b64_tr_b16 v[154:155], v218 offset:9216
v_mfma_f32_16x16x32_bf16 v[120:123], v[156:159], v[168:171], v[120:123]
s_cmp_eq_u32 s30, 163840
s_cselect_b32 s30, 0, s30
s_add_u32 m0, s30, s29
v_mfma_f32_16x16x32_bf16 v[124:127], v[156:159], v[172:175], v[124:127]
s_add_u32 s36, s31, 0
s_waitcnt lgkmcnt(12)
v_mfma_f32_16x16x32_bf16 a[128:131], v[128:131], v[160:163], a[128:131]
ds_read_b64_tr_b16 v[156:157], v218 offset:8200
v_mfma_f32_16x16x32_bf16 a[132:135], v[128:131], v[164:167], a[132:135]
ds_read_b64_tr_b16 v[158:159], v218 offset:9224
v_mfma_f32_16x16x32_bf16 a[136:139], v[128:131], v[168:171], a[136:139]
v_add_u32 v215, s37, v215
v_add_u32 v216, s37, v216
v_mfma_f32_16x16x32_bf16 a[140:143], v[128:131], v[172:175], a[140:143]
v_add_u32 v217, s37, v217
v_add_u32 v218, s37, v218
s_waitcnt lgkmcnt(12)
v_mfma_f32_16x16x32_bf16 a[144:147], v[132:135], v[160:163], a[144:147]
ds_read_b64_tr_b16 v[128:129], v215 offset:0
v_mfma_f32_16x16x32_bf16 a[148:151], v[132:135], v[164:167], a[148:151]
ds_read_b64_tr_b16 v[130:131], v215 offset:1024
v_mfma_f32_16x16x32_bf16 a[152:155], v[132:135], v[168:171], a[152:155]
buffer_load_dwordx4 v223, s[8:11], s36 offen offset:0 lds
s_add_u32 s36, s31, 31744
v_mfma_f32_16x16x32_bf16 a[156:159], v[132:135], v[172:175], a[156:159]
buffer_load_dwordx4 v223, s[8:11], s36 offen offset:1024 lds
s_waitcnt lgkmcnt(12)
v_mfma_f32_16x16x32_bf16 a[160:163], v[136:139], v[160:163], a[160:163]
ds_read_b64_tr_b16 v[132:133], v215 offset:8
s_add_u32 s36, s31, 63488
v_mfma_f32_16x16x32_bf16 a[164:167], v[136:139], v[164:167], a[164:167]
ds_read_b64_tr_b16 v[134:135], v215 offset:1032
v_mfma_f32_16x16x32_bf16 a[168:171], v[136:139], v[168:171], a[168:171]
ds_read_b128 v[176:179], v220 offset:0
v_mfma_f32_16x16x32_bf16 a[172:175], v[136:139], v[172:175], a[172:175]
s_waitcnt lgkmcnt(13)
v_mfma_f32_16x16x32_bf16 a[176:179], v[140:143], v[160:163], a[176:179]
ds_read_b64_tr_b16 v[136:137], v216 offset:0
v_mfma_f32_16x16x32_bf16 a[180:183], v[140:143], v[164:167], a[180:183]
ds_read_b64_tr_b16 v[138:139], v216 offset:1024
v_mfma_f32_16x16x32_bf16 a[184:187], v[140:143], v[168:171], a[184:187]
ds_read_b128 v[180:183], v220 offset:2048
v_mfma_f32_16x16x32_bf16 a[188:191], v[140:143], v[172:175], a[188:191]
buffer_load_dwordx4 v223, s[8:11], s36 offen offset:2048 lds
s_waitcnt lgkmcnt(14)
v_mfma_f32_16x16x32_bf16 a[192:195], v[144:147], v[160:163], a[192:195]
ds_read_b64_tr_b16 v[140:141], v216 offset:8
s_add_u32 s36, s31, 95232
v_mfma_f32_16x16x32_bf16 a[196:199], v[144:147], v[164:167], a[196:199]
ds_read_b64_tr_b16 v[142:143], v216 offset:1032
v_mfma_f32_16x16x32_bf16 a[200:203], v[144:147], v[168:171], a[200:203]
ds_read_b128 v[184:187], v222 offset:0
v_mfma_f32_16x16x32_bf16 a[204:207], v[144:147], v[172:175], a[204:207]
s_waitcnt lgkmcnt(15)
v_mfma_f32_16x16x32_bf16 a[208:211], v[148:151], v[160:163], a[208:211]
ds_read_b64_tr_b16 v[144:145], v217 offset:0
v_mfma_f32_16x16x32_bf16 a[212:215], v[148:151], v[164:167], a[212:215]
ds_read_b64_tr_b16 v[146:147], v217 offset:1024
v_mfma_f32_16x16x32_bf16 a[216:219], v[148:151], v[168:171], a[216:219]
ds_read_b128 v[188:191], v222 offset:2048
v_mfma_f32_16x16x32_bf16 a[220:223], v[148:151], v[172:175], a[220:223]
buffer_load_dwordx4 v223, s[8:11], s36 offen offset:3072 lds
s_waitcnt lgkmcnt(15)
v_mfma_f32_16x16x32_bf16 a[224:227], v[152:155], v[160:163], a[224:227]
ds_read_b64_tr_b16 v[148:149], v217 offset:8
s_add_u32 s31, s31, 262144
v_mfma_f32_16x16x32_bf16 a[228:231], v[152:155], v[164:167], a[228:231]
ds_read_b64_tr_b16 v[150:151], v217 offset:1032
s_add_u32 s30, s30, 16384
v_mfma_f32_16x16x32_bf16 a[232:235], v[152:155], v[168:171], a[232:235]
s_cmp_eq_u32 s30, 163840
s_cselect_b32 s30, 0, s30
v_mfma_f32_16x16x32_bf16 a[236:239], v[152:155], v[172:175], a[236:239]
s_waitcnt lgkmcnt(15)
v_mfma_f32_16x16x32_bf16 a[240:243], v[156:159], v[160:163], a[240:243]
ds_read_b64_tr_b16 v[152:153], v218 offset:0
v_mfma_f32_16x16x32_bf16 a[244:247], v[156:159], v[164:167], a[244:247]
ds_read_b64_tr_b16 v[154:155], v218 offset:1024
v_mfma_f32_16x16x32_bf16 a[248:251], v[156:159], v[168:171], a[248:251]
v_mfma_f32_16x16x32_bf16 a[252:255], v[156:159], v[172:175], a[252:255]
s_sub_u32 s40, s40, 1
s_cmp_lg_u32 s40, 0
s_cbranch_scc1 L_loop0
s_waitcnt lgkmcnt(13)
v_mfma_f32_16x16x32_bf16 v[0:3], v[128:131], v[176:179], v[0:3]
ds_read_b64_tr_b16 v[156:157], v218 offset:8
s_waitcnt lgkmcnt(11)
v_mfma_f32_16x16x32_bf16 v[4:7], v[128:131], v[180:183], v[4:7]
s_waitcnt vmcnt(8)
s_barrier
ds_read_b64_tr_b16 v[158:159], v218 offset:1032
s_waitcnt lgkmcnt(9)
v_mfma_f32_16x16x32_bf16 v[8:11], v[128:131], v[184:187], v[8:11]
s_sub_u32 s37, s35, s50
s_mov_b32 s50, s35
s_waitcnt lgkmcnt(6)
v_mfma_f32_16x16x32_bf16 v[12:15], v[128:131], v[188:191], v[12:15]
s_add_u32 s35, s35, 16384
s_add_u32 m0, s30, s29
v_mfma_f32_16x16x32_bf16 v[16:19], v[132:135], v[176:179], v[16:19]
ds_read_b64_tr_b16 v[128:129], v215 offset:8192
s_add_u32 s36, s32, 0
v_mfma_f32_16x16x32_bf16 v[20:23], v[132:135], v[180:183], v[20:23]
ds_read_b64_tr_b16 v[130:131], v215 offset:9216
v_mfma_f32_16x16x32_bf16 v[24:27], v[132:135], v[184:187], v[24:27]
s_cmp_eq_u32 s35, 163840
s_cselect_b32 s35, 0, s35
s_sub_u32 s38, s35, s51
v_mfma_f32_16x16x32_bf16 v[28:31], v[132:135], v[188:191], v[28:31]
s_mov_b32 s51, s35
s_add_u32 s35, s35, 16384
v_mfma_f32_16x16x32_bf16 v[32:35], v[136:139], v[176:179], v[32:35]
ds_read_b64_tr_b16 v[132:133], v215 offset:8200
v_mfma_f32_16x16x32_bf16 v[36:39], v[136:139], v[180:183], v[36:39]
ds_read_b64_tr_b16 v[134:135], v215 offset:9224
v_mfma_f32_16x16x32_bf16 v[40:43], v[136:139], v[184:187], v[40:43]
s_cmp_eq_u32 s35, 163840
s_cselect_b32 s35, 0, s35
s_sub_u32 s39, s35, s52
v_mfma_f32_16x16x32_bf16 v[44:47], v[136:139], v[188:191], v[44:47]
s_mov_b32 s52, s35
s_add_u32 s35, s35, 16384
v_mfma_f32_16x16x32_bf16 v[48:51], v[140:143], v[176:179], v[48:51]
ds_read_b64_tr_b16 v[136:137], v216 offset:8192
v_mfma_f32_16x16x32_bf16 v[52:55], v[140:143], v[180:183], v[52:55]
ds_read_b64_tr_b16 v[138:139], v216 offset:9216
v_mfma_f32_16x16x32_bf16 v[56:59], v[140:143], v[184:187], v[56:59]
s_cmp_eq_u32 s35, 163840
s_cselect_b32 s35, 0, s35
v_mfma_f32_16x16x32_bf16 v[60:63], v[140:143], v[188:191], v[60:63]
buffer_load_dwordx4 v224, s[4:7], s36 offen offset:0 lds
v_mfma_f32_16x16x32_bf16 v[64:67], v[144:147], v[176:179], v[64:67]
ds_read_b64_tr_b16 v[140:141], v216 offset:8200
s_add_u32 s36, s32, 7168
v_mfma_f32_16x16x32_bf16 v[68:71], v[144:147], v[180:183], v[68:71]
ds_read_b64_tr_b16 v[142:143], v216 offset:9224
v_mfma_f32_16x16x32_bf16 v[72:75], v[144:147], v[184:187], v[72:75]
buffer_load_dwordx4 v225, s[4:7], s36 offen offset:1024 lds
s_add_u32 s36, s32, 14336
v_mfma_f32_16x16x32_bf16 v[76:79], v[144:147], v[188:191], v[76:79]
buffer_load_dwordx4 v224, s[4:7], s36 offen offset:2048 lds
s_waitcnt lgkmcnt(12)
v_mfma_f32_16x16x32_bf16 v[80:83], v[148:151], v[176:179], v[80:83]
ds_read_b64_tr_b16 v[144:145], v217 offset:8192
s_add_u32 s36, s32, 21504
v_mfma_f32_16x16x32_bf16 v[84:87], v[148:151], v[180:183], v[84:87]
ds_read_b64_tr_b16 v[146:147], v217 offset:9216
v_mfma_f32_16x16x32_bf16 v[88:91], v[148:151], v[184:187], v[88:91]
v_mfma_f32_16x16x32_bf16 v[92:95], v[148:151], v[188:191], v[92:95]
s_waitcnt lgkmcnt(12)
v_mfma_f32_16x16x32_bf16 v[96:99], v[152:155], v[176:179], v[96:99]
ds_read_b64_tr_b16 v[148:149], v217 offset:8200
v_mfma_f32_16x16x32_bf16 v[100:103], v[152:155], v[180:183], v[100:103]
ds_read_b64_tr_b16 v[150:151], v217 offset:9224
v_mfma_f32_16x16x32_bf16 v[104:107], v[152:155], v[184:187], v[104:107]
buffer_load_dwordx4 v225, s[4:7], s36 offen offset:3072 lds
s_add_u32 s30, s30, 16384
v_mfma_f32_16x16x32_bf16 v[108:111], v[152:155], v[188:191], v[108:111]
s_cmp_eq_u32 s30, 163840
s_cselect_b32 s30, 0, s30
s_waitcnt lgkmcnt(12)
v_mfma_f32_16x16x32_bf16 v[112:115], v[156:159], v[176:179], v[112:115]
ds_read_b64_tr_b16 v[152:153], v218 offset:8192
s_add_u32 m0, s30, s29
v_mfma_f32_16x16x32_bf16 v[116:119], v[156:159], v[180:183], v[116:119]
ds_read_b64_tr_b16 v[154:155], v218 offset:9216
s_add_u32 s36, s32, 32768
v_mfma_f32_16x16x32_bf16 v[120:123], v[156:159], v[184:187], v[120:123]
v_mfma_f32_16x16x32_bf16 v[124:127], v[156:159], v[188:191], v[124:127]
s_waitcnt lgkmcnt(12)
v_mfma_f32_16x16x32_bf16 a[128:131], v[128:131], v[176:179], a[128:131]
ds_read_b64_tr_b16 v[156:157], v218 offset:8200
v_mfma_f32_16x16x32_bf16 a[132:135], v[128:131], v[180:183], a[132:135]
ds_read_b64_tr_b16 v[158:159], v218 offset:9224
v_mfma_f32_16x16x32_bf16 a[136:139], v[128:131], v[184:187], a[136:139]
v_add_u32 v215, s37, v215
v_add_u32 v216, s37, v216
v_mfma_f32_16x16x32_bf16 a[140:143], v[128:131], v[188:191], a[140:143]
v_add_u32 v217, s37, v217
v_add_u32 v218, s37, v218
s_waitcnt lgkmcnt(12)
v_mfma_f32_16x16x32_bf16 a[144:147], v[132:135], v[176:179], a[144:147]
ds_read_b64_tr_b16 v[128:129], v215 offset:0
v_mfma_f32_16x16x32_bf16 a[148:151], v[132:135], v[180:183], a[148:151]
ds_read_b64_tr_b16 v[130:131], v215 offset:1024
v_mfma_f32_16x16x32_bf16 a[152:155], v[132:135], v[184:187], a[152:155]
v_add_u32 v219, s38, v219
v_add_u32 v220, s38, v220
v_mfma_f32_16x16x32_bf16 a[156:159], v[132:135], v[188:191], a[156:159]
v_add_u32 v221, s39, v221
v_add_u32 v222, s39, v222
s_waitcnt lgkmcnt(12)
v_mfma_f32_16x16x32_bf16 a[160:163], v[136:139], v[176:179], a[160:163]
ds_read_b64_tr_b16 v[132:133], v215 offset:8
v_mfma_f32_16x16x32_bf16 a[164:167], v[136:139], v[180:183], a[164:167]
ds_read_b64_tr_b16 v[134:135], v215 offset:1032
v_mfma_f32_16x16x32_bf16 a[168:171], v[136:139], v[184:187], a[168:171]
ds_read_b128 v[160:163], v219 offset:0
v_mfma_f32_16x16x32_bf16 a[172:175], v[136:139], v[188:191], a[172:175]
buffer_load_dwordx4 v224, s[4:7], s36 offen offset:0 lds
s_waitcnt lgkmcnt(13)
v_mfma_f32_16x16x32_bf16 a[176:179], v[140:143], v[176:179], a[176:179]
ds_read_b64_tr_b16 v[136:137], v216 offset:0
s_add_u32 s36, s32, 39936
v_mfma_f32_16x16x32_bf16 a[180:183], v[140:143], v[180:183], a[180:183]
ds_read_b64_tr_b16 v[138:139], v216 offset:1024
v_mfma_f32_16x16x32_bf16 a[184:187], v[140:143], v[184:187], a[184:187]
ds_read_b128 v[164:167], v219 offset:2048
v_mfma_f32_16x16x32_bf16 a[188:191], v[140:143], v[188:191], a[188:191]
buffer_load_dwordx4 v225, s[4:7], s36 offen offset:1024 lds
s_waitcnt lgkmcnt(14)
v_mfma_f32_16x16x32_bf16 a[192:195], v[144:147], v[176:179], a[192:195]
ds_read_b64_tr_b16 v[140:141], v216 offset:8
s_add_u32 s36, s32, 47104
v_mfma_f32_16x16x32_bf16 a[196:199], v[144:147], v[180:183], a[196:199]
ds_read_b64_tr_b16 v[142:143], v216 offset:1032
v_mfma_f32_16x16x32_bf16 a[200:203], v[144:147], v[184:187], a[200:203]
ds_read_b128 v[168:171], v221 offset:0
v_mfma_f32_16x16x32_bf16 a[204:207], v[144:147], v[188:191], a[204:207]
buffer_load_dwordx4 v224, s[4:7], s36 offen offset:2048 lds
s_waitcnt lgkmcnt(15)
v_mfma_f32_16x16x32_bf16 a[208:211], v[148:151], v[176:179], a[208:211]
ds_read_b64_tr_b16 v[144:145], v217 offset:0
s_add_u32 s36, s32, 54272
v_mfma_f32_16x16x32_bf16 a[212:215], v[148:151], v[180:183], a[212:215]
ds_read_b64_tr_b16 v[146:147], v217 offset:1024
v_mfma_f32_16x16x32_bf16 a[216:219], v[148:151], v[184:187], a[216:219]
ds_read_b128 v[172:175], v221 offset:2048
v_mfma_f32_16x16x32_bf16 a[220:223], v[148:151], v[188:191], a[220:223]
buffer_load_dwordx4 v225, s[4:7], s36 offen offset:3072 lds
s_waitcnt lgkmcnt(15)
v_mfma_f32_16x16x32_bf16 a[224:227], v[152:155], v[176:179], a[224:227]
ds_read_b64_tr_b16 v[148:149], v217 offset:8
s_add_u32 s32, s32, 128
v_mfma_f32_16x16x32_bf16 a[228:231], v[152:155], v[180:183], a[228:231]
ds_read_b64_tr_b16 v[150:151], v217 offset:1032
s_add_u32 s30, s30, 16384
v_mfma_f32_16x16x32_bf16 a[232:235], v[152:155], v[184:187], a[232:235]
s_cmp_eq_u32 s30, 163840
s_cselect_b32 s30, 0, s30
v_mfma_f32_16x16x32_bf16 a[236:239], v[152:155], v[188:191], a[236:239]
s_waitcnt lgkmcnt(15)
v_mfma_f32_16x16x32_bf16 a[240:243], v[156:159], v[176:179], a[240:243]
ds_read_b64_tr_b16 v[152:153], v218 offset:0
v_mfma_f32_16x16x32_bf16 a[244:247], v[156:159], v[180:183], a[244:247]
ds_read_b64_tr_b16 v[154:155], v218 offset:1024
v_mfma_f32_16x16x32_bf16 a[248:251], v[156:159], v[184:187], a[248:251]
v_mfma_f32_16x16x32_bf16 a[252:255], v[156:159], v[188:191], a[252:255]
s_waitcnt lgkmcnt(13)
v_mfma_f32_16x16x32_bf16 v[0:3], v[128:131], v[160:163], v[0:3]
ds_read_b64_tr_b16 v[156:157], v218 offset:8
s_waitcnt lgkmcnt(11)
v_mfma_f32_16x16x32_bf16 v[4:7], v[128:131], v[164:167], v[4:7]
s_waitcnt vmcnt(12)
s_barrier
ds_read_b64_tr_b16 v[158:159], v218 offset:1032
s_waitcnt lgkmcnt(9)
v_mfma_f32_16x16x32_bf16 v[8:11], v[128:131], v[168:171], v[8:11]
s_sub_u32 s37, s35, s50
s_mov_b32 s50, s35
s_waitcnt lgkmcnt(6)
v_mfma_f32_16x16x32_bf16 v[12:15], v[128:131], v[172:175], v[12:15]
s_add_u32 s35, s35, 16384
s_add_u32 m0, s30, s29
v_mfma_f32_16x16x32_bf16 v[16:19], v[132:135], v[160:163], v[16:19]
ds_read_b64_tr_b16 v[128:129], v215 offset:8192
s_add_u32 s36, s31, 0
v_mfma_f32_16x16x32_bf16 v[20:23], v[132:135], v[164:167], v[20:23]
ds_read_b64_tr_b16 v[130:131], v215 offset:9216
v_mfma_f32_16x16x32_bf16 v[24:27], v[132:135], v[168:171], v[24:27]
s_cmp_eq_u32 s35, 163840
s_cselect_b32 s35, 0, s35
v_mfma_f32_16x16x32_bf16 v[28:31], v[132:135], v[172:175], v[28:31]
buffer_load_dwordx4 v223, s[8:11], s36 offen offset:0 lds
v_mfma_f32_16x16x32_bf16 v[32:35], v[136:139], v[160:163], v[32:35]
ds_read_b64_tr_b16 v[132:133], v215 offset:8200
s_add_u32 s36, s31, 31744
v_mfma_f32_16x16x32_bf16 v[36:39], v[136:139], v[164:167], v[36:39]
ds_read_b64_tr_b16 v[134:135], v215 offset:9224
v_mfma_f32_16x16x32_bf16 v[40:43], v[136:139], v[168:171], v[40:43]
buffer_load_dwordx4 v223, s[8:11], s36 offen offset:1024 lds
s_add_u32 s36, s31, 63488
v_mfma_f32_16x16x32_bf16 v[44:47], v[136:139], v[172:175], v[44:47]
v_mfma_f32_16x16x32_bf16 v[48:51], v[140:143], v[160:163], v[48:51]
ds_read_b64_tr_b16 v[136:137], v216 offset:8192
v_mfma_f32_16x16x32_bf16 v[52:55], v[140:143], v[164:167], v[52:55]
ds_read_b64_tr_b16 v[138:139], v216 offset:9216
v_mfma_f32_16x16x32_bf16 v[56:59], v[140:143], v[168:171], v[56:59]
v_mfma_f32_16x16x32_bf16 v[60:63], v[140:143], v[172:175], v[60:63]
v_mfma_f32_16x16x32_bf16 v[64:67], v[144:147], v[160:163], v[64:67]
ds_read_b64_tr_b16 v[140:141], v216 offset:8200
v_mfma_f32_16x16x32_bf16 v[68:71], v[144:147], v[164:167], v[68:71]
ds_read_b64_tr_b16 v[142:143], v216 offset:9224
v_mfma_f32_16x16x32_bf16 v[72:75], v[144:147], v[168:171], v[72:75]
buffer_load_dwordx4 v223, s[8:11], s36 offen offset:2048 lds
s_add_u32 s36, s31, 95232
v_mfma_f32_16x16x32_bf16 v[76:79], v[144:147], v[172:175], v[76:79]
s_waitcnt lgkmcnt(12)
v_mfma_f32_16x16x32_bf16 v[80:83], v[148:151], v[160:163], v[80:83]
ds_read_b64_tr_b16 v[144:145], v217 offset:8192
v_mfma_f32_16x16x32_bf16 v[84:87], v[148:151], v[164:167], v[84:87]
ds_read_b64_tr_b16 v[146:147], v217 offset:9216
v_mfma_f32_16x16x32_bf16 v[88:91], v[148:151], v[168:171], v[88:91]
v_mfma_f32_16x16x32_bf16 v[92:95], v[148:151], v[172:175], v[92:95]
s_waitcnt lgkmcnt(12)
v_mfma_f32_16x16x32_bf16 v[96:99], v[152:155], v[160:163], v[96:99]
ds_read_b64_tr_b16 v[148:149], v217 offset:8200
v_mfma_f32_16x16x32_bf16 v[100:103], v[152:155], v[164:167], v[100:103]
ds_read_b64_tr_b16 v[150:151], v217 offset:9224
v_mfma_f32_16x16x32_bf16 v[104:107], v[152:155], v[168:171], v[104:107]
buffer_load_dwordx4 v223, s[8:11], s36 offen offset:3072 lds
s_add_u32 s31, s31, 262144
v_mfma_f32_16x16x32_bf16 v[108:111], v[152:155], v[172:175], v[108:111]
s_add_u32 s30, s30, 16384
s_waitcnt lgkmcnt(12)
v_mfma_f32_16x16x32_bf16 v[112:115], v[156:159], v[160:163], v[112:115]
ds_read_b64_tr_b16 v[152:153], v218 offset:8192
v_mfma_f32_16x16x32_bf16 v[116:119], v[156:159], v[164:167], v[116:119]
ds_read_b64_tr_b16 v[154:155], v218 offset:9216
v_mfma_f32_16x16x32_bf16 v[120:123], v[156:159], v[168:171], v[120:123]
s_cmp_eq_u32 s30, 163840
s_cselect_b32 s30, 0, s30
s_add_u32 m0, s30, s29
v_mfma_f32_16x16x32_bf16 v[124:127], v[156:159], v[172:175], v[124:127]
s_add_u32 s36, s43, 0
s_waitcnt lgkmcnt(12)
v_mfma_f32_16x16x32_bf16 a[128:131], v[128:131], v[160:163], a[128:131]
ds_read_b64_tr_b16 v[156:157], v218 offset:8200
v_mfma_f32_16x16x32_bf16 a[132:135], v[128:131], v[164:167], a[132:135]
ds_read_b64_tr_b16 v[158:159], v218 offset:9224
v_mfma_f32_16x16x32_bf16 a[136:139], v[128:131], v[168:171], a[136:139]
v_add_u32 v215, s37, v215
v_add_u32 v216, s37, v216
v_mfma_f32_16x16x32_bf16 a[140:143], v[128:131], v[172:175], a[140:143]
v_add_u32 v217, s37, v217
v_add_u32 v218, s37, v218
s_waitcnt lgkmcnt(12)
v_mfma_f32_16x16x32_bf16 a[144:147], v[132:135], v[160:163], a[144:147]
ds_read_b64_tr_b16 v[128:129], v215 offset:0
v_mfma_f32_16x16x32_bf16 a[148:151], v[132:135], v[164:167], a[148:151]
ds_read_b64_tr_b16 v[130:131], v215 offset:1024
v_mfma_f32_16x16x32_bf16 a[152:155], v[132:135], v[168:171], a[152:155]
buffer_load_dwordx4 v250, s[24:27], s36 offen offset:0 lds
s_add_u32 s36, s43, 1024
v_mfma_f32_16x16x32_bf16 a[156:159], v[132:135], v[172:175], a[156:159]
buffer_load_dwordx4 v250, s[24:27], s36 offen offset:1024 lds
s_waitcnt lgkmcnt(12)
v_mfma_f32_16x16x32_bf16 a[160:163], v[136:139], v[160:163], a[160:163]
ds_read_b64_tr_b16 v[132:133], v215 offset:8
s_add_u32 s36, s43, 2048
v_mfma_f32_16x16x32_bf16 a[164:167], v[136:139], v[164:167], a[164:167]
ds_read_b64_tr_b16 v[134:135], v215 offset:1032
v_mfma_f32_16x16x32_bf16 a[168:171], v[136:139], v[168:171], a[168:171]
ds_read_b128 v[176:179], v220 offset:0
v_mfma_f32_16x16x32_bf16 a[172:175], v[136:139], v[172:175], a[172:175]
s_waitcnt lgkmcnt(13)
v_mfma_f32_16x16x32_bf16 a[176:179], v[140:143], v[160:163], a[176:179]
ds_read_b64_tr_b16 v[136:137], v216 offset:0
v_mfma_f32_16x16x32_bf16 a[180:183], v[140:143], v[164:167], a[180:183]
ds_read_b64_tr_b16 v[138:139], v216 offset:1024
v_mfma_f32_16x16x32_bf16 a[184:187], v[140:143], v[168:171], a[184:187]
ds_read_b128 v[180:183], v220 offset:2048
v_mfma_f32_16x16x32_bf16 a[188:191], v[140:143], v[172:175], a[188:191]
buffer_load_dwordx4 v250, s[24:27], s36 offen offset:2048 lds
s_waitcnt lgkmcnt(14)
v_mfma_f32_16x16x32_bf16 a[192:195], v[144:147], v[160:163], a[192:195]
ds_read_b64_tr_b16 v[140:141], v216 offset:8
s_add_u32 s36, s43, 3072
v_mfma_f32_16x16x32_bf16 a[196:199], v[144:147], v[164:167], a[196:199]
ds_read_b64_tr_b16 v[142:143], v216 offset:1032
v_mfma_f32_16x16x32_bf16 a[200:203], v[144:147], v[168:171], a[200:203]
ds_read_b128 v[184:187], v222 offset:0
v_mfma_f32_16x16x32_bf16 a[204:207], v[144:147], v[172:175], a[204:207]
s_waitcnt lgkmcnt(15)
v_mfma_f32_16x16x32_bf16 a[208:211], v[148:151], v[160:163], a[208:211]
ds_read_b64_tr_b16 v[144:145], v217 offset:0
v_mfma_f32_16x16x32_bf16 a[212:215], v[148:151], v[164:167], a[212:215]
ds_read_b64_tr_b16 v[146:147], v217 offset:1024
v_mfma_f32_16x16x32_bf16 a[216:219], v[148:151], v[168:171], a[216:219]
ds_read_b128 v[188:191], v222 offset:2048
v_mfma_f32_16x16x32_bf16 a[220:223], v[148:151], v[172:175], a[220:223]
buffer_load_dwordx4 v250, s[24:27], s36 offen offset:3072 lds
s_waitcnt lgkmcnt(15)
v_mfma_f32_16x16x32_bf16 a[224:227], v[152:155], v[160:163], a[224:227]
ds_read_b64_tr_b16 v[148:149], v217 offset:8
s_add_u32 s30, s30, 16384
v_mfma_f32_16x16x32_bf16 a[228:231], v[152:155], v[164:167], a[228:231]
ds_read_b64_tr_b16 v[150:151], v217 offset:1032
v_mfma_f32_16x16x32_bf16 a[232:235], v[152:155], v[168:171], a[232:235]
s_cmp_eq_u32 s30, 163840
s_cselect_b32 s30, 0, s30
v_mfma_f32_16x16x32_bf16 a[236:239], v[152:155], v[172:175], a[236:239]
s_waitcnt lgkmcnt(15)
v_mfma_f32_16x16x32_bf16 a[240:243], v[156:159], v[160:163], a[240:243]
ds_read_b64_tr_b16 v[152:153], v218 offset:0
v_mfma_f32_16x16x32_bf16 a[244:247], v[156:159], v[164:167], a[244:247]
ds_read_b64_tr_b16 v[154:155], v218 offset:1024
v_mfma_f32_16x16x32_bf16 a[248:251], v[156:159], v[168:171], a[248:251]
v_mfma_f32_16x16x32_bf16 a[252:255], v[156:159], v[172:175], a[252:255]
s_waitcnt lgkmcnt(13)
v_mfma_f32_16x16x32_bf16 v[0:3], v[128:131], v[176:179], v[0:3]
ds_read_b64_tr_b16 v[156:157], v218 offset:8
s_waitcnt lgkmcnt(11)
v_mfma_f32_16x16x32_bf16 v[4:7], v[128:131], v[180:183], v[4:7]
s_waitcnt vmcnt(8)
s_barrier
ds_read_b64_tr_b16 v[158:159], v218 offset:1032
s_waitcnt lgkmcnt(9)
v_mfma_f32_16x16x32_bf16 v[8:11], v[128:131], v[184:187], v[8:11]
s_sub_u32 s37, s35, s50
s_mov_b32 s50, s35
s_waitcnt lgkmcnt(6)
v_mfma_f32_16x16x32_bf16 v[12:15], v[128:131], v[188:191], v[12:15]
s_add_u32 s35, s35, 16384
s_add_u32 m0, s30, s29
v_mfma_f32_16x16x32_bf16 v[16:19], v[132:135], v[176:179], v[16:19]
ds_read_b64_tr_b16 v[128:129], v215 offset:8192
v_mfma_f32_16x16x32_bf16 v[20:23], v[132:135], v[180:183], v[20:23]
ds_read_b64_tr_b16 v[130:131], v215 offset:9216
v_mfma_f32_16x16x32_bf16 v[24:27], v[132:135], v[184:187], v[24:27]
s_cmp_eq_u32 s35, 163840
s_cselect_b32 s35, 0, s35
s_sub_u32 s38, s35, s51
v_mfma_f32_16x16x32_bf16 v[28:31], v[132:135], v[188:191], v[28:31]
s_mov_b32 s51, s35
s_add_u32 s35, s35, 16384
v_mfma_f32_16x16x32_bf16 v[32:35], v[136:139], v[176:179], v[32:35]
ds_read_b64_tr_b16 v[132:133], v215 offset:8200
v_mfma_f32_16x16x32_bf16 v[36:39], v[136:139], v[180:183], v[36:39]
ds_read_b64_tr_b16 v[134:135], v215 offset:9224
v_mfma_f32_16x16x32_bf16 v[40:43], v[136:139], v[184:187], v[40:43]
s_cmp_eq_u32 s35, 163840
s_cselect_b32 s35, 0, s35
s_sub_u32 s39, s35, s52
v_mfma_f32_16x16x32_bf16 v[44:47], v[136:139], v[188:191], v[44:47]
s_mov_b32 s52, s35
s_add_u32 s35, s35, 16384
v_mfma_f32_16x16x32_bf16 v[48:51], v[140:143], v[176:179], v[48:51]
ds_read_b64_tr_b16 v[136:137], v216 offset:8192
v_mfma_f32_16x16x32_bf16 v[52:55], v[140:143], v[180:183], v[52:55]
ds_read_b64_tr_b16 v[138:139], v216 offset:9216
v_mfma_f32_16x16x32_bf16 v[56:59], v[140:143], v[184:187], v[56:59]
s_cmp_eq_u32 s35, 163840
s_cselect_b32 s35, 0, s35
v_mfma_f32_16x16x32_bf16 v[60:63], v[140:143], v[188:191], v[60:63]
buffer_load_dwordx4 v204, s[12:15], s33 offen offset:0 nt lds
v_mfma_f32_16x16x32_bf16 v[64:67], v[144:147], v[176:179], v[64:67]
ds_read_b64_tr_b16 v[140:141], v216 offset:8200
v_mfma_f32_16x16x32_bf16 v[68:71], v[144:147], v[180:183], v[68:71]
ds_read_b64_tr_b16 v[142:143], v216 offset:9224
v_mfma_f32_16x16x32_bf16 v[72:75], v[144:147], v[184:187], v[72:75]
buffer_load_dwordx4 v205, s[12:15], s33 offen offset:1024 nt lds
v_mfma_f32_16x16x32_bf16 v[76:79], v[144:147], v[188:191], v[76:79]
s_waitcnt lgkmcnt(12)
v_mfma_f32_16x16x32_bf16 v[80:83], v[148:151], v[176:179], v[80:83]
ds_read_b64_tr_b16 v[144:145], v217 offset:8192
v_mfma_f32_16x16x32_bf16 v[84:87], v[148:151], v[180:183], v[84:87]
ds_read_b64_tr_b16 v[146:147], v217 offset:9216
v_mfma_f32_16x16x32_bf16 v[88:91], v[148:151], v[184:187], v[88:91]
v_mfma_f32_16x16x32_bf16 v[92:95], v[148:151], v[188:191], v[92:95]
s_waitcnt lgkmcnt(12)
v_mfma_f32_16x16x32_bf16 v[96:99], v[152:155], v[176:179], v[96:99]
ds_read_b64_tr_b16 v[148:149], v217 offset:8200
v_mfma_f32_16x16x32_bf16 v[100:103], v[152:155], v[180:183], v[100:103]
ds_read_b64_tr_b16 v[150:151], v217 offset:9224
v_mfma_f32_16x16x32_bf16 v[104:107], v[152:155], v[184:187], v[104:107]
v_mfma_f32_16x16x32_bf16 v[108:111], v[152:155], v[188:191], v[108:111]
s_waitcnt lgkmcnt(12)
v_mfma_f32_16x16x32_bf16 v[112:115], v[156:159], v[176:179], v[112:115]
ds_read_b64_tr_b16 v[152:153], v218 offset:8192
v_mfma_f32_16x16x32_bf16 v[116:119], v[156:159], v[180:183], v[116:119]
ds_read_b64_tr_b16 v[154:155], v218 offset:9216
v_mfma_f32_16x16x32_bf16 v[120:123], v[156:159], v[184:187], v[120:123]
v_mfma_f32_16x16x32_bf16 v[124:127], v[156:159], v[188:191], v[124:127]
s_waitcnt lgkmcnt(12)
v_mfma_f32_16x16x32_bf16 a[128:131], v[128:131], v[176:179], a[128:131]
ds_read_b64_tr_b16 v[156:157], v218 offset:8200
v_mfma_f32_16x16x32_bf16 a[132:135], v[128:131], v[180:183], a[132:135]
ds_read_b64_tr_b16 v[158:159], v218 offset:9224
v_mfma_f32_16x16x32_bf16 a[136:139], v[128:131], v[184:187], a[136:139]
v_add_u32 v215, s37, v215
v_add_u32 v216, s37, v216
v_mfma_f32_16x16x32_bf16 a[140:143], v[128:131], v[188:191], a[140:143]
v_add_u32 v217, s37, v217
v_add_u32 v218, s37, v218
s_waitcnt lgkmcnt(12)
v_mfma_f32_16x16x32_bf16 a[144:147], v[132:135], v[176:179], a[144:147]
ds_read_b64_tr_b16 v[128:129], v215 offset:0
v_mfma_f32_16x16x32_bf16 a[148:151], v[132:135], v[180:183], a[148:151]
ds_read_b64_tr_b16 v[130:131], v215 offset:1024
v_mfma_f32_16x16x32_bf16 a[152:155], v[132:135], v[184:187], a[152:155]
v_add_u32 v219, s38, v219
v_add_u32 v220, s38, v220
v_mfma_f32_16x16x32_bf16 a[156:159], v[132:135], v[188:191], a[156:159]
v_add_u32 v221, s39, v221
v_add_u32 v222, s39, v222
s_waitcnt lgkmcnt(12)
v_mfma_f32_16x16x32_bf16 a[160:163], v[136:139], v[176:179], a[160:163]
ds_read_b64_tr_b16 v[132:133], v215 offset:8
v_mfma_f32_16x16x32_bf16 a[164:167], v[136:139], v[180:183], a[164:167]
ds_read_b64_tr_b16 v[134:135], v215 offset:1032
v_mfma_f32_16x16x32_bf16 a[168:171], v[136:139], v[184:187], a[168:171]
ds_read_b128 v[160:163], v219 offset:0
v_mfma_f32_16x16x32_bf16 a[172:175], v[136:139], v[188:191], a[172:175]
buffer_load_dwordx4 v206, s[12:15], s33 offen offset:2048 nt lds
s_waitcnt lgkmcnt(13)
v_mfma_f32_16x16x32_bf16 a[176:179], v[140:143], v[176:179], a[176:179]
ds_read_b64_tr_b16 v[136:137], v216 offset:0
v_mfma_f32_16x16x32_bf16 a[180:183], v[140:143], v[180:183], a[180:183]
ds_read_b64_tr_b16 v[138:139], v216 offset:1024
v_mfma_f32_16x16x32_bf16 a[184:187], v[140:143], v[184:187], a[184:187]
ds_read_b128 v[164:167], v219 offset:2048
v_mfma_f32_16x16x32_bf16 a[188:191], v[140:143], v[188:191], a[188:191]
buffer_load_dwordx4 v207, s[12:15], s33 offen offset:3072 nt lds
s_waitcnt lgkmcnt(14)
v_mfma_f32_16x16x32_bf16 a[192:195], v[144:147], v[176:179], a[192:195]
ds_read_b64_tr_b16 v[140:141], v216 offset:8
s_add_u32 s33, s33, 16384
v_mfma_f32_16x16x32_bf16 a[196:199], v[144:147], v[180:183], a[196:199]
ds_read_b64_tr_b16 v[142:143], v216 offset:1032
s_add_u32 s30, s30, 16384
v_mfma_f32_16x16x32_bf16 a[200:203], v[144:147], v[184:187], a[200:203]
ds_read_b128 v[168:171], v221 offset:0
v_mfma_f32_16x16x32_bf16 a[204:207], v[144:147], v[188:191], a[204:207]
s_cmp_eq_u32 s30, 163840
s_cselect_b32 s30, 0, s30
s_waitcnt lgkmcnt(15)
v_mfma_f32_16x16x32_bf16 a[208:211], v[148:151], v[176:179], a[208:211]
ds_read_b64_tr_b16 v[144:145], v217 offset:0
v_mfma_f32_16x16x32_bf16 a[212:215], v[148:151], v[180:183], a[212:215]
ds_read_b64_tr_b16 v[146:147], v217 offset:1024
v_mfma_f32_16x16x32_bf16 a[216:219], v[148:151], v[184:187], a[216:219]
ds_read_b128 v[172:175], v221 offset:2048
v_mfma_f32_16x16x32_bf16 a[220:223], v[148:151], v[188:191], a[220:223]
s_waitcnt lgkmcnt(15)
v_mfma_f32_16x16x32_bf16 a[224:227], v[152:155], v[176:179], a[224:227]
ds_read_b64_tr_b16 v[148:149], v217 offset:8
v_mfma_f32_16x16x32_bf16 a[228:231], v[152:155], v[180:183], a[228:231]
ds_read_b64_tr_b16 v[150:151], v217 offset:1032
v_mfma_f32_16x16x32_bf16 a[232:235], v[152:155], v[184:187], a[232:235]
v_mfma_f32_16x16x32_bf16 a[236:239], v[152:155], v[188:191], a[236:239]
s_waitcnt lgkmcnt(15)
v_mfma_f32_16x16x32_bf16 a[240:243], v[156:159], v[176:179], a[240:243]
ds_read_b64_tr_b16 v[152:153], v218 offset:0
v_mfma_f32_16x16x32_bf16 a[244:247], v[156:159], v[180:183], a[244:247]
ds_read_b64_tr_b16 v[154:155], v218 offset:1024
v_mfma_f32_16x16x32_bf16 a[248:251], v[156:159], v[184:187], a[248:251]
v_mfma_f32_16x16x32_bf16 a[252:255], v[156:159], v[188:191], a[252:255]
s_waitcnt lgkmcnt(13)
v_mfma_f32_16x16x32_bf16 v[0:3], v[128:131], v[160:163], v[0:3]
ds_read_b64_tr_b16 v[156:157], v218 offset:8
s_waitcnt lgkmcnt(11)
v_mfma_f32_16x16x32_bf16 v[4:7], v[128:131], v[164:167], v[4:7]
s_waitcnt vmcnt(8)
s_barrier
ds_read_b64_tr_b16 v[158:159], v218 offset:1032
s_waitcnt lgkmcnt(9)
v_mfma_f32_16x16x32_bf16 v[8:11], v[128:131], v[168:171], v[8:11]
s_sub_u32 s37, s35, s50
s_mov_b32 s50, s35
s_waitcnt lgkmcnt(6)
v_mfma_f32_16x16x32_bf16 v[12:15], v[128:131], v[172:175], v[12:15]
s_add_u32 s35, s35, 16384
s_add_u32 m0, s30, s29
v_mfma_f32_16x16x32_bf16 v[16:19], v[132:135], v[160:163], v[16:19]
ds_read_b64_tr_b16 v[128:129], v215 offset:8192
v_mfma_f32_16x16x32_bf16 v[20:23], v[132:135], v[164:167], v[20:23]
ds_read_b64_tr_b16 v[130:131], v215 offset:9216
v_mfma_f32_16x16x32_bf16 v[24:27], v[132:135], v[168:171], v[24:27]
s_cmp_eq_u32 s35, 163840
s_cselect_b32 s35, 0, s35
v_mfma_f32_16x16x32_bf16 v[28:31], v[132:135], v[172:175], v[28:31]
buffer_load_dwordx4 v208, s[16:19], s34 offen offset:0 nt lds
v_mfma_f32_16x16x32_bf16 v[32:35], v[136:139], v[160:163], v[32:35]
ds_read_b64_tr_b16 v[132:133], v215 offset:8200
v_mfma_f32_16x16x32_bf16 v[36:39], v[136:139], v[164:167], v[36:39]
ds_read_b64_tr_b16 v[134:135], v215 offset:9224
v_mfma_f32_16x16x32_bf16 v[40:43], v[136:139], v[168:171], v[40:43]
v_mfma_f32_16x16x32_bf16 v[44:47], v[136:139], v[172:175], v[44:47]
v_mfma_f32_16x16x32_bf16 v[48:51], v[140:143], v[160:163], v[48:51]
ds_read_b64_tr_b16 v[136:137], v216 offset:8192
v_mfma_f32_16x16x32_bf16 v[52:55], v[140:143], v[164:167], v[52:55]
ds_read_b64_tr_b16 v[138:139], v216 offset:9216
v_mfma_f32_16x16x32_bf16 v[56:59], v[140:143], v[168:171], v[56:59]
v_mfma_f32_16x16x32_bf16 v[60:63], v[140:143], v[172:175], v[60:63]
v_mfma_f32_16x16x32_bf16 v[64:67], v[144:147], v[160:163], v[64:67]
ds_read_b64_tr_b16 v[140:141], v216 offset:8200
v_mfma_f32_16x16x32_bf16 v[68:71], v[144:147], v[164:167], v[68:71]
ds_read_b64_tr_b16 v[142:143], v216 offset:9224
v_mfma_f32_16x16x32_bf16 v[72:75], v[144:147], v[168:171], v[72:75]
buffer_load_dwordx4 v209, s[16:19], s34 offen offset:1024 nt lds
v_mfma_f32_16x16x32_bf16 v[76:79], v[144:147], v[172:175], v[76:79]
s_waitcnt lgkmcnt(12)
v_mfma_f32_16x16x32_bf16 v[80:83], v[148:151], v[160:163], v[80:83]
ds_read_b64_tr_b16 v[144:145], v217 offset:8192
v_mfma_f32_16x16x32_bf16 v[84:87], v[148:151], v[164:167], v[84:87]
ds_read_b64_tr_b16 v[146:147], v217 offset:9216
v_mfma_f32_16x16x32_bf16 v[88:91], v[148:151], v[168:171], v[88:91]
v_mfma_f32_16x16x32_bf16 v[92:95], v[148:151], v[172:175], v[92:95]
s_waitcnt lgkmcnt(12)
v_mfma_f32_16x16x32_bf16 v[96:99], v[152:155], v[160:163], v[96:99]
ds_read_b64_tr_b16 v[148:149], v217 offset:8200
v_mfma_f32_16x16x32_bf16 v[100:103], v[152:155], v[164:167], v[100:103]
ds_read_b64_tr_b16 v[150:151], v217 offset:9224
v_mfma_f32_16x16x32_bf16 v[104:107], v[152:155], v[168:171], v[104:107]
v_mfma_f32_16x16x32_bf16 v[108:111], v[152:155], v[172:175], v[108:111]
s_waitcnt lgkmcnt(12)
v_mfma_f32_16x16x32_bf16 v[112:115], v[156:159], v[160:163], v[112:115]
ds_read_b64_tr_b16 v[152:153], v218 offset:8192
v_mfma_f32_16x16x32_bf16 v[116:119], v[156:159], v[164:167], v[116:119]
ds_read_b64_tr_b16 v[154:155], v218 offset:9216
v_mfma_f32_16x16x32_bf16 v[120:123], v[156:159], v[168:171], v[120:123]
v_mfma_f32_16x16x32_bf16 v[124:127], v[156:159], v[172:175], v[124:127]
s_waitcnt lgkmcnt(12)
v_mfma_f32_16x16x32_bf16 a[128:131], v[128:131], v[160:163], a[128:131]
ds_read_b64_tr_b16 v[156:157], v218 offset:8200
v_mfma_f32_16x16x32_bf16 a[132:135], v[128:131], v[164:167], a[132:135]
ds_read_b64_tr_b16 v[158:159], v218 offset:9224
v_mfma_f32_16x16x32_bf16 a[136:139], v[128:131], v[168:171], a[136:139]
v_add_u32 v215, s37, v215
v_add_u32 v216, s37, v216
v_mfma_f32_16x16x32_bf16 a[140:143], v[128:131], v[172:175], a[140:143]
v_add_u32 v217, s37, v217
v_add_u32 v218, s37, v218
s_waitcnt lgkmcnt(12)
v_mfma_f32_16x16x32_bf16 a[144:147], v[132:135], v[160:163], a[144:147]
ds_read_b64_tr_b16 v[128:129], v215 offset:0
v_mfma_f32_16x16x32_bf16 a[148:151], v[132:135], v[164:167], a[148:151]
ds_read_b64_tr_b16 v[130:131], v215 offset:1024
v_mfma_f32_16x16x32_bf16 a[152:155], v[132:135], v[168:171], a[152:155]
buffer_load_dwordx4 v208, s[16:19], s34 offen offset:2048 nt lds
v_mfma_f32_16x16x32_bf16 a[156:159], v[132:135], v[172:175], a[156:159]
s_waitcnt lgkmcnt(12)
v_mfma_f32_16x16x32_bf16 a[160:163], v[136:139], v[160:163], a[160:163]
ds_read_b64_tr_b16 v[132:133], v215 offset:8
v_mfma_f32_16x16x32_bf16 a[164:167], v[136:139], v[164:167], a[164:167]
ds_read_b64_tr_b16 v[134:135], v215 offset:1032
v_mfma_f32_16x16x32_bf16 a[168:171], v[136:139], v[168:171], a[168:171]
ds_read_b128 v[176:179], v220 offset:0
v_mfma_f32_16x16x32_bf16 a[172:175], v[136:139], v[172:175], a[172:175]
s_waitcnt lgkmcnt(13)
v_mfma_f32_16x16x32_bf16 a[176:179], v[140:143], v[160:163], a[176:179]
ds_read_b64_tr_b16 v[136:137], v216 offset:0
v_mfma_f32_16x16x32_bf16 a[180:183], v[140:143], v[164:167], a[180:183]
ds_read_b64_tr_b16 v[138:139], v216 offset:1024
v_mfma_f32_16x16x32_bf16 a[184:187], v[140:143], v[168:171], a[184:187]
ds_read_b128 v[180:183], v220 offset:2048
v_mfma_f32_16x16x32_bf16 a[188:191], v[140:143], v[172:175], a[188:191]
buffer_load_dwordx4 v209, s[16:19], s34 offen offset:3072 nt lds
s_waitcnt lgkmcnt(14)
v_mfma_f32_16x16x32_bf16 a[192:195], v[144:147], v[160:163], a[192:195]
ds_read_b64_tr_b16 v[140:141], v216 offset:8
s_add_u32 s34, s34, 16384
v_mfma_f32_16x16x32_bf16 a[196:199], v[144:147], v[164:167], a[196:199]
ds_read_b64_tr_b16 v[142:143], v216 offset:1032
s_add_u32 s30, s30, 16384
v_mfma_f32_16x16x32_bf16 a[200:203], v[144:147], v[168:171], a[200:203]
ds_read_b128 v[184:187], v222 offset:0
v_mfma_f32_16x16x32_bf16 a[204:207], v[144:147], v[172:175], a[204:207]
s_cmp_eq_u32 s30, 163840
s_cselect_b32 s30, 0, s30
s_waitcnt lgkmcnt(15)
v_mfma_f32_16x16x32_bf16 a[208:211], v[148:151], v[160:163], a[208:211]
ds_read_b64_tr_b16 v[144:145], v217 offset:0
v_mfma_f32_16x16x32_bf16 a[212:215], v[148:151], v[164:167], a[212:215]
ds_read_b64_tr_b16 v[146:147], v217 offset:1024
v_mfma_f32_16x16x32_bf16 a[216:219], v[148:151], v[168:171], a[216:219]
ds_read_b128 v[188:191], v222 offset:2048
v_mfma_f32_16x16x32_bf16 a[220:223], v[148:151], v[172:175], a[220:223]
s_waitcnt lgkmcnt(15)
v_mfma_f32_16x16x32_bf16 a[224:227], v[152:155], v[160:163], a[224:227]
ds_read_b64_tr_b16 v[148:149], v217 offset:8
v_mfma_f32_16x16x32_bf16 a[228:231], v[152:155], v[164:167], a[228:231]
ds_read_b64_tr_b16 v[150:151], v217 offset:1032
v_mfma_f32_16x16x32_bf16 a[232:235], v[152:155], v[168:171], a[232:235]
v_mfma_f32_16x16x32_bf16 a[236:239], v[152:155], v[172:175], a[236:239]
s_waitcnt lgkmcnt(15)
v_mfma_f32_16x16x32_bf16 a[240:243], v[156:159], v[160:163], a[240:243]
ds_read_b64_tr_b16 v[152:153], v218 offset:0
v_mfma_f32_16x16x32_bf16 a[244:247], v[156:159], v[164:167], a[244:247]
ds_read_b64_tr_b16 v[154:155], v218 offset:1024
v_mfma_f32_16x16x32_bf16 a[248:251], v[156:159], v[168:171], a[248:251]
v_mfma_f32_16x16x32_bf16 a[252:255], v[156:159], v[172:175], a[252:255]
s_waitcnt lgkmcnt(13)
v_mfma_f32_16x16x32_bf16 v[0:3], v[128:131], v[176:179], v[0:3]
ds_read_b64_tr_b16 v[156:157], v218 offset:8
s_waitcnt lgkmcnt(11)
v_mfma_f32_16x16x32_bf16 v[4:7], v[128:131], v[180:183], v[4:7]
s_barrier
ds_read_b64_tr_b16 v[158:159], v218 offset:1032
s_waitcnt lgkmcnt(9)
v_mfma_f32_16x16x32_bf16 v[8:11], v[128:131], v[184:187], v[8:11]
s_add_u32 m0, s30, s29
s_waitcnt lgkmcnt(6)
v_mfma_f32_16x16x32_bf16 v[12:15], v[128:131], v[188:191], v[12:15]
buffer_load_dwordx4 v204, s[12:15], s33 offen offset:0 nt lds
v_mfma_f32_16x16x32_bf16 v[16:19], v[132:135], v[176:179], v[16:19]
ds_read_b64_tr_b16 v[128:129], v215 offset:8192
v_mfma_f32_16x16x32_bf16 v[20:23], v[132:135], v[180:183], v[20:23]
ds_read_b64_tr_b16 v[130:131], v215 offset:9216
v_mfma_f32_16x16x32_bf16 v[24:27], v[132:135], v[184:187], v[24:27]
v_mfma_f32_16x16x32_bf16 v[28:31], v[132:135], v[188:191], v[28:31]
v_mfma_f32_16x16x32_bf16 v[32:35], v[136:139], v[176:179], v[32:35]
ds_read_b64_tr_b16 v[132:133], v215 offset:8200
v_mfma_f32_16x16x32_bf16 v[36:39], v[136:139], v[180:183], v[36:39]
ds_read_b64_tr_b16 v[134:135], v215 offset:9224
v_mfma_f32_16x16x32_bf16 v[40:43], v[136:139], v[184:187], v[40:43]
v_mfma_f32_16x16x32_bf16 v[44:47], v[136:139], v[188:191], v[44:47]
v_mfma_f32_16x16x32_bf16 v[48:51], v[140:143], v[176:179], v[48:51]
ds_read_b64_tr_b16 v[136:137], v216 offset:8192
v_mfma_f32_16x16x32_bf16 v[52:55], v[140:143], v[180:183], v[52:55]
ds_read_b64_tr_b16 v[138:139], v216 offset:9216
v_mfma_f32_16x16x32_bf16 v[56:59], v[140:143], v[184:187], v[56:59]
v_mfma_f32_16x16x32_bf16 v[60:63], v[140:143], v[188:191], v[60:63]
v_mfma_f32_16x16x32_bf16 v[64:67], v[144:147], v[176:179], v[64:67]
ds_read_b64_tr_b16 v[140:141], v216 offset:8200
v_mfma_f32_16x16x32_bf16 v[68:71], v[144:147], v[180:183], v[68:71]
ds_read_b64_tr_b16 v[142:143], v216 offset:9224
v_mfma_f32_16x16x32_bf16 v[72:75], v[144:147], v[184:187], v[72:75]
buffer_load_dwordx4 v205, s[12:15], s33 offen offset:1024 nt lds
v_mfma_f32_16x16x32_bf16 v[76:79], v[144:147], v[188:191], v[76:79]
s_waitcnt lgkmcnt(12)
v_mfma_f32_16x16x32_bf16 v[80:83], v[148:151], v[176:179], v[80:83]
ds_read_b64_tr_b16 v[144:145], v217 offset:8192
v_mfma_f32_16x16x32_bf16 v[84:87], v[148:151], v[180:183], v[84:87]
ds_read_b64_tr_b16 v[146:147], v217 offset:9216
v_mfma_f32_16x16x32_bf16 v[88:91], v[148:151], v[184:187], v[88:91]
v_mfma_f32_16x16x32_bf16 v[92:95], v[148:151], v[188:191], v[92:95]
s_waitcnt lgkmcnt(12)
v_mfma_f32_16x16x32_bf16 v[96:99], v[152:155], v[176:179], v[96:99]
ds_read_b64_tr_b16 v[148:149], v217 offset:8200
v_mfma_f32_16x16x32_bf16 v[100:103], v[152:155], v[180:183], v[100:103]
ds_read_b64_tr_b16 v[150:151], v217 offset:9224
v_mfma_f32_16x16x32_bf16 v[104:107], v[152:155], v[184:187], v[104:107]
v_mfma_f32_16x16x32_bf16 v[108:111], v[152:155], v[188:191], v[108:111]
s_waitcnt lgkmcnt(12)
v_mfma_f32_16x16x32_bf16 v[112:115], v[156:159], v[176:179], v[112:115]
ds_read_b64_tr_b16 v[152:153], v218 offset:8192
v_mfma_f32_16x16x32_bf16 v[116:119], v[156:159], v[180:183], v[116:119]
ds_read_b64_tr_b16 v[154:155], v218 offset:9216
v_mfma_f32_16x16x32_bf16 v[120:123], v[156:159], v[184:187], v[120:123]
v_mfma_f32_16x16x32_bf16 v[124:127], v[156:159], v[188:191], v[124:127]
s_waitcnt lgkmcnt(12)
v_mfma_f32_16x16x32_bf16 a[128:131], v[128:131], v[176:179], a[128:131]
ds_read_b64_tr_b16 v[156:157], v218 offset:8200
v_mfma_f32_16x16x32_bf16 a[132:135], v[128:131], v[180:183], a[132:135]
ds_read_b64_tr_b16 v[158:159], v218 offset:9224
v_mfma_f32_16x16x32_bf16 a[136:139], v[128:131], v[184:187], a[136:139]
buffer_load_dwordx4 v206, s[12:15], s33 offen offset:2048 nt lds
v_mfma_f32_16x16x32_bf16 a[140:143], v[128:131], v[188:191], a[140:143]
s_waitcnt lgkmcnt(12)
v_mfma_f32_16x16x32_bf16 a[144:147], v[132:135], v[176:179], a[144:147]
v_mfma_f32_16x16x32_bf16 a[148:151], v[132:135], v[180:183], a[148:151]
v_mfma_f32_16x16x32_bf16 a[152:155], v[132:135], v[184:187], a[152:155]
v_mfma_f32_16x16x32_bf16 a[156:159], v[132:135], v[188:191], a[156:159]
s_waitcnt lgkmcnt(10)
v_mfma_f32_16x16x32_bf16 a[160:163], v[136:139], v[176:179], a[160:163]
v_mfma_f32_16x16x32_bf16 a[164:167], v[136:139], v[180:183], a[164:167]
v_mfma_f32_16x16x32_bf16 a[168:171], v[136:139], v[184:187], a[168:171]
v_mfma_f32_16x16x32_bf16 a[172:175], v[136:139], v[188:191], a[172:175]
s_waitcnt lgkmcnt(8)
v_mfma_f32_16x16x32_bf16 a[176:179], v[140:143], v[176:179], a[176:179]
v_mfma_f32_16x16x32_bf16 a[180:183], v[140:143], v[180:183], a[180:183]
v_mfma_f32_16x16x32_bf16 a[184:187], v[140:143], v[184:187], a[184:187]
v_mfma_f32_16x16x32_bf16 a[188:191], v[140:143], v[188:191], a[188:191]
buffer_load_dwordx4 v207, s[12:15], s33 offen offset:3072 nt lds
s_waitcnt lgkmcnt(6)
v_mfma_f32_16x16x32_bf16 a[192:195], v[144:147], v[176:179], a[192:195]
s_add_u32 s33, s33, 16384
s_add_u32 s30, s30, 16384
v_mfma_f32_16x16x32_bf16 a[196:199], v[144:147], v[180:183], a[196:199]
s_cmp_eq_u32 s30, 163840
s_cselect_b32 s30, 0, s30
v_mfma_f32_16x16x32_bf16 a[200:203], v[144:147], v[184:187], a[200:203]
v_mfma_f32_16x16x32_bf16 a[204:207], v[144:147], v[188:191], a[204:207]
s_waitcnt lgkmcnt(4)
v_mfma_f32_16x16x32_bf16 a[208:211], v[148:151], v[176:179], a[208:211]
v_mfma_f32_16x16x32_bf16 a[212:215], v[148:151], v[180:183], a[212:215]
v_mfma_f32_16x16x32_bf16 a[216:219], v[148:151], v[184:187], a[216:219]
v_mfma_f32_16x16x32_bf16 a[220:223], v[148:151], v[188:191], a[220:223]
s_waitcnt lgkmcnt(2)
v_mfma_f32_16x16x32_bf16 a[224:227], v[152:155], v[176:179], a[224:227]
v_mfma_f32_16x16x32_bf16 a[228:231], v[152:155], v[180:183], a[228:231]
v_mfma_f32_16x16x32_bf16 a[232:235], v[152:155], v[184:187], a[232:235]
v_mfma_f32_16x16x32_bf16 a[236:239], v[152:155], v[188:191], a[236:239]
s_waitcnt lgkmcnt(0)
v_mfma_f32_16x16x32_bf16 a[240:243], v[156:159], v[176:179], a[240:243]
v_mfma_f32_16x16x32_bf16 a[244:247], v[156:159], v[180:183], a[244:247]
v_mfma_f32_16x16x32_bf16 a[248:251], v[156:159], v[184:187], a[248:251]
v_mfma_f32_16x16x32_bf16 a[252:255], v[156:159], v[188:191], a[252:255]
s_waitcnt vmcnt(8)
s_barrier
v_add_u32 v251, s35, v251
s_add_u32 s35, s35, 16384
s_cmp_eq_u32 s35, 163840
s_cselect_b32 s35, 0, s35
ds_read_b64_tr_b16 v[128:129], v251 offset:0
ds_read_b64_tr_b16 v[130:131], v251 offset:8192
ds_read_b64_tr_b16 v[132:133], v251 offset:8
ds_read_b64_tr_b16 v[134:135], v251 offset:8200
ds_read_b64_tr_b16 v[136:137], v251 offset:64
ds_read_b64_tr_b16 v[138:139], v251 offset:8256
ds_read_b64_tr_b16 v[140:141], v251 offset:72
ds_read_b64_tr_b16 v[142:143], v251 offset:8264
s_sub_u32 s37, s35, s48
s_mov_b32 s48, s35
s_add_u32 s35, s35, 16384
s_cmp_eq_u32 s35, 163840
s_cselect_b32 s35, 0, s35
v_add_u32 v192, s37, v192
v_add_u32 v193, s37, v193
v_add_u32 v194, s37, v194
v_add_u32 v195, s37, v195
v_accvgpr_read_b32 v226, a128
v_accvgpr_read_b32 v227, a129
v_accvgpr_read_b32 v228, a130
v_accvgpr_read_b32 v229, a131
v_pk_mul_f32 v[226:227], v[226:227], s[58:59]
v_pk_mul_f32 v[228:229], v[228:229], s[58:59]
v_cvt_pk_bf16_f32 v234, v226, v227
v_cvt_pk_bf16_f32 v235, v228, v229
v_accvgpr_read_b32 v230, a144
v_accvgpr_read_b32 v231, a145
v_accvgpr_read_b32 v232, a146
v_accvgpr_read_b32 v233, a147
v_pk_mul_f32 v[230:231], v[230:231], s[58:59]
v_pk_mul_f32 v[232:233], v[232:233], s[58:59]
v_cvt_pk_bf16_f32 v236, v230, v231
v_cvt_pk_bf16_f32 v237, v232, v233
v_accvgpr_write_b32 a64, v234
v_accvgpr_write_b32 a65, v235
v_accvgpr_write_b32 a66, v236
v_accvgpr_write_b32 a67, v237
v_accvgpr_read_b32 v226, a132
v_accvgpr_read_b32 v227, a133
v_accvgpr_read_b32 v228, a134
v_accvgpr_read_b32 v229, a135
v_pk_mul_f32 v[226:227], v[226:227], s[58:59]
v_pk_mul_f32 v[228:229], v[228:229], s[58:59]
v_cvt_pk_bf16_f32 v234, v226, v227
v_cvt_pk_bf16_f32 v235, v228, v229
v_accvgpr_read_b32 v230, a148
v_accvgpr_read_b32 v231, a149
v_accvgpr_read_b32 v232, a150
v_accvgpr_read_b32 v233, a151
v_pk_mul_f32 v[230:231], v[230:231], s[58:59]
v_pk_mul_f32 v[232:233], v[232:233], s[58:59]
v_cvt_pk_bf16_f32 v236, v230, v231
v_cvt_pk_bf16_f32 v237, v232, v233
v_accvgpr_write_b32 a80, v234
v_accvgpr_write_b32 a81, v235
v_accvgpr_write_b32 a82, v236
v_accvgpr_write_b32 a83, v237
v_accvgpr_read_b32 v226, a136
v_accvgpr_read_b32 v227, a137
v_accvgpr_read_b32 v228, a138
v_accvgpr_read_b32 v229, a139
v_pk_mul_f32 v[226:227], v[226:227], s[58:59]
v_pk_mul_f32 v[228:229], v[228:229], s[58:59]
v_cvt_pk_bf16_f32 v234, v226, v227
v_cvt_pk_bf16_f32 v235, v228, v229
v_accvgpr_read_b32 v230, a152
v_accvgpr_read_b32 v231, a153
v_accvgpr_read_b32 v232, a154
v_accvgpr_read_b32 v233, a155
v_pk_mul_f32 v[230:231], v[230:231], s[58:59]
v_pk_mul_f32 v[232:233], v[232:233], s[58:59]
v_cvt_pk_bf16_f32 v236, v230, v231
v_cvt_pk_bf16_f32 v237, v232, v233
v_accvgpr_write_b32 a96, v234
v_accvgpr_write_b32 a97, v235
v_accvgpr_write_b32 a98, v236
v_accvgpr_write_b32 a99, v237
v_accvgpr_read_b32 v226, a140
v_accvgpr_read_b32 v227, a141
v_accvgpr_read_b32 v228, a142
v_accvgpr_read_b32 v229, a143
v_pk_mul_f32 v[226:227], v[226:227], s[58:59]
v_pk_mul_f32 v[228:229], v[228:229], s[58:59]
v_cvt_pk_bf16_f32 v234, v226, v227
v_cvt_pk_bf16_f32 v235, v228, v229
v_accvgpr_read_b32 v230, a156
v_accvgpr_read_b32 v231, a157
v_accvgpr_read_b32 v232, a158
v_accvgpr_read_b32 v233, a159
v_pk_mul_f32 v[230:231], v[230:231], s[58:59]
v_pk_mul_f32 v[232:233], v[232:233], s[58:59]
v_cvt_pk_bf16_f32 v236, v230, v231
v_cvt_pk_bf16_f32 v237, v232, v233
v_accvgpr_write_b32 a112, v234
v_accvgpr_write_b32 a113, v235
v_accvgpr_write_b32 a114, v236
v_accvgpr_write_b32 a115, v237
s_add_u32 m0, s30, s29
s_nop 0
buffer_load_dwordx4 v208, s[16:19], s34 offen offset:0 nt lds
ds_read_b128 a[128:131], v192 offset:0
ds_read_b128 a[132:135], v193 offset:0
ds_read_b128 a[136:139], v194 offset:0
ds_read_b128 a[140:143], v195 offset:0
ds_read_b128 a[144:147], v192 offset:4096
ds_read_b128 a[148:151], v193 offset:4096
ds_read_b128 a[152:155], v194 offset:4096
ds_read_b128 a[156:159], v195 offset:4096
s_waitcnt lgkmcnt(8)
s_add_u32 s37, s56, 0
buffer_store_dwordx4 v[128:131], v214, s[20:23], s37 offen sc1
s_add_u32 s37, s56, 131072
buffer_store_dwordx4 v[132:135], v214, s[20:23], s37 offen sc1
s_add_u32 s37, s56, 262144
buffer_store_dwordx4 v[136:139], v214, s[20:23], s37 offen sc1
s_add_u32 s37, s56, 393216
buffer_store_dwordx4 v[140:143], v214, s[20:23], s37 offen sc1
s_nop 1
v_accvgpr_read_b32 v226, a160
v_accvgpr_read_b32 v227, a161
v_accvgpr_read_b32 v228, a162
v_accvgpr_read_b32 v229, a163
v_pk_mul_f32 v[226:227], v[226:227], s[58:59]
v_pk_mul_f32 v[228:229], v[228:229], s[58:59]
v_cvt_pk_bf16_f32 v234, v226, v227
v_cvt_pk_bf16_f32 v235, v228, v229
v_accvgpr_read_b32 v230, a176
v_accvgpr_read_b32 v231, a177
v_accvgpr_read_b32 v232, a178
v_accvgpr_read_b32 v233, a179
v_pk_mul_f32 v[230:231], v[230:231], s[58:59]
v_pk_mul_f32 v[232:233], v[232:233], s[58:59]
v_cvt_pk_bf16_f32 v236, v230, v231
v_cvt_pk_bf16_f32 v237, v232, v233
v_accvgpr_write_b32 a68, v234
v_accvgpr_write_b32 a69, v235
v_accvgpr_write_b32 a70, v236
v_accvgpr_write_b32 a71, v237
v_accvgpr_read_b32 v226, a164
v_accvgpr_read_b32 v227, a165
v_accvgpr_read_b32 v228, a166
v_accvgpr_read_b32 v229, a167
v_pk_mul_f32 v[226:227], v[226:227], s[58:59]
v_pk_mul_f32 v[228:229], v[228:229], s[58:59]
v_cvt_pk_bf16_f32 v234, v226, v227
v_cvt_pk_bf16_f32 v235, v228, v229
v_accvgpr_read_b32 v230, a180
v_accvgpr_read_b32 v231, a181
v_accvgpr_read_b32 v232, a182
v_accvgpr_read_b32 v233, a183
v_pk_mul_f32 v[230:231], v[230:231], s[58:59]
v_pk_mul_f32 v[232:233], v[232:233], s[58:59]
v_cvt_pk_bf16_f32 v236, v230, v231
v_cvt_pk_bf16_f32 v237, v232, v233
v_accvgpr_write_b32 a84, v234
v_accvgpr_write_b32 a85, v235
v_accvgpr_write_b32 a86, v236
v_accvgpr_write_b32 a87, v237
v_accvgpr_read_b32 v226, a168
v_accvgpr_read_b32 v227, a169
v_accvgpr_read_b32 v228, a170
v_accvgpr_read_b32 v229, a171
v_pk_mul_f32 v[226:227], v[226:227], s[58:59]
v_pk_mul_f32 v[228:229], v[228:229], s[58:59]
v_cvt_pk_bf16_f32 v234, v226, v227
v_cvt_pk_bf16_f32 v235, v228, v229
v_accvgpr_read_b32 v230, a184
v_accvgpr_read_b32 v231, a185
v_accvgpr_read_b32 v232, a186
v_accvgpr_read_b32 v233, a187
v_pk_mul_f32 v[230:231], v[230:231], s[58:59]
v_pk_mul_f32 v[232:233], v[232:233], s[58:59]
v_cvt_pk_bf16_f32 v236, v230, v231
v_cvt_pk_bf16_f32 v237, v232, v233
v_accvgpr_write_b32 a100, v234
v_accvgpr_write_b32 a101, v235
v_accvgpr_write_b32 a102, v236
v_accvgpr_write_b32 a103, v237
v_accvgpr_read_b32 v226, a172
v_accvgpr_read_b32 v227, a173
v_accvgpr_read_b32 v228, a174
v_accvgpr_read_b32 v229, a175
v_pk_mul_f32 v[226:227], v[226:227], s[58:59]
v_pk_mul_f32 v[228:229], v[228:229], s[58:59]
v_cvt_pk_bf16_f32 v234, v226, v227
v_cvt_pk_bf16_f32 v235, v228, v229
v_accvgpr_read_b32 v230, a188
v_accvgpr_read_b32 v231, a189
v_accvgpr_read_b32 v232, a190
v_accvgpr_read_b32 v233, a191
v_pk_mul_f32 v[230:231], v[230:231], s[58:59]
v_pk_mul_f32 v[232:233], v[232:233], s[58:59]
v_cvt_pk_bf16_f32 v236, v230, v231
v_cvt_pk_bf16_f32 v237, v232, v233
v_accvgpr_write_b32 a116, v234
v_accvgpr_write_b32 a117, v235
v_accvgpr_write_b32 a118, v236
v_accvgpr_write_b32 a119, v237
buffer_load_dwordx4 v209, s[16:19], s34 offen offset:1024 nt lds
v_accvgpr_read_b32 v226, a192
v_accvgpr_read_b32 v227, a193
v_accvgpr_read_b32 v228, a194
v_accvgpr_read_b32 v229, a195
v_pk_mul_f32 v[226:227], v[226:227], s[58:59]
v_pk_mul_f32 v[228:229], v[228:229], s[58:59]
v_cvt_pk_bf16_f32 v234, v226, v227
v_cvt_pk_bf16_f32 v235, v228, v229
v_accvgpr_read_b32 v230, a208
v_accvgpr_read_b32 v231, a209
v_accvgpr_read_b32 v232, a210
v_accvgpr_read_b32 v233, a211
v_pk_mul_f32 v[230:231], v[230:231], s[58:59]
v_pk_mul_f32 v[232:233], v[232:233], s[58:59]
v_cvt_pk_bf16_f32 v236, v230, v231
v_cvt_pk_bf16_f32 v237, v232, v233
v_accvgpr_write_b32 a72, v234
v_accvgpr_write_b32 a73, v235
v_accvgpr_write_b32 a74, v236
v_accvgpr_write_b32 a75, v237
v_accvgpr_read_b32 v226, a196
v_accvgpr_read_b32 v227, a197
v_accvgpr_read_b32 v228, a198
v_accvgpr_read_b32 v229, a199
v_pk_mul_f32 v[226:227], v[226:227], s[58:59]
v_pk_mul_f32 v[228:229], v[228:229], s[58:59]
v_cvt_pk_bf16_f32 v234, v226, v227
v_cvt_pk_bf16_f32 v235, v228, v229
v_accvgpr_read_b32 v230, a212
v_accvgpr_read_b32 v231, a213
v_accvgpr_read_b32 v232, a214
v_accvgpr_read_b32 v233, a215
v_pk_mul_f32 v[230:231], v[230:231], s[58:59]
v_pk_mul_f32 v[232:233], v[232:233], s[58:59]
v_cvt_pk_bf16_f32 v236, v230, v231
v_cvt_pk_bf16_f32 v237, v232, v233
v_accvgpr_write_b32 a88, v234
v_accvgpr_write_b32 a89, v235
v_accvgpr_write_b32 a90, v236
v_accvgpr_write_b32 a91, v237
v_accvgpr_read_b32 v226, a200
v_accvgpr_read_b32 v227, a201
v_accvgpr_read_b32 v228, a202
v_accvgpr_read_b32 v229, a203
v_pk_mul_f32 v[226:227], v[226:227], s[58:59]
v_pk_mul_f32 v[228:229], v[228:229], s[58:59]
v_cvt_pk_bf16_f32 v234, v226, v227
v_cvt_pk_bf16_f32 v235, v228, v229
v_accvgpr_read_b32 v230, a216
v_accvgpr_read_b32 v231, a217
v_accvgpr_read_b32 v232, a218
v_accvgpr_read_b32 v233, a219
v_pk_mul_f32 v[230:231], v[230:231], s[58:59]
v_pk_mul_f32 v[232:233], v[232:233], s[58:59]
v_cvt_pk_bf16_f32 v236, v230, v231
v_cvt_pk_bf16_f32 v237, v232, v233
v_accvgpr_write_b32 a104, v234
v_accvgpr_write_b32 a105, v235
v_accvgpr_write_b32 a106, v236
v_accvgpr_write_b32 a107, v237
v_accvgpr_read_b32 v226, a204
v_accvgpr_read_b32 v227, a205
v_accvgpr_read_b32 v228, a206
v_accvgpr_read_b32 v229, a207
v_pk_mul_f32 v[226:227], v[226:227], s[58:59]
v_pk_mul_f32 v[228:229], v[228:229], s[58:59]
v_cvt_pk_bf16_f32 v234, v226, v227
v_cvt_pk_bf16_f32 v235, v228, v229
v_accvgpr_read_b32 v230, a220
v_accvgpr_read_b32 v231, a221
v_accvgpr_read_b32 v232, a222
v_accvgpr_read_b32 v233, a223
v_pk_mul_f32 v[230:231], v[230:231], s[58:59]
v_pk_mul_f32 v[232:233], v[232:233], s[58:59]
v_cvt_pk_bf16_f32 v236, v230, v231
v_cvt_pk_bf16_f32 v237, v232, v233
v_accvgpr_write_b32 a120, v234
v_accvgpr_write_b32 a121, v235
v_accvgpr_write_b32 a122, v236
v_accvgpr_write_b32 a123, v237
buffer_load_dwordx4 v208, s[16:19], s34 offen offset:2048 nt lds
v_accvgpr_read_b32 v226, a224
v_accvgpr_read_b32 v227, a225
v_accvgpr_read_b32 v228, a226
v_accvgpr_read_b32 v229, a227
v_pk_mul_f32 v[226:227], v[226:227], s[58:59]
v_pk_mul_f32 v[228:229], v[228:229], s[58:59]
v_cvt_pk_bf16_f32 v234, v226, v227
v_cvt_pk_bf16_f32 v235, v228, v229
v_accvgpr_read_b32 v230, a240
v_accvgpr_read_b32 v231, a241
v_accvgpr_read_b32 v232, a242
v_accvgpr_read_b32 v233, a243
v_pk_mul_f32 v[230:231], v[230:231], s[58:59]
v_pk_mul_f32 v[232:233], v[232:233], s[58:59]
v_cvt_pk_bf16_f32 v236, v230, v231
v_cvt_pk_bf16_f32 v237, v232, v233
v_accvgpr_write_b32 a76, v234
v_accvgpr_write_b32 a77, v235
v_accvgpr_write_b32 a78, v236
v_accvgpr_write_b32 a79, v237
v_accvgpr_read_b32 v226, a228
v_accvgpr_read_b32 v227, a229
v_accvgpr_read_b32 v228, a230
v_accvgpr_read_b32 v229, a231
v_pk_mul_f32 v[226:227], v[226:227], s[58:59]
v_pk_mul_f32 v[228:229], v[228:229], s[58:59]
v_cvt_pk_bf16_f32 v234, v226, v227
v_cvt_pk_bf16_f32 v235, v228, v229
v_accvgpr_read_b32 v230, a244
v_accvgpr_read_b32 v231, a245
v_accvgpr_read_b32 v232, a246
v_accvgpr_read_b32 v233, a247
v_pk_mul_f32 v[230:231], v[230:231], s[58:59]
v_pk_mul_f32 v[232:233], v[232:233], s[58:59]
v_cvt_pk_bf16_f32 v236, v230, v231
v_cvt_pk_bf16_f32 v237, v232, v233
v_accvgpr_write_b32 a92, v234
v_accvgpr_write_b32 a93, v235
v_accvgpr_write_b32 a94, v236
v_accvgpr_write_b32 a95, v237
v_accvgpr_read_b32 v226, a232
v_accvgpr_read_b32 v227, a233
v_accvgpr_read_b32 v228, a234
v_accvgpr_read_b32 v229, a235
v_pk_mul_f32 v[226:227], v[226:227], s[58:59]
v_pk_mul_f32 v[228:229], v[228:229], s[58:59]
v_cvt_pk_bf16_f32 v234, v226, v227
v_cvt_pk_bf16_f32 v235, v228, v229
v_accvgpr_read_b32 v230, a248
v_accvgpr_read_b32 v231, a249
v_accvgpr_read_b32 v232, a250
v_accvgpr_read_b32 v233, a251
v_pk_mul_f32 v[230:231], v[230:231], s[58:59]
v_pk_mul_f32 v[232:233], v[232:233], s[58:59]
v_cvt_pk_bf16_f32 v236, v230, v231
v_cvt_pk_bf16_f32 v237, v232, v233
v_accvgpr_write_b32 a108, v234
v_accvgpr_write_b32 a109, v235
v_accvgpr_write_b32 a110, v236
v_accvgpr_write_b32 a111, v237
v_accvgpr_read_b32 v226, a236
v_accvgpr_read_b32 v227, a237
v_accvgpr_read_b32 v228, a238
v_accvgpr_read_b32 v229, a239
v_pk_mul_f32 v[226:227], v[226:227], s[58:59]
v_pk_mul_f32 v[228:229], v[228:229], s[58:59]
v_cvt_pk_bf16_f32 v234, v226, v227
v_cvt_pk_bf16_f32 v235, v228, v229
v_accvgpr_read_b32 v230, a252
v_accvgpr_read_b32 v231, a253
v_accvgpr_read_b32 v232, a254
v_accvgpr_read_b32 v233, a255
v_pk_mul_f32 v[230:231], v[230:231], s[58:59]
v_pk_mul_f32 v[232:233], v[232:233], s[58:59]
v_cvt_pk_bf16_f32 v236, v230, v231
v_cvt_pk_bf16_f32 v237, v232, v233
v_accvgpr_write_b32 a124, v234
v_accvgpr_write_b32 a125, v235
v_accvgpr_write_b32 a126, v236
v_accvgpr_write_b32 a127, v237
buffer_load_dwordx4 v209, s[16:19], s34 offen offset:3072 nt lds
s_add_u32 s34, s34, 16384
s_add_u32 s30, s30, 16384
s_cmp_eq_u32 s30, 163840
s_cselect_b32 s30, 0, s30
v_pk_mul_f32 v[0:1], v[0:1], s[58:59]
v_pk_mul_f32 v[2:3], v[2:3], s[58:59]
v_cvt_pk_bf16_f32 v234, v0, v1
v_cvt_pk_bf16_f32 v235, v2, v3
v_pk_mul_f32 v[16:17], v[16:17], s[58:59]
v_pk_mul_f32 v[18:19], v[18:19], s[58:59]
v_cvt_pk_bf16_f32 v236, v16, v17
v_cvt_pk_bf16_f32 v237, v18, v19
v_accvgpr_write_b32 a0, v234
v_accvgpr_write_b32 a1, v235
v_accvgpr_write_b32 a2, v236
v_accvgpr_write_b32 a3, v237
v_pk_mul_f32 v[4:5], v[4:5], s[58:59]
v_pk_mul_f32 v[6:7], v[6:7], s[58:59]
v_cvt_pk_bf16_f32 v234, v4, v5
v_cvt_pk_bf16_f32 v235, v6, v7
v_pk_mul_f32 v[20:21], v[20:21], s[58:59]
v_pk_mul_f32 v[22:23], v[22:23], s[58:59]
v_cvt_pk_bf16_f32 v236, v20, v21
v_cvt_pk_bf16_f32 v237, v22, v23
v_accvgpr_write_b32 a16, v234
v_accvgpr_write_b32 a17, v235
v_accvgpr_write_b32 a18, v236
v_accvgpr_write_b32 a19, v237
v_pk_mul_f32 v[8:9], v[8:9], s[58:59]
v_pk_mul_f32 v[10:11], v[10:11], s[58:59]
v_cvt_pk_bf16_f32 v234, v8, v9
v_cvt_pk_bf16_f32 v235, v10, v11
v_pk_mul_f32 v[24:25], v[24:25], s[58:59]
v_pk_mul_f32 v[26:27], v[26:27], s[58:59]
v_cvt_pk_bf16_f32 v236, v24, v25
v_cvt_pk_bf16_f32 v237, v26, v27
v_accvgpr_write_b32 a32, v234
v_accvgpr_write_b32 a33, v235
v_accvgpr_write_b32 a34, v236
v_accvgpr_write_b32 a35, v237
v_pk_mul_f32 v[12:13], v[12:13], s[58:59]
v_pk_mul_f32 v[14:15], v[14:15], s[58:59]
v_cvt_pk_bf16_f32 v234, v12, v13
v_cvt_pk_bf16_f32 v235, v14, v15
v_pk_mul_f32 v[28:29], v[28:29], s[58:59]
v_pk_mul_f32 v[30:31], v[30:31], s[58:59]
v_cvt_pk_bf16_f32 v236, v28, v29
v_cvt_pk_bf16_f32 v237, v30, v31
v_accvgpr_write_b32 a48, v234
v_accvgpr_write_b32 a49, v235
v_accvgpr_write_b32 a50, v236
v_accvgpr_write_b32 a51, v237
s_add_u32 m0, s30, s29
s_nop 0
buffer_load_dwordx4 v204, s[12:15], s33 offen offset:0 nt lds
v_pk_mul_f32 v[32:33], v[32:33], s[58:59]
v_pk_mul_f32 v[34:35], v[34:35], s[58:59]
v_cvt_pk_bf16_f32 v234, v32, v33
v_cvt_pk_bf16_f32 v235, v34, v35
v_pk_mul_f32 v[48:49], v[48:49], s[58:59]
v_pk_mul_f32 v[50:51], v[50:51], s[58:59]
v_cvt_pk_bf16_f32 v236, v48, v49
v_cvt_pk_bf16_f32 v237, v50, v51
v_accvgpr_write_b32 a4, v234
v_accvgpr_write_b32 a5, v235
v_accvgpr_write_b32 a6, v236
v_accvgpr_write_b32 a7, v237
v_pk_mul_f32 v[36:37], v[36:37], s[58:59]
v_pk_mul_f32 v[38:39], v[38:39], s[58:59]
v_cvt_pk_bf16_f32 v234, v36, v37
v_cvt_pk_bf16_f32 v235, v38, v39
v_pk_mul_f32 v[52:53], v[52:53], s[58:59]
v_pk_mul_f32 v[54:55], v[54:55], s[58:59]
v_cvt_pk_bf16_f32 v236, v52, v53
v_cvt_pk_bf16_f32 v237, v54, v55
v_accvgpr_write_b32 a20, v234
v_accvgpr_write_b32 a21, v235
v_accvgpr_write_b32 a22, v236
v_accvgpr_write_b32 a23, v237
v_pk_mul_f32 v[40:41], v[40:41], s[58:59]
v_pk_mul_f32 v[42:43], v[42:43], s[58:59]
v_cvt_pk_bf16_f32 v234, v40, v41
v_cvt_pk_bf16_f32 v235, v42, v43
v_pk_mul_f32 v[56:57], v[56:57], s[58:59]
v_pk_mul_f32 v[58:59], v[58:59], s[58:59]
v_cvt_pk_bf16_f32 v236, v56, v57
v_cvt_pk_bf16_f32 v237, v58, v59
v_accvgpr_write_b32 a36, v234
v_accvgpr_write_b32 a37, v235
v_accvgpr_write_b32 a38, v236
v_accvgpr_write_b32 a39, v237
v_pk_mul_f32 v[44:45], v[44:45], s[58:59]
v_pk_mul_f32 v[46:47], v[46:47], s[58:59]
v_cvt_pk_bf16_f32 v234, v44, v45
v_cvt_pk_bf16_f32 v235, v46, v47
v_pk_mul_f32 v[60:61], v[60:61], s[58:59]
v_pk_mul_f32 v[62:63], v[62:63], s[58:59]
v_cvt_pk_bf16_f32 v236, v60, v61
v_cvt_pk_bf16_f32 v237, v62, v63
v_accvgpr_write_b32 a52, v234
v_accvgpr_write_b32 a53, v235
v_accvgpr_write_b32 a54, v236
v_accvgpr_write_b32 a55, v237
buffer_load_dwordx4 v205, s[12:15], s33 offen offset:1024 nt lds
v_pk_mul_f32 v[64:65], v[64:65], s[58:59]
v_pk_mul_f32 v[66:67], v[66:67], s[58:59]
v_cvt_pk_bf16_f32 v234, v64, v65
v_cvt_pk_bf16_f32 v235, v66, v67
v_pk_mul_f32 v[80:81], v[80:81], s[58:59]
v_pk_mul_f32 v[82:83], v[82:83], s[58:59]
v_cvt_pk_bf16_f32 v236, v80, v81
v_cvt_pk_bf16_f32 v237, v82, v83
v_accvgpr_write_b32 a8, v234
v_accvgpr_write_b32 a9, v235
v_accvgpr_write_b32 a10, v236
v_accvgpr_write_b32 a11, v237
v_pk_mul_f32 v[68:69], v[68:69], s[58:59]
v_pk_mul_f32 v[70:71], v[70:71], s[58:59]
v_cvt_pk_bf16_f32 v234, v68, v69
v_cvt_pk_bf16_f32 v235, v70, v71
v_pk_mul_f32 v[84:85], v[84:85], s[58:59]
v_pk_mul_f32 v[86:87], v[86:87], s[58:59]
v_cvt_pk_bf16_f32 v236, v84, v85
v_cvt_pk_bf16_f32 v237, v86, v87
v_accvgpr_write_b32 a24, v234
v_accvgpr_write_b32 a25, v235
v_accvgpr_write_b32 a26, v236
v_accvgpr_write_b32 a27, v237
v_pk_mul_f32 v[72:73], v[72:73], s[58:59]
v_pk_mul_f32 v[74:75], v[74:75], s[58:59]
v_cvt_pk_bf16_f32 v234, v72, v73
v_cvt_pk_bf16_f32 v235, v74, v75
v_pk_mul_f32 v[88:89], v[88:89], s[58:59]
v_pk_mul_f32 v[90:91], v[90:91], s[58:59]
v_cvt_pk_bf16_f32 v236, v88, v89
v_cvt_pk_bf16_f32 v237, v90, v91
v_accvgpr_write_b32 a40, v234
v_accvgpr_write_b32 a41, v235
v_accvgpr_write_b32 a42, v236
v_accvgpr_write_b32 a43, v237
v_pk_mul_f32 v[76:77], v[76:77], s[58:59]
v_pk_mul_f32 v[78:79], v[78:79], s[58:59]
v_cvt_pk_bf16_f32 v234, v76, v77
v_cvt_pk_bf16_f32 v235, v78, v79
v_pk_mul_f32 v[92:93], v[92:93], s[58:59]
v_pk_mul_f32 v[94:95], v[94:95], s[58:59]
v_cvt_pk_bf16_f32 v236, v92, v93
v_cvt_pk_bf16_f32 v237, v94, v95
v_accvgpr_write_b32 a56, v234
v_accvgpr_write_b32 a57, v235
v_accvgpr_write_b32 a58, v236
v_accvgpr_write_b32 a59, v237
buffer_load_dwordx4 v206, s[12:15], s33 offen offset:2048 nt lds
v_pk_mul_f32 v[96:97], v[96:97], s[58:59]
v_pk_mul_f32 v[98:99], v[98:99], s[58:59]
v_cvt_pk_bf16_f32 v234, v96, v97
v_cvt_pk_bf16_f32 v235, v98, v99
v_pk_mul_f32 v[112:113], v[112:113], s[58:59]
v_pk_mul_f32 v[114:115], v[114:115], s[58:59]
v_cvt_pk_bf16_f32 v236, v112, v113
v_cvt_pk_bf16_f32 v237, v114, v115
v_accvgpr_write_b32 a12, v234
v_accvgpr_write_b32 a13, v235
v_accvgpr_write_b32 a14, v236
v_accvgpr_write_b32 a15, v237
v_pk_mul_f32 v[100:101], v[100:101], s[58:59]
v_pk_mul_f32 v[102:103], v[102:103], s[58:59]
v_cvt_pk_bf16_f32 v234, v100, v101
v_cvt_pk_bf16_f32 v235, v102, v103
v_pk_mul_f32 v[116:117], v[116:117], s[58:59]
v_pk_mul_f32 v[118:119], v[118:119], s[58:59]
v_cvt_pk_bf16_f32 v236, v116, v117
v_cvt_pk_bf16_f32 v237, v118, v119
v_accvgpr_write_b32 a28, v234
v_accvgpr_write_b32 a29, v235
v_accvgpr_write_b32 a30, v236
v_accvgpr_write_b32 a31, v237
v_pk_mul_f32 v[104:105], v[104:105], s[58:59]
v_pk_mul_f32 v[106:107], v[106:107], s[58:59]
v_cvt_pk_bf16_f32 v234, v104, v105
v_cvt_pk_bf16_f32 v235, v106, v107
v_pk_mul_f32 v[120:121], v[120:121], s[58:59]
v_pk_mul_f32 v[122:123], v[122:123], s[58:59]
v_cvt_pk_bf16_f32 v236, v120, v121
v_cvt_pk_bf16_f32 v237, v122, v123
v_accvgpr_write_b32 a44, v234
v_accvgpr_write_b32 a45, v235
v_accvgpr_write_b32 a46, v236
v_accvgpr_write_b32 a47, v237
v_pk_mul_f32 v[108:109], v[108:109], s[58:59]
v_pk_mul_f32 v[110:111], v[110:111], s[58:59]
v_cvt_pk_bf16_f32 v234, v108, v109
v_cvt_pk_bf16_f32 v235, v110, v111
v_pk_mul_f32 v[124:125], v[124:125], s[58:59]
v_pk_mul_f32 v[126:127], v[126:127], s[58:59]
v_cvt_pk_bf16_f32 v236, v124, v125
v_cvt_pk_bf16_f32 v237, v126, v127
v_accvgpr_write_b32 a60, v234
v_accvgpr_write_b32 a61, v235
v_accvgpr_write_b32 a62, v236
v_accvgpr_write_b32 a63, v237
buffer_load_dwordx4 v207, s[12:15], s33 offen offset:3072 nt lds
s_add_u32 s33, s33, 16384
s_add_u32 s30, s30, 16384
s_cmp_eq_u32 s30, 163840
s_cselect_b32 s30, 0, s30
s_waitcnt lgkmcnt(7)
v_mfma_f32_16x16x32_bf16 v[128:131], a[128:131], a[0:3], 0
s_waitcnt lgkmcnt(6)
v_mfma_f32_16x16x32_bf16 v[128:131], a[132:135], a[4:7], v[128:131]
s_waitcnt lgkmcnt(5)
v_mfma_f32_16x16x32_bf16 v[128:131], a[136:139], a[8:11], v[128:131]
s_add_u32 m0, s30, s29
s_waitcnt lgkmcnt(4)
v_mfma_f32_16x16x32_bf16 v[128:131], a[140:143], a[12:15], v[128:131]
s_waitcnt lgkmcnt(3)
v_mfma_f32_16x16x32_bf16 v[144:147], a[144:147], a[0:3], 0
s_waitcnt lgkmcnt(2)
v_mfma_f32_16x16x32_bf16 v[144:147], a[148:151], a[4:7], v[144:147]
s_waitcnt lgkmcnt(1)
v_mfma_f32_16x16x32_bf16 v[144:147], a[152:155], a[8:11], v[144:147]
buffer_load_dwordx4 v208, s[16:19], s34 offen offset:0 nt lds
s_waitcnt lgkmcnt(0)
v_mfma_f32_16x16x32_bf16 v[144:147], a[156:159], a[12:15], v[144:147]
v_mfma_f32_16x16x32_bf16 v[132:135], a[128:131], a[16:19], 0
v_mfma_f32_16x16x32_bf16 v[132:135], a[132:135], a[20:23], v[132:135]
v_mfma_f32_16x16x32_bf16 v[132:135], a[136:139], a[24:27], v[132:135]
v_mov_b32 v210, 0
v_mfma_f32_16x16x32_bf16 v[132:135], a[140:143], a[28:31], v[132:135]
v_mfma_f32_16x16x32_bf16 v[148:151], a[144:147], a[16:19], 0
buffer_load_dwordx4 v209, s[16:19], s34 offen offset:1024 nt lds
v_mfma_f32_16x16x32_bf16 v[148:151], a[148:151], a[20:23], v[148:151]
v_mfma_f32_16x16x32_bf16 v[148:151], a[152:155], a[24:27], v[148:151]
v_mfma_f32_16x16x32_bf16 v[148:151], a[156:159], a[28:31], v[148:151]
v_mfma_f32_16x16x32_bf16 v[136:139], a[128:131], a[32:35], 0
v_mfma_f32_16x16x32_bf16 v[136:139], a[132:135], a[36:39], v[136:139]
v_mfma_f32_16x16x32_bf16 v[136:139], a[136:139], a[40:43], v[136:139]
buffer_load_dwordx4 v208, s[16:19], s34 offen offset:2048 nt lds
v_mov_b32 v211, 0
v_mfma_f32_16x16x32_bf16 v[136:139], a[140:143], a[44:47], v[136:139]
v_max3_f32 v226, v128, v129, v130
v_max3_f32 v230, v131, v144, v145
v_max3_f32 v226, v226, v146, v147
v_max_f32 v226, v226, v230
v_max3_f32 v227, v132, v133, v134
v_max3_f32 v231, v135, v148, v149
v_max3_f32 v227, v227, v150, v151
v_max_f32 v227, v227, v231
v_mfma_f32_16x16x32_bf16 v[152:155], a[144:147], a[32:35], 0
v_mov_b32 v230, v226
v_mov_b32 v231, v227
s_nop 1
v_permlane16_swap_b32 v226, v230
v_permlane16_swap_b32 v227, v231
s_nop 0
v_max_f32 v226, v226, v230
v_max_f32 v227, v227, v231
v_mov_b32 v230, v226
v_mov_b32 v231, v227
s_nop 1
v_permlane32_swap_b32 v226, v230
v_permlane32_swap_b32 v227, v231
s_nop 0
v_max_f32 v226, v226, v230
v_max_f32 v227, v227, v231
v_mfma_f32_16x16x32_bf16 v[152:155], a[148:151], a[36:39], v[152:155]
v_sub_f32 v176, 0, v226
v_sub_f32 v177, 0, v226
v_mfma_f32_16x16x32_bf16 v[152:155], a[152:155], a[40:43], v[152:155]
v_sub_f32 v178, 0, v226
v_sub_f32 v179, 0, v226
v_mfma_f32_16x16x32_bf16 v[152:155], a[156:159], a[44:47], v[152:155]
v_sub_f32 v128, v128, v226
v_sub_f32 v129, v129, v226
v_mfma_f32_16x16x32_bf16 v[140:143], a[128:131], a[48:51], 0
buffer_load_dwordx4 v209, s[16:19], s34 offen offset:3072 nt lds
v_sub_f32 v130, v130, v226
v_mfma_f32_16x16x32_bf16 v[140:143], a[132:135], a[52:55], v[140:143]
v_exp_f32 v128, v128
v_mfma_f32_16x16x32_bf16 v[140:143], a[136:139], a[56:59], v[140:143]
s_add_u32 s34, s34, 16384
v_exp_f32 v129, v129
v_mfma_f32_16x16x32_bf16 v[140:143], a[140:143], a[60:63], v[140:143]
v_exp_f32 v130, v130
v_mfma_f32_16x16x32_bf16 v[156:159], a[144:147], a[48:51], 0
s_add_u32 s30, s30, 16384
v_sub_f32 v131, v131, v226
v_sub_f32 v144, v144, v226
v_mfma_f32_16x16x32_bf16 v[156:159], a[148:151], a[52:55], v[156:159]
v_exp_f32 v131, v131
v_mfma_f32_16x16x32_bf16 v[156:159], a[152:155], a[56:59], v[156:159]
v_exp_f32 v144, v144
v_mfma_f32_16x16x32_bf16 v[156:159], a[156:159], a[60:63], v[156:159]
v_sub_f32 v145, v145, v226
v_sub_f32 v146, v146, v226
s_cmp_eq_u32 s30, 163840
s_cselect_b32 s30, 0, s30
v_exp_f32 v145, v145
v_exp_f32 v146, v146
s_nop 1
v_sub_f32 v147, v147, v226
v_exp_f32 v147, v147
v_add_f32 v210, v210, v128
s_nop 0
v_max3_f32 v228, v136, v137, v138
v_max3_f32 v232, v139, v152, v153
v_max3_f32 v228, v228, v154, v155
v_max_f32 v228, v228, v232
v_max3_f32 v229, v140, v141, v142
v_max3_f32 v233, v143, v156, v157
v_max3_f32 v229, v229, v158, v159
v_max_f32 v229, v229, v233
v_mov_b32 v232, v228
v_mov_b32 v233, v229
s_nop 1
v_permlane16_swap_b32 v228, v232
v_permlane16_swap_b32 v229, v233
s_nop 0
v_max_f32 v228, v228, v232
v_max_f32 v229, v229, v233
v_mov_b32 v232, v228
v_mov_b32 v233, v229
s_nop 1
v_permlane32_swap_b32 v228, v232
v_permlane32_swap_b32 v229, v233
s_nop 0
v_max_f32 v228, v228, v232
v_max_f32 v229, v229, v233
v_max_f32 v229, s53, v229
s_add_u32 m0, s30, s29
v_add_f32 v210, v210, v129
v_cvt_pk_bf16_f32 v160, v128, v129
v_add_f32 v210, v210, v130
v_add_f32 v210, v210, v131
ds_read_b128 a[128:131], v192 offset:8192
v_cvt_pk_bf16_f32 v161, v130, v131
v_add_f32 v210, v210, v144
v_add_f32 v210, v210, v145
v_cvt_pk_bf16_f32 v162, v144, v145
buffer_load_dwordx4 v204, s[12:15], s33 offen offset:0 nt lds
v_add_f32 v210, v210, v146
v_add_f32 v210, v210, v147
v_cvt_pk_bf16_f32 v163, v146, v147
v_sub_f32 v180, 0, v227
ds_read_b128 a[132:135], v193 offset:8192
v_sub_f32 v181, 0, v227
v_sub_f32 v182, 0, v227
v_sub_f32 v183, 0, v227
v_sub_f32 v132, v132, v227
v_exp_f32 v132, v132
v_sub_f32 v133, v133, v227
v_sub_f32 v134, v134, v227
s_nop 0
ds_read_b128 a[136:139], v194 offset:8192
v_exp_f32 v133, v133
v_exp_f32 v134, v134
s_nop 1
v_sub_f32 v135, v135, v227
v_exp_f32 v135, v135
v_sub_f32 v148, v148, v227
s_nop 0
ds_read_b128 a[140:143], v195 offset:8192
v_exp_f32 v148, v148
v_sub_f32 v149, v149, v227
v_sub_f32 v150, v150, v227
s_nop 0
buffer_load_dwordx4 v205, s[12:15], s33 offen offset:1024 nt lds
v_exp_f32 v149, v149
v_exp_f32 v150, v150
s_nop 1
ds_read_b128 a[144:147], v192 offset:12288
v_sub_f32 v151, v151, v227
v_exp_f32 v151, v151
v_add_f32 v211, v211, v132
s_nop 0
v_add_f32 v211, v211, v133
v_cvt_pk_bf16_f32 v164, v132, v133
v_add_f32 v211, v211, v134
v_add_f32 v211, v211, v135
ds_read_b128 a[148:151], v193 offset:12288
v_cvt_pk_bf16_f32 v165, v134, v135
v_add_f32 v211, v211, v148
v_add_f32 v211, v211, v149
v_cvt_pk_bf16_f32 v166, v148, v149
s_sub_u32 s37, s35, s49
s_mov_b32 s49, s35
v_add_f32 v211, v211, v150
v_add_f32 v211, v211, v151
v_cvt_pk_bf16_f32 v167, v150, v151
v_sub_f32 v184, 0, v228
ds_read_b128 a[152:155], v194 offset:12288
v_add_u32 v196, s37, v196
v_add_u32 v197, s37, v197
v_add_u32 v198, s37, v198
v_add_u32 v199, s37, v199
s_add_u32 s35, s35, 16384
buffer_load_dwordx4 v206, s[12:15], s33 offen offset:2048 nt lds
v_add_u32 v200, s37, v200
v_add_u32 v201, s37, v201
v_add_u32 v202, s37, v202
v_add_u32 v203, s37, v203
ds_read_b128 a[156:159], v195 offset:12288
v_sub_f32 v185, 0, v228
v_sub_f32 v186, 0, v228
v_sub_f32 v187, 0, v228
v_mov_b32 v212, 0
s_cmp_eq_u32 s35, 163840
s_cselect_b32 s35, 0, s35
v_sub_f32 v136, v136, v228
v_exp_f32 v136, v136
v_sub_f32 v137, v137, v228
s_nop 0
v_exp_f32 v137, v137
v_sub_f32 v138, v138, v228
v_sub_f32 v139, v139, v228
s_nop 0
v_exp_f32 v138, v138
v_exp_f32 v139, v139
s_nop 1
v_sub_f32 v152, v152, v228
v_exp_f32 v152, v152
v_sub_f32 v153, v153, v228
s_nop 0
buffer_load_dwordx4 v207, s[12:15], s33 offen offset:3072 nt lds
v_exp_f32 v153, v153
v_sub_f32 v154, v154, v228
v_sub_f32 v155, v155, v228
s_nop 0
v_exp_f32 v154, v154
v_exp_f32 v155, v155
s_nop 1
s_add_u32 s33, s33, 16384
v_add_f32 v212, v212, v136
v_add_f32 v212, v212, v137
v_cvt_pk_bf16_f32 v168, v136, v137
v_add_f32 v212, v212, v138
v_add_f32 v212, v212, v139
v_cvt_pk_bf16_f32 v169, v138, v139
v_add_f32 v212, v212, v152
v_add_f32 v212, v212, v153
s_add_u32 s30, s30, 16384
v_cvt_pk_bf16_f32 v170, v152, v153
v_add_f32 v212, v212, v154
v_add_f32 v212, v212, v155
v_cvt_pk_bf16_f32 v171, v154, v155
v_sub_f32 v188, 0, v229
v_sub_f32 v189, 0, v229
v_sub_f32 v190, 0, v229
v_sub_f32 v191, 0, v229
s_cmp_eq_u32 s30, 163840
s_cselect_b32 s30, 0, s30
v_mov_b32 v213, 0
v_sub_f32 v140, v140, v229
v_exp_f32 v140, v140
s_nop 0
s_waitcnt lgkmcnt(0)
v_sub_f32 v141, v141, v229
v_exp_f32 v141, v141
v_sub_f32 v142, v142, v229
s_nop 0
v_mfma_f32_16x16x32_bf16 v[128:131], a[128:131], a[0:3], v[176:179]
s_waitcnt vmcnt(20)
s_barrier
v_exp_f32 v142, v142
v_mfma_f32_16x16x32_bf16 v[128:131], a[132:135], a[4:7], v[128:131]
ds_read_b64_tr_b16 a[160:161], v196 offset:0
v_sub_f32 v143, v143, v229
v_mfma_f32_16x16x32_bf16 v[128:131], a[136:139], a[8:11], v[128:131]
s_add_u32 m0, s30, s29
v_exp_f32 v143, v143
v_mfma_f32_16x16x32_bf16 v[128:131], a[140:143], a[12:15], v[128:131]
ds_read_b64_tr_b16 a[162:163], v196 offset:4096
v_sub_f32 v156, v156, v229
v_mfma_f32_16x16x32_bf16 v[144:147], a[144:147], a[0:3], v[176:179]
v_exp_f32 v156, v156
v_mfma_f32_16x16x32_bf16 v[144:147], a[148:151], a[4:7], v[144:147]
ds_read_b64_tr_b16 a[164:165], v197 offset:0
v_sub_f32 v157, v157, v229
v_mfma_f32_16x16x32_bf16 v[144:147], a[152:155], a[8:11], v[144:147]
buffer_load_dwordx4 v208, s[16:19], s34 offen offset:0 nt lds
v_sub_f32 v158, v158, v229
v_mfma_f32_16x16x32_bf16 v[144:147], a[156:159], a[12:15], v[144:147]
ds_read_b64_tr_b16 a[166:167], v197 offset:4096
v_sub_f32 v159, v159, v229
v_mfma_f32_16x16x32_bf16 v[132:135], a[128:131], a[16:19], v[180:183]
v_exp_f32 v157, v157
v_mfma_f32_16x16x32_bf16 v[132:135], a[132:135], a[20:23], v[132:135]
ds_read_b64_tr_b16 a[168:169], v198 offset:0
v_add_f32 v213, v213, v140
v_mfma_f32_16x16x32_bf16 v[132:135], a[136:139], a[24:27], v[132:135]
v_exp_f32 v158, v158
v_mfma_f32_16x16x32_bf16 v[132:135], a[140:143], a[28:31], v[132:135]
ds_read_b64_tr_b16 a[170:171], v198 offset:4096
v_add_f32 v213, v213, v141
v_mfma_f32_16x16x32_bf16 v[148:151], a[144:147], a[16:19], v[180:183]
buffer_load_dwordx4 v209, s[16:19], s34 offen offset:1024 nt lds
v_cvt_pk_bf16_f32 v172, v140, v141
v_mfma_f32_16x16x32_bf16 v[148:151], a[148:151], a[20:23], v[148:151]
ds_read_b64_tr_b16 a[172:173], v199 offset:0
v_add_f32 v213, v213, v142
v_mfma_f32_16x16x32_bf16 v[148:151], a[152:155], a[24:27], v[148:151]
v_exp_f32 v159, v159
v_mfma_f32_16x16x32_bf16 v[148:151], a[156:159], a[28:31], v[148:151]
ds_read_b64_tr_b16 a[174:175], v199 offset:4096
v_add_f32 v213, v213, v143
v_mfma_f32_16x16x32_bf16 v[136:139], a[128:131], a[32:35], v[184:187]
v_exp_f32 v128, v128
v_mfma_f32_16x16x32_bf16 v[136:139], a[132:135], a[36:39], v[136:139]
ds_read_b64_tr_b16 a[176:177], v200 offset:0
v_cvt_pk_bf16_f32 v173, v142, v143
v_mfma_f32_16x16x32_bf16 v[136:139], a[136:139], a[40:43], v[136:139]
buffer_load_dwordx4 v208, s[16:19], s34 offen offset:2048 nt lds
v_add_f32 v213, v213, v156
v_mfma_f32_16x16x32_bf16 v[136:139], a[140:143], a[44:47], v[136:139]
ds_read_b64_tr_b16 a[178:179], v200 offset:4096
v_add_f32 v213, v213, v157
v_mfma_f32_16x16x32_bf16 v[152:155], a[144:147], a[32:35], v[184:187]
v_exp_f32 v129, v129
v_mfma_f32_16x16x32_bf16 v[152:155], a[148:151], a[36:39], v[152:155]
ds_read_b64_tr_b16 a[180:181], v201 offset:0
v_cvt_pk_bf16_f32 v174, v156, v157
v_mfma_f32_16x16x32_bf16 v[152:155], a[152:155], a[40:43], v[152:155]
v_exp_f32 v130, v130
v_mfma_f32_16x16x32_bf16 v[152:155], a[156:159], a[44:47], v[152:155]
ds_read_b64_tr_b16 a[182:183], v201 offset:4096
v_add_f32 v213, v213, v158
v_add_f32 v213, v213, v159
v_cvt_pk_bf16_f32 v175, v158, v159
v_mfma_f32_16x16x32_bf16 v[140:143], a[128:131], a[48:51], v[188:191]
buffer_load_dwordx4 v209, s[16:19], s34 offen offset:3072 nt lds
v_add_f32 v210, v210, v128
v_mfma_f32_16x16x32_bf16 v[140:143], a[132:135], a[52:55], v[140:143]
ds_read_b64_tr_b16 a[184:185], v202 offset:0
v_add_f32 v210, v210, v129
v_mfma_f32_16x16x32_bf16 v[140:143], a[136:139], a[56:59], v[140:143]
s_add_u32 s34, s34, 16384
v_exp_f32 v131, v131
v_mfma_f32_16x16x32_bf16 v[140:143], a[140:143], a[60:63], v[140:143]
ds_read_b64_tr_b16 a[186:187], v202 offset:4096
v_add_f32 v210, v210, v130
v_mfma_f32_16x16x32_bf16 v[156:159], a[144:147], a[48:51], v[188:191]
s_waitcnt lgkmcnt(4)
s_add_u32 s30, s30, 16384
v_add_f32 v210, v210, v131
v_mfma_f32_16x16x32_bf16 v[156:159], a[148:151], a[52:55], v[156:159]
ds_read_b64_tr_b16 a[188:189], v203 offset:0
v_mfma_f32_16x16x32_bf16 v[156:159], a[152:155], a[56:59], v[156:159]
s_sub_u32 s37, s35, s48
s_mov_b32 s48, s35
v_mfma_f32_16x16x32_bf16 v[156:159], a[156:159], a[60:63], v[156:159]
ds_read_b64_tr_b16 a[190:191], v203 offset:4096
v_add_u32 v192, s37, v192
v_mfma_f32_16x16x32_bf16 v[0:3], a[160:163], v[160:163], 0
s_add_u32 s35, s35, 16384
s_cmp_eq_u32 s30, 163840
s_cselect_b32 s30, 0, s30
v_mfma_f32_16x16x32_bf16 v[16:19], a[164:167], v[160:163], 0
v_exp_f32 v144, v144
v_mfma_f32_16x16x32_bf16 v[32:35], a[168:171], v[160:163], 0
s_cmp_eq_u32 s35, 163840
s_cselect_b32 s35, 0, s35
v_add_u32 v193, s37, v193
v_mfma_f32_16x16x32_bf16 v[48:51], a[172:175], v[160:163], 0
v_exp_f32 v145, v145
v_mfma_f32_16x16x32_bf16 v[64:67], a[176:179], v[160:163], 0
s_waitcnt lgkmcnt(0)
s_add_u32 m0, s30, s29
v_add_u32 v194, s37, v194
v_mfma_f32_16x16x32_bf16 v[80:83], a[180:183], v[160:163], 0
v_add_u32 v195, s37, v195
ds_read_b128 a[128:131], v192 offset:0
v_add_f32 v210, v210, v144
v_mfma_f32_16x16x32_bf16 v[96:99], a[184:187], v[160:163], 0
buffer_load_dwordx4 v204, s[12:15], s33 offen offset:0 nt lds
v_add_f32 v210, v210, v145
v_mfma_f32_16x16x32_bf16 v[112:115], a[188:191], v[160:163], 0
ds_read_b128 a[132:135], v193 offset:0
v_mfma_f32_16x16x32_bf16 v[4:7], a[160:163], v[164:167], 0
v_exp_f32 v146, v146
v_mfma_f32_16x16x32_bf16 v[20:23], a[164:167], v[164:167], 0
ds_read_b128 a[136:139], v194 offset:0
v_cvt_pk_bf16_f32 v160, v128, v129
v_mfma_f32_16x16x32_bf16 v[36:39], a[168:171], v[164:167], 0
v_exp_f32 v147, v147
v_mfma_f32_16x16x32_bf16 v[52:55], a[172:175], v[164:167], 0
ds_read_b128 a[140:143], v195 offset:0
v_cvt_pk_bf16_f32 v161, v130, v131
v_mfma_f32_16x16x32_bf16 v[68:71], a[176:179], v[164:167], 0
buffer_load_dwordx4 v205, s[12:15], s33 offen offset:1024 nt lds
v_cvt_pk_bf16_f32 v162, v144, v145
v_mfma_f32_16x16x32_bf16 v[84:87], a[180:183], v[164:167], 0
ds_read_b128 a[144:147], v192 offset:4096
v_add_f32 v210, v210, v146
v_mfma_f32_16x16x32_bf16 v[100:103], a[184:187], v[164:167], 0
v_exp_f32 v132, v132
v_mfma_f32_16x16x32_bf16 v[116:119], a[188:191], v[164:167], 0
ds_read_b128 a[148:151], v193 offset:4096
v_add_f32 v210, v210, v147
v_mfma_f32_16x16x32_bf16 v[8:11], a[160:163], v[168:171], 0
v_exp_f32 v133, v133
v_mfma_f32_16x16x32_bf16 v[24:27], a[164:167], v[168:171], 0
ds_read_b128 a[152:155], v194 offset:4096
v_cvt_pk_bf16_f32 v163, v146, v147
v_mfma_f32_16x16x32_bf16 v[40:43], a[168:171], v[168:171], 0
buffer_load_dwordx4 v206, s[12:15], s33 offen offset:2048 nt lds
v_add_f32 v211, v211, v132
v_mfma_f32_16x16x32_bf16 v[56:59], a[172:175], v[168:171], 0
ds_read_b128 a[156:159], v195 offset:4096
v_add_f32 v211, v211, v133
v_mfma_f32_16x16x32_bf16 v[72:75], a[176:179], v[168:171], 0
v_exp_f32 v134, v134
v_mfma_f32_16x16x32_bf16 v[88:91], a[180:183], v[168:171], 0
v_exp_f32 v135, v135
v_mfma_f32_16x16x32_bf16 v[104:107], a[184:187], v[168:171], 0
v_exp_f32 v148, v148
v_mfma_f32_16x16x32_bf16 v[120:123], a[188:191], v[168:171], 0
v_exp_f32 v149, v149
v_mfma_f32_16x16x32_bf16 v[12:15], a[160:163], v[172:175], 0
buffer_load_dwordx4 v207, s[12:15], s33 offen offset:3072 nt lds
v_cvt_pk_bf16_f32 v164, v132, v133
v_mfma_f32_16x16x32_bf16 v[28:31], a[164:167], v[172:175], 0
v_exp_f32 v150, v150
v_mfma_f32_16x16x32_bf16 v[44:47], a[168:171], v[172:175], 0
s_add_u32 s33, s33, 16384
v_exp_f32 v151, v151
v_mfma_f32_16x16x32_bf16 v[60:63], a[172:175], v[172:175], 0
v_exp_f32 v136, v136
v_mfma_f32_16x16x32_bf16 v[76:79], a[176:179], v[172:175], 0
s_add_u32 s30, s30, 16384
v_exp_f32 v137, v137
v_mfma_f32_16x16x32_bf16 v[92:95], a[180:183], v[172:175], 0
v_exp_f32 v138, v138
v_mfma_f32_16x16x32_bf16 v[108:111], a[184:187], v[172:175], 0
s_cmp_eq_u32 s30, 163840
s_cselect_b32 s30, 0, s30
v_add_f32 v211, v211, v134
v_mfma_f32_16x16x32_bf16 v[124:127], a[188:191], v[172:175], 0
s_waitcnt lgkmcnt(0)
v_exp_f32 v139, v139
v_mfma_f32_16x16x32_bf16 v[128:131], a[128:131], a[0:3], v[176:179]
s_barrier
v_exp_f32 v152, v152
v_mfma_f32_16x16x32_bf16 v[128:131], a[132:135], a[4:7], v[128:131]
ds_read_b64_tr_b16 a[160:161], v196 offset:8192
v_add_f32 v211, v211, v135
v_mfma_f32_16x16x32_bf16 v[128:131], a[136:139], a[8:11], v[128:131]
s_add_u32 m0, s30, s29
v_exp_f32 v153, v153
v_mfma_f32_16x16x32_bf16 v[128:131], a[140:143], a[12:15], v[128:131]
ds_read_b64_tr_b16 a[162:163], v196 offset:12288
v_cvt_pk_bf16_f32 v165, v134, v135
v_mfma_f32_16x16x32_bf16 v[144:147], a[144:147], a[0:3], v[176:179]
v_exp_f32 v154, v154
v_mfma_f32_16x16x32_bf16 v[144:147], a[148:151], a[4:7], v[144:147]
ds_read_b64_tr_b16 a[164:165], v197 offset:8192
v_add_f32 v211, v211, v148
v_mfma_f32_16x16x32_bf16 v[144:147], a[152:155], a[8:11], v[144:147]
v_exp_f32 v155, v155
v_mfma_f32_16x16x32_bf16 v[144:147], a[156:159], a[12:15], v[144:147]
ds_read_b64_tr_b16 a[166:167], v197 offset:12288
v_add_f32 v211, v211, v149
v_cvt_pk_bf16_f32 v166, v148, v149
v_add_f32 v211, v211, v150
v_add_f32 v211, v211, v151
v_cvt_pk_bf16_f32 v167, v150, v151
v_mfma_f32_16x16x32_bf16 v[132:135], a[128:131], a[16:19], v[180:183]
buffer_load_dwordx4 v208, s[16:19], s34 offen offset:0 nt lds
v_add_f32 v212, v212, v136
v_mfma_f32_16x16x32_bf16 v[132:135], a[132:135], a[20:23], v[132:135]
ds_read_b64_tr_b16 a[168:169], v198 offset:8192
v_add_f32 v212, v212, v137
v_mfma_f32_16x16x32_bf16 v[132:135], a[136:139], a[24:27], v[132:135]
v_exp_f32 v140, v140
v_mfma_f32_16x16x32_bf16 v[132:135], a[140:143], a[28:31], v[132:135]
ds_read_b64_tr_b16 a[170:171], v198 offset:12288
v_cvt_pk_bf16_f32 v168, v136, v137
v_mfma_f32_16x16x32_bf16 v[148:151], a[144:147], a[16:19], v[180:183]
v_exp_f32 v141, v141
v_mfma_f32_16x16x32_bf16 v[148:151], a[148:151], a[20:23], v[148:151]
ds_read_b64_tr_b16 a[172:173], v199 offset:8192
v_add_f32 v212, v212, v138
v_mfma_f32_16x16x32_bf16 v[148:151], a[152:155], a[24:27], v[148:151]
v_exp_f32 v142, v142
v_mfma_f32_16x16x32_bf16 v[148:151], a[156:159], a[28:31], v[148:151]
ds_read_b64_tr_b16 a[174:175], v199 offset:12288
v_add_f32 v212, v212, v139
v_cvt_pk_bf16_f32 v169, v138, v139
v_add_f32 v212, v212, v152
v_add_f32 v212, v212, v153
v_cvt_pk_bf16_f32 v170, v152, v153
v_add_f32 v212, v212, v154
v_add_f32 v212, v212, v155
v_cvt_pk_bf16_f32 v171, v154, v155
v_mfma_f32_16x16x32_bf16 v[136:139], a[128:131], a[32:35], v[184:187]
v_exp_f32 v143, v143
v_mfma_f32_16x16x32_bf16 v[136:139], a[132:135], a[36:39], v[136:139]
ds_read_b64_tr_b16 a[176:177], v200 offset:8192
v_add_f32 v213, v213, v140
v_mfma_f32_16x16x32_bf16 v[136:139], a[136:139], a[40:43], v[136:139]
v_exp_f32 v156, v156
v_mfma_f32_16x16x32_bf16 v[136:139], a[140:143], a[44:47], v[136:139]
ds_read_b64_tr_b16 a[178:179], v200 offset:12288
v_add_f32 v213, v213, v141
v_mfma_f32_16x16x32_bf16 v[152:155], a[144:147], a[32:35], v[184:187]
v_exp_f32 v157, v157
v_mfma_f32_16x16x32_bf16 v[152:155], a[148:151], a[36:39], v[152:155]
ds_read_b64_tr_b16 a[180:181], v201 offset:8192
v_cvt_pk_bf16_f32 v172, v140, v141
v_mfma_f32_16x16x32_bf16 v[152:155], a[152:155], a[40:43], v[152:155]
v_exp_f32 v158, v158
v_mfma_f32_16x16x32_bf16 v[152:155], a[156:159], a[44:47], v[152:155]
ds_read_b64_tr_b16 a[182:183], v201 offset:12288
v_add_f32 v213, v213, v142
v_add_f32 v213, v213, v143
v_cvt_pk_bf16_f32 v173, v142, v143
v_add_f32 v213, v213, v156
v_add_f32 v213, v213, v157
v_cvt_pk_bf16_f32 v174, v156, v157
v_add_f32 v213, v213, v158
v_exp_f32 v159, v159
s_nop 0
v_add_f32 v213, v213, v159
v_cvt_pk_bf16_f32 v175, v158, v159
v_mfma_f32_16x16x32_bf16 v[140:143], a[128:131], a[48:51], v[188:191]
buffer_load_dwordx4 v209, s[16:19], s34 offen offset:1024 nt lds
v_mfma_f32_16x16x32_bf16 v[140:143], a[132:135], a[52:55], v[140:143]
ds_read_b64_tr_b16 a[184:185], v202 offset:8192
v_mfma_f32_16x16x32_bf16 v[140:143], a[136:139], a[56:59], v[140:143]
v_exp_f32 v128, v128
v_mfma_f32_16x16x32_bf16 v[140:143], a[140:143], a[60:63], v[140:143]
ds_read_b64_tr_b16 a[186:187], v202 offset:12288
v_add_f32 v210, v210, v128
v_mfma_f32_16x16x32_bf16 v[156:159], a[144:147], a[48:51], v[188:191]
s_waitcnt lgkmcnt(4)
v_exp_f32 v129, v129
v_mfma_f32_16x16x32_bf16 v[156:159], a[148:151], a[52:55], v[156:159]
ds_read_b64_tr_b16 a[188:189], v203 offset:8192
v_add_f32 v210, v210, v129
v_mfma_f32_16x16x32_bf16 v[156:159], a[152:155], a[56:59], v[156:159]
v_exp_f32 v130, v130
v_mfma_f32_16x16x32_bf16 v[156:159], a[156:159], a[60:63], v[156:159]
ds_read_b64_tr_b16 a[190:191], v203 offset:12288
v_add_f32 v210, v210, v130
v_mfma_f32_16x16x32_bf16 v[0:3], a[160:163], v[160:163], v[0:3]
v_exp_f32 v131, v131
v_mfma_f32_16x16x32_bf16 v[16:19], a[164:167], v[160:163], v[16:19]
v_exp_f32 v144, v144
v_mfma_f32_16x16x32_bf16 v[32:35], a[168:171], v[160:163], v[32:35]
v_exp_f32 v145, v145
v_mfma_f32_16x16x32_bf16 v[48:51], a[172:175], v[160:163], v[48:51]
v_exp_f32 v146, v146
v_mfma_f32_16x16x32_bf16 v[64:67], a[176:179], v[160:163], v[64:67]
s_waitcnt lgkmcnt(0)
v_exp_f32 v147, v147
v_mfma_f32_16x16x32_bf16 v[80:83], a[180:183], v[160:163], v[80:83]
ds_read_b128 a[128:131], v192 offset:8192
v_add_f32 v210, v210, v131
v_mfma_f32_16x16x32_bf16 v[96:99], a[184:187], v[160:163], v[96:99]
v_exp_f32 v132, v132
v_mfma_f32_16x16x32_bf16 v[112:115], a[188:191], v[160:163], v[112:115]
ds_read_b128 a[132:135], v193 offset:8192
v_add_f32 v210, v210, v144
v_mfma_f32_16x16x32_bf16 v[4:7], a[160:163], v[164:167], v[4:7]
buffer_load_dwordx4 v208, s[16:19], s34 offen offset:2048 nt lds
v_cvt_pk_bf16_f32 v160, v128, v129
v_mfma_f32_16x16x32_bf16 v[20:23], a[164:167], v[164:167], v[20:23]
ds_read_b128 a[136:139], v194 offset:8192
v_cvt_pk_bf16_f32 v161, v130, v131
v_mfma_f32_16x16x32_bf16 v[36:39], a[168:171], v[164:167], v[36:39]
v_exp_f32 v133, v133
v_mfma_f32_16x16x32_bf16 v[52:55], a[172:175], v[164:167], v[52:55]
ds_read_b128 a[140:143], v195 offset:8192
v_add_f32 v210, v210, v145
v_mfma_f32_16x16x32_bf16 v[68:71], a[176:179], v[164:167], v[68:71]
v_exp_f32 v134, v134
v_mfma_f32_16x16x32_bf16 v[84:87], a[180:183], v[164:167], v[84:87]
ds_read_b128 a[144:147], v192 offset:12288
v_cvt_pk_bf16_f32 v162, v144, v145
v_mfma_f32_16x16x32_bf16 v[100:103], a[184:187], v[164:167], v[100:103]
v_exp_f32 v135, v135
v_mfma_f32_16x16x32_bf16 v[116:119], a[188:191], v[164:167], v[116:119]
ds_read_b128 a[148:151], v193 offset:12288
v_add_f32 v210, v210, v146
v_mfma_f32_16x16x32_bf16 v[8:11], a[160:163], v[168:171], v[8:11]
s_sub_u32 s37, s35, s49
s_mov_b32 s49, s35
v_add_f32 v210, v210, v147
v_mfma_f32_16x16x32_bf16 v[24:27], a[164:167], v[168:171], v[24:27]
ds_read_b128 a[152:155], v194 offset:12288
v_cvt_pk_bf16_f32 v163, v146, v147
v_mfma_f32_16x16x32_bf16 v[40:43], a[168:171], v[168:171], v[40:43]
s_add_u32 s35, s35, 16384
v_exp_f32 v148, v148
v_mfma_f32_16x16x32_bf16 v[56:59], a[172:175], v[168:171], v[56:59]
ds_read_b128 a[156:159], v195 offset:12288
v_add_f32 v211, v211, v132
v_mfma_f32_16x16x32_bf16 v[72:75], a[176:179], v[168:171], v[72:75]
s_cmp_eq_u32 s35, 163840
s_cselect_b32 s35, 0, s35
v_add_f32 v211, v211, v133
v_mfma_f32_16x16x32_bf16 v[88:91], a[180:183], v[168:171], v[88:91]
v_exp_f32 v149, v149
v_mfma_f32_16x16x32_bf16 v[104:107], a[184:187], v[168:171], v[104:107]
v_exp_f32 v150, v150
v_mfma_f32_16x16x32_bf16 v[120:123], a[188:191], v[168:171], v[120:123]
v_exp_f32 v151, v151
v_mfma_f32_16x16x32_bf16 v[12:15], a[160:163], v[172:175], v[12:15]
buffer_load_dwordx4 v209, s[16:19], s34 offen offset:3072 nt lds
v_cvt_pk_bf16_f32 v164, v132, v133
v_mfma_f32_16x16x32_bf16 v[28:31], a[164:167], v[172:175], v[28:31]
v_exp_f32 v136, v136
v_mfma_f32_16x16x32_bf16 v[44:47], a[168:171], v[172:175], v[44:47]
s_add_u32 s34, s34, 16384
v_exp_f32 v137, v137
v_mfma_f32_16x16x32_bf16 v[60:63], a[172:175], v[172:175], v[60:63]
v_exp_f32 v138, v138
v_mfma_f32_16x16x32_bf16 v[76:79], a[176:179], v[172:175], v[76:79]
s_add_u32 s30, s30, 16384
v_exp_f32 v139, v139
v_mfma_f32_16x16x32_bf16 v[92:95], a[180:183], v[172:175], v[92:95]
v_exp_f32 v152, v152
v_mfma_f32_16x16x32_bf16 v[108:111], a[184:187], v[172:175], v[108:111]
s_cmp_eq_u32 s30, 163840
s_cselect_b32 s30, 0, s30
v_add_f32 v211, v211, v134
v_mfma_f32_16x16x32_bf16 v[124:127], a[188:191], v[172:175], v[124:127]
s_waitcnt lgkmcnt(0)
v_exp_f32 v153, v153
v_add_u32 v196, s37, v196
v_add_u32 v197, s37, v197
v_add_u32 v198, s37, v198
v_add_u32 v199, s37, v199
v_add_u32 v200, s37, v200
v_add_u32 v201, s37, v201
v_add_u32 v202, s37, v202
v_add_u32 v203, s37, v203
v_mfma_f32_16x16x32_bf16 v[128:131], a[128:131], a[0:3], v[176:179]
s_waitcnt vmcnt(20)
s_barrier
s_mov_b32 s60, s98
s_and_b32 s61, s99, 0xffff
s_mov_b32 s62, 256
s_mov_b32 s63, 0x20000
s_cmp_lg_u32 s28, 0
s_cbranch_scc1 L_sigw
v_mov_b32 v250, 1
v_mov_b32 v251, 0
s_mov_b64 exec, 1
buffer_atomic_add v250, v251, s[60:63], 0 offen sc0 sc1
s_mov_b64 exec, -1
L_sigw:
v_exp_f32 v154, v154
v_mfma_f32_16x16x32_bf16 v[128:131], a[132:135], a[4:7], v[128:131]
ds_read_b64_tr_b16 a[160:161], v196 offset:0
v_add_f32 v211, v211, v135
v_mfma_f32_16x16x32_bf16 v[128:131], a[136:139], a[8:11], v[128:131]
s_add_u32 m0, s30, s29
v_exp_f32 v155, v155
v_mfma_f32_16x16x32_bf16 v[128:131], a[140:143], a[12:15], v[128:131]
ds_read_b64_tr_b16 a[162:163], v196 offset:4096
v_cvt_pk_bf16_f32 v165, v134, v135
v_mfma_f32_16x16x32_bf16 v[144:147], a[144:147], a[0:3], v[176:179]
v_exp_f32 v140, v140
v_mfma_f32_16x16x32_bf16 v[144:147], a[148:151], a[4:7], v[144:147]
ds_read_b64_tr_b16 a[164:165], v197 offset:0
v_add_f32 v211, v211, v148
v_mfma_f32_16x16x32_bf16 v[144:147], a[152:155], a[8:11], v[144:147]
v_exp_f32 v141, v141
v_mfma_f32_16x16x32_bf16 v[144:147], a[156:159], a[12:15], v[144:147]
ds_read_b64_tr_b16 a[166:167], v197 offset:4096
v_add_f32 v211, v211, v149
v_cvt_pk_bf16_f32 v166, v148, v149
v_add_f32 v211, v211, v150
v_add_f32 v211, v211, v151
v_cvt_pk_bf16_f32 v167, v150, v151
v_mfma_f32_16x16x32_bf16 v[132:135], a[128:131], a[16:19], v[180:183]
buffer_load_dwordx4 v204, s[12:15], s33 offen offset:0 nt lds
v_add_f32 v212, v212, v136
v_mfma_f32_16x16x32_bf16 v[132:135], a[132:135], a[20:23], v[132:135]
ds_read_b64_tr_b16 a[168:169], v198 offset:0
v_add_f32 v212, v212, v137
v_mfma_f32_16x16x32_bf16 v[132:135], a[136:139], a[24:27], v[132:135]
v_exp_f32 v142, v142
v_mfma_f32_16x16x32_bf16 v[132:135], a[140:143], a[28:31], v[132:135]
ds_read_b64_tr_b16 a[170:171], v198 offset:4096
v_cvt_pk_bf16_f32 v168, v136, v137
v_mfma_f32_16x16x32_bf16 v[148:151], a[144:147], a[16:19], v[180:183]
v_exp_f32 v143, v143
v_mfma_f32_16x16x32_bf16 v[148:151], a[148:151], a[20:23], v[148:151]
ds_read_b64_tr_b16 a[172:173], v199 offset:0
v_add_f32 v212, v212, v138
v_mfma_f32_16x16x32_bf16 v[148:151], a[152:155], a[24:27], v[148:151]
v_exp_f32 v156, v156
v_mfma_f32_16x16x32_bf16 v[148:151], a[156:159], a[28:31], v[148:151]
ds_read_b64_tr_b16 a[174:175], v199 offset:4096
v_add_f32 v212, v212, v139
v_cvt_pk_bf16_f32 v169, v138, v139
v_add_f32 v212, v212, v152
v_add_f32 v212, v212, v153
v_cvt_pk_bf16_f32 v170, v152, v153
v_add_f32 v212, v212, v154
v_add_f32 v212, v212, v155
v_cvt_pk_bf16_f32 v171, v154, v155
v_mfma_f32_16x16x32_bf16 v[136:139], a[128:131], a[32:35], v[184:187]
v_exp_f32 v157, v157
v_mfma_f32_16x16x32_bf16 v[136:139], a[132:135], a[36:39], v[136:139]
ds_read_b64_tr_b16 a[176:177], v200 offset:0
v_add_f32 v213, v213, v140
v_mfma_f32_16x16x32_bf16 v[136:139], a[136:139], a[40:43], v[136:139]
v_exp_f32 v158, v158
v_mfma_f32_16x16x32_bf16 v[136:139], a[140:143], a[44:47], v[136:139]
ds_read_b64_tr_b16 a[178:179], v200 offset:4096
v_add_f32 v213, v213, v141
v_mfma_f32_16x16x32_bf16 v[152:155], a[144:147], a[32:35], v[184:187]
v_exp_f32 v159, v159
v_mfma_f32_16x16x32_bf16 v[152:155], a[148:151], a[36:39], v[152:155]
ds_read_b64_tr_b16 a[180:181], v201 offset:0
v_cvt_pk_bf16_f32 v172, v140, v141
v_mfma_f32_16x16x32_bf16 v[152:155], a[152:155], a[40:43], v[152:155]
v_exp_f32 v128, v128
v_mfma_f32_16x16x32_bf16 v[152:155], a[156:159], a[44:47], v[152:155]
ds_read_b64_tr_b16 a[182:183], v201 offset:4096
v_add_f32 v213, v213, v142
v_add_f32 v213, v213, v143
v_cvt_pk_bf16_f32 v173, v142, v143
v_add_f32 v213, v213, v156
v_add_f32 v213, v213, v157
v_cvt_pk_bf16_f32 v174, v156, v157
v_add_f32 v213, v213, v158
v_add_f32 v213, v213, v159
v_cvt_pk_bf16_f32 v175, v158, v159
v_mfma_f32_16x16x32_bf16 v[140:143], a[128:131], a[48:51], v[188:191]
buffer_load_dwordx4 v205, s[12:15], s33 offen offset:1024 nt lds
v_add_f32 v210, v210, v128
v_mfma_f32_16x16x32_bf16 v[140:143], a[132:135], a[52:55], v[140:143]
ds_read_b64_tr_b16 a[184:185], v202 offset:0
v_mfma_f32_16x16x32_bf16 v[140:143], a[136:139], a[56:59], v[140:143]
v_exp_f32 v129, v129
v_mfma_f32_16x16x32_bf16 v[140:143], a[140:143], a[60:63], v[140:143]
ds_read_b64_tr_b16 a[186:187], v202 offset:4096
v_add_f32 v210, v210, v129
v_mfma_f32_16x16x32_bf16 v[156:159], a[144:147], a[48:51], v[188:191]
s_waitcnt lgkmcnt(4)
v_exp_f32 v130, v130
v_mfma_f32_16x16x32_bf16 v[156:159], a[148:151], a[52:55], v[156:159]
ds_read_b64_tr_b16 a[188:189], v203 offset:0
v_add_f32 v210, v210, v130
v_mfma_f32_16x16x32_bf16 v[156:159], a[152:155], a[56:59], v[156:159]
s_sub_u32 s37, s35, s48
s_mov_b32 s48, s35
v_mfma_f32_16x16x32_bf16 v[156:159], a[156:159], a[60:63], v[156:159]
ds_read_b64_tr_b16 a[190:191], v203 offset:4096
v_add_u32 v192, s37, v192
v_mfma_f32_16x16x32_bf16 v[0:3], a[160:163], v[160:163], v[0:3]
s_add_u32 s35, s35, 16384
v_exp_f32 v131, v131
v_mfma_f32_16x16x32_bf16 v[16:19], a[164:167], v[160:163], v[16:19]
v_exp_f32 v144, v144
v_mfma_f32_16x16x32_bf16 v[32:35], a[168:171], v[160:163], v[32:35]
s_cmp_eq_u32 s35, 163840
s_cselect_b32 s35, 0, s35
v_add_u32 v193, s37, v193
v_mfma_f32_16x16x32_bf16 v[48:51], a[172:175], v[160:163], v[48:51]
v_exp_f32 v145, v145
v_mfma_f32_16x16x32_bf16 v[64:67], a[176:179], v[160:163], v[64:67]
s_waitcnt lgkmcnt(0)
v_exp_f32 v146, v146
v_mfma_f32_16x16x32_bf16 v[80:83], a[180:183], v[160:163], v[80:83]
v_add_u32 v194, s37, v194
v_add_u32 v195, s37, v195
ds_read_b128 a[128:131], v192 offset:0
v_add_f32 v210, v210, v131
v_mfma_f32_16x16x32_bf16 v[96:99], a[184:187], v[160:163], v[96:99]
v_exp_f32 v147, v147
v_mfma_f32_16x16x32_bf16 v[112:115], a[188:191], v[160:163], v[112:115]
ds_read_b128 a[132:135], v193 offset:0
v_add_f32 v210, v210, v144
v_mfma_f32_16x16x32_bf16 v[4:7], a[160:163], v[164:167], v[4:7]
buffer_load_dwordx4 v206, s[12:15], s33 offen offset:2048 nt lds
v_cvt_pk_bf16_f32 v160, v128, v129
v_mfma_f32_16x16x32_bf16 v[20:23], a[164:167], v[164:167], v[20:23]
ds_read_b128 a[136:139], v194 offset:0
v_cvt_pk_bf16_f32 v161, v130, v131
v_mfma_f32_16x16x32_bf16 v[36:39], a[168:171], v[164:167], v[36:39]
v_exp_f32 v132, v132
v_mfma_f32_16x16x32_bf16 v[52:55], a[172:175], v[164:167], v[52:55]
ds_read_b128 a[140:143], v195 offset:0
v_add_f32 v210, v210, v145
v_mfma_f32_16x16x32_bf16 v[68:71], a[176:179], v[164:167], v[68:71]
v_exp_f32 v133, v133
v_mfma_f32_16x16x32_bf16 v[84:87], a[180:183], v[164:167], v[84:87]
ds_read_b128 a[144:147], v192 offset:4096
v_cvt_pk_bf16_f32 v162, v144, v145
v_mfma_f32_16x16x32_bf16 v[100:103], a[184:187], v[164:167], v[100:103]
v_exp_f32 v134, v134
v_mfma_f32_16x16x32_bf16 v[116:119], a[188:191], v[164:167], v[116:119]
ds_read_b128 a[148:151], v193 offset:4096
v_add_f32 v210, v210, v146
v_mfma_f32_16x16x32_bf16 v[8:11], a[160:163], v[168:171], v[8:11]
v_exp_f32 v135, v135
v_mfma_f32_16x16x32_bf16 v[24:27], a[164:167], v[168:171], v[24:27]
ds_read_b128 a[152:155], v194 offset:4096
v_add_f32 v210, v210, v147
v_mfma_f32_16x16x32_bf16 v[40:43], a[168:171], v[168:171], v[40:43]
v_exp_f32 v148, v148
v_mfma_f32_16x16x32_bf16 v[56:59], a[172:175], v[168:171], v[56:59]
ds_read_b128 a[156:159], v195 offset:4096
v_cvt_pk_bf16_f32 v163, v146, v147
v_mfma_f32_16x16x32_bf16 v[72:75], a[176:179], v[168:171], v[72:75]
v_exp_f32 v149, v149
v_mfma_f32_16x16x32_bf16 v[88:91], a[180:183], v[168:171], v[88:91]
v_exp_f32 v150, v150
v_mfma_f32_16x16x32_bf16 v[104:107], a[184:187], v[168:171], v[104:107]
v_exp_f32 v151, v151
v_mfma_f32_16x16x32_bf16 v[120:123], a[188:191], v[168:171], v[120:123]
v_exp_f32 v136, v136
v_mfma_f32_16x16x32_bf16 v[12:15], a[160:163], v[172:175], v[12:15]
buffer_load_dwordx4 v207, s[12:15], s33 offen offset:3072 nt lds
v_add_f32 v211, v211, v132
v_mfma_f32_16x16x32_bf16 v[28:31], a[164:167], v[172:175], v[28:31]
v_exp_f32 v137, v137
v_mfma_f32_16x16x32_bf16 v[44:47], a[168:171], v[172:175], v[44:47]
s_add_u32 s33, s33, 16384
v_exp_f32 v138, v138
v_mfma_f32_16x16x32_bf16 v[60:63], a[172:175], v[172:175], v[60:63]
v_exp_f32 v139, v139
v_mfma_f32_16x16x32_bf16 v[76:79], a[176:179], v[172:175], v[76:79]
s_add_u32 s30, s30, 16384
v_exp_f32 v152, v152
v_mfma_f32_16x16x32_bf16 v[92:95], a[180:183], v[172:175], v[92:95]
v_exp_f32 v153, v153
v_mfma_f32_16x16x32_bf16 v[108:111], a[184:187], v[172:175], v[108:111]
s_cmp_eq_u32 s30, 163840
s_cselect_b32 s30, 0, s30
v_add_f32 v211, v211, v133
v_mfma_f32_16x16x32_bf16 v[124:127], a[188:191], v[172:175], v[124:127]
s_waitcnt lgkmcnt(0)
v_exp_f32 v154, v154
v_cvt_pk_bf16_f32 v164, v132, v133
v_add_f32 v211, v211, v134
v_exp_f32 v155, v155
v_exp_f32 v140, v140
v_exp_f32 v141, v141
v_exp_f32 v142, v142
v_exp_f32 v143, v143
v_exp_f32 v156, v156
s_nop 1
s_mov_b32 s40, 6
L_loop1:
v_mfma_f32_16x16x32_bf16 v[128:131], a[128:131], a[0:3], v[176:179]
s_barrier
v_exp_f32 v157, v157
v_mfma_f32_16x16x32_bf16 v[128:131], a[132:135], a[4:7], v[128:131]
ds_read_b64_tr_b16 a[160:161], v196 offset:8192
v_add_f32 v211, v211, v135
v_mfma_f32_16x16x32_bf16 v[128:131], a[136:139], a[8:11], v[128:131]
s_add_u32 m0, s30, s29
v_exp_f32 v158, v158
v_mfma_f32_16x16x32_bf16 v[128:131], a[140:143], a[12:15], v[128:131]
ds_read_b64_tr_b16 a[162:163], v196 offset:12288
v_cvt_pk_bf16_f32 v165, v134, v135
v_mfma_f32_16x16x32_bf16 v[144:147], a[144:147], a[0:3], v[176:179]
v_exp_f32 v159, v159
v_mfma_f32_16x16x32_bf16 v[144:147], a[148:151], a[4:7], v[144:147]
ds_read_b64_tr_b16 a[164:165], v197 offset:8192
v_add_f32 v211, v211, v148
v_mfma_f32_16x16x32_bf16 v[144:147], a[152:155], a[8:11], v[144:147]
v_add_f32 v211, v211, v149
v_cvt_pk_bf16_f32 v166, v148, v149
v_mfma_f32_16x16x32_bf16 v[144:147], a[156:159], a[12:15], v[144:147]
ds_read_b64_tr_b16 a[166:167], v197 offset:12288
v_add_f32 v211, v211, v150
v_add_f32 v211, v211, v151
v_cvt_pk_bf16_f32 v167, v150, v151
v_mfma_f32_16x16x32_bf16 v[132:135], a[128:131], a[16:19], v[180:183]
buffer_load_dwordx4 v208, s[16:19], s34 offen offset:0 nt lds
v_add_f32 v212, v212, v136
v_mfma_f32_16x16x32_bf16 v[132:135], a[132:135], a[20:23], v[132:135]
ds_read_b64_tr_b16 a[168:169], v198 offset:8192
v_add_f32 v212, v212, v137
v_mfma_f32_16x16x32_bf16 v[132:135], a[136:139], a[24:27], v[132:135]
v_exp_f32 v128, v128
v_mfma_f32_16x16x32_bf16 v[132:135], a[140:143], a[28:31], v[132:135]
ds_read_b64_tr_b16 a[170:171], v198 offset:12288
v_cvt_pk_bf16_f32 v168, v136, v137
v_mfma_f32_16x16x32_bf16 v[148:151], a[144:147], a[16:19], v[180:183]
v_exp_f32 v129, v129
v_mfma_f32_16x16x32_bf16 v[148:151], a[148:151], a[20:23], v[148:151]
ds_read_b64_tr_b16 a[172:173], v199 offset:8192
v_add_f32 v212, v212, v138
v_mfma_f32_16x16x32_bf16 v[148:151], a[152:155], a[24:27], v[148:151]
v_exp_f32 v130, v130
v_mfma_f32_16x16x32_bf16 v[148:151], a[156:159], a[28:31], v[148:151]
ds_read_b64_tr_b16 a[174:175], v199 offset:12288
v_add_f32 v212, v212, v139
v_cvt_pk_bf16_f32 v169, v138, v139
v_add_f32 v212, v212, v152
v_add_f32 v212, v212, v153
v_cvt_pk_bf16_f32 v170, v152, v153
v_add_f32 v212, v212, v154
v_add_f32 v212, v212, v155
v_cvt_pk_bf16_f32 v171, v154, v155
v_mfma_f32_16x16x32_bf16 v[136:139], a[128:131], a[32:35], v[184:187]
v_exp_f32 v131, v131
v_mfma_f32_16x16x32_bf16 v[136:139], a[132:135], a[36:39], v[136:139]
ds_read_b64_tr_b16 a[176:177], v200 offset:8192
v_add_f32 v213, v213, v140
v_mfma_f32_16x16x32_bf16 v[136:139], a[136:139], a[40:43], v[136:139]
v_exp_f32 v144, v144
v_mfma_f32_16x16x32_bf16 v[136:139], a[140:143], a[44:47], v[136:139]
ds_read_b64_tr_b16 a[178:179], v200 offset:12288
v_add_f32 v213, v213, v141
v_mfma_f32_16x16x32_bf16 v[152:155], a[144:147], a[32:35], v[184:187]
v_exp_f32 v145, v145
v_mfma_f32_16x16x32_bf16 v[152:155], a[148:151], a[36:39], v[152:155]
ds_read_b64_tr_b16 a[180:181], v201 offset:8192
v_cvt_pk_bf16_f32 v172, v140, v141
v_mfma_f32_16x16x32_bf16 v[152:155], a[152:155], a[40:43], v[152:155]
v_exp_f32 v146, v146
v_mfma_f32_16x16x32_bf16 v[152:155], a[156:159], a[44:47], v[152:155]
ds_read_b64_tr_b16 a[182:183], v201 offset:12288
v_add_f32 v213, v213, v142
v_add_f32 v213, v213, v143
v_cvt_pk_bf16_f32 v173, v142, v143
v_add_f32 v213, v213, v156
v_add_f32 v213, v213, v157
v_cvt_pk_bf16_f32 v174, v156, v157
v_add_f32 v213, v213, v158
v_add_f32 v213, v213, v159
v_cvt_pk_bf16_f32 v175, v158, v159
v_mfma_f32_16x16x32_bf16 v[140:143], a[128:131], a[48:51], v[188:191]
buffer_load_dwordx4 v209, s[16:19], s34 offen offset:1024 nt lds
v_add_f32 v210, v210, v128
v_mfma_f32_16x16x32_bf16 v[140:143], a[132:135], a[52:55], v[140:143]
ds_read_b64_tr_b16 a[184:185], v202 offset:8192
v_add_f32 v210, v210, v129
v_mfma_f32_16x16x32_bf16 v[140:143], a[136:139], a[56:59], v[140:143]
v_exp_f32 v147, v147
v_mfma_f32_16x16x32_bf16 v[140:143], a[140:143], a[60:63], v[140:143]
ds_read_b64_tr_b16 a[186:187], v202 offset:12288
v_add_f32 v210, v210, v130
v_mfma_f32_16x16x32_bf16 v[156:159], a[144:147], a[48:51], v[188:191]
s_waitcnt lgkmcnt(4)
v_exp_f32 v132, v132
v_mfma_f32_16x16x32_bf16 v[156:159], a[148:151], a[52:55], v[156:159]
ds_read_b64_tr_b16 a[188:189], v203 offset:8192
v_add_f32 v210, v210, v131
v_mfma_f32_16x16x32_bf16 v[156:159], a[152:155], a[56:59], v[156:159]
v_exp_f32 v133, v133
v_mfma_f32_16x16x32_bf16 v[156:159], a[156:159], a[60:63], v[156:159]
ds_read_b64_tr_b16 a[190:191], v203 offset:12288
v_add_f32 v210, v210, v144
v_mfma_f32_16x16x32_bf16 v[0:3], a[160:163], v[160:163], v[0:3]
v_exp_f32 v134, v134
v_mfma_f32_16x16x32_bf16 v[16:19], a[164:167], v[160:163], v[16:19]
v_exp_f32 v135, v135
v_mfma_f32_16x16x32_bf16 v[32:35], a[168:171], v[160:163], v[32:35]
v_exp_f32 v148, v148
v_mfma_f32_16x16x32_bf16 v[48:51], a[172:175], v[160:163], v[48:51]
v_exp_f32 v149, v149
v_mfma_f32_16x16x32_bf16 v[64:67], a[176:179], v[160:163], v[64:67]
s_waitcnt lgkmcnt(0)
v_exp_f32 v150, v150
v_mfma_f32_16x16x32_bf16 v[80:83], a[180:183], v[160:163], v[80:83]
ds_read_b128 a[128:131], v192 offset:8192
v_add_f32 v210, v210, v145
v_mfma_f32_16x16x32_bf16 v[96:99], a[184:187], v[160:163], v[96:99]
v_exp_f32 v151, v151
v_mfma_f32_16x16x32_bf16 v[112:115], a[188:191], v[160:163], v[112:115]
ds_read_b128 a[132:135], v193 offset:8192
v_add_f32 v210, v210, v146
v_mfma_f32_16x16x32_bf16 v[4:7], a[160:163], v[164:167], v[4:7]
buffer_load_dwordx4 v208, s[16:19], s34 offen offset:2048 nt lds
v_cvt_pk_bf16_f32 v160, v128, v129
v_mfma_f32_16x16x32_bf16 v[20:23], a[164:167], v[164:167], v[20:23]
ds_read_b128 a[136:139], v194 offset:8192
v_cvt_pk_bf16_f32 v161, v130, v131
v_mfma_f32_16x16x32_bf16 v[36:39], a[168:171], v[164:167], v[36:39]
v_exp_f32 v136, v136
v_mfma_f32_16x16x32_bf16 v[52:55], a[172:175], v[164:167], v[52:55]
ds_read_b128 a[140:143], v195 offset:8192
v_cvt_pk_bf16_f32 v162, v144, v145
v_mfma_f32_16x16x32_bf16 v[68:71], a[176:179], v[164:167], v[68:71]
v_exp_f32 v137, v137
v_mfma_f32_16x16x32_bf16 v[84:87], a[180:183], v[164:167], v[84:87]
ds_read_b128 a[144:147], v192 offset:12288
v_add_f32 v210, v210, v147
v_mfma_f32_16x16x32_bf16 v[100:103], a[184:187], v[164:167], v[100:103]
v_exp_f32 v138, v138
v_mfma_f32_16x16x32_bf16 v[116:119], a[188:191], v[164:167], v[116:119]
ds_read_b128 a[148:151], v193 offset:12288
v_cvt_pk_bf16_f32 v163, v146, v147
v_mfma_f32_16x16x32_bf16 v[8:11], a[160:163], v[168:171], v[8:11]
s_sub_u32 s37, s35, s49
s_mov_b32 s49, s35
v_add_f32 v211, v211, v132
v_mfma_f32_16x16x32_bf16 v[24:27], a[164:167], v[168:171], v[24:27]
ds_read_b128 a[152:155], v194 offset:12288
v_add_f32 v211, v211, v133
v_mfma_f32_16x16x32_bf16 v[40:43], a[168:171], v[168:171], v[40:43]
s_add_u32 s35, s35, 16384
v_exp_f32 v139, v139
v_mfma_f32_16x16x32_bf16 v[56:59], a[172:175], v[168:171], v[56:59]
ds_read_b128 a[156:159], v195 offset:12288
v_cvt_pk_bf16_f32 v164, v132, v133
v_mfma_f32_16x16x32_bf16 v[72:75], a[176:179], v[168:171], v[72:75]
s_cmp_eq_u32 s35, 163840
s_cselect_b32 s35, 0, s35
v_add_f32 v211, v211, v134
v_mfma_f32_16x16x32_bf16 v[88:91], a[180:183], v[168:171], v[88:91]
v_exp_f32 v152, v152
v_mfma_f32_16x16x32_bf16 v[104:107], a[184:187], v[168:171], v[104:107]
v_exp_f32 v153, v153
v_mfma_f32_16x16x32_bf16 v[120:123], a[188:191], v[168:171], v[120:123]
v_exp_f32 v154, v154
v_mfma_f32_16x16x32_bf16 v[12:15], a[160:163], v[172:175], v[12:15]
buffer_load_dwordx4 v209, s[16:19], s34 offen offset:3072 nt lds
v_add_f32 v211, v211, v135
v_mfma_f32_16x16x32_bf16 v[28:31], a[164:167], v[172:175], v[28:31]
v_exp_f32 v155, v155
v_mfma_f32_16x16x32_bf16 v[44:47], a[168:171], v[172:175], v[44:47]
s_add_u32 s34, s34, 16384
v_exp_f32 v140, v140
v_mfma_f32_16x16x32_bf16 v[60:63], a[172:175], v[172:175], v[60:63]
v_exp_f32 v141, v141
v_mfma_f32_16x16x32_bf16 v[76:79], a[176:179], v[172:175], v[76:79]
s_add_u32 s30, s30, 16384
v_exp_f32 v142, v142
v_mfma_f32_16x16x32_bf16 v[92:95], a[180:183], v[172:175], v[92:95]
v_exp_f32 v143, v143
v_mfma_f32_16x16x32_bf16 v[108:111], a[184:187], v[172:175], v[108:111]
s_cmp_eq_u32 s30, 163840
s_cselect_b32 s30, 0, s30
v_cvt_pk_bf16_f32 v165, v134, v135
v_mfma_f32_16x16x32_bf16 v[124:127], a[188:191], v[172:175], v[124:127]
s_waitcnt lgkmcnt(0)
v_exp_f32 v156, v156
v_add_u32 v196, s37, v196
v_add_u32 v197, s37, v197
v_add_u32 v198, s37, v198
v_add_u32 v199, s37, v199
v_add_u32 v200, s37, v200
v_add_u32 v201, s37, v201
v_add_u32 v202, s37, v202
v_add_u32 v203, s37, v203
v_mfma_f32_16x16x32_bf16 v[128:131], a[128:131], a[0:3], v[176:179]
s_waitcnt vmcnt(20)
s_barrier
v_exp_f32 v157, v157
v_mfma_f32_16x16x32_bf16 v[128:131], a[132:135], a[4:7], v[128:131]
ds_read_b64_tr_b16 a[160:161], v196 offset:0
v_add_f32 v211, v211, v148
v_mfma_f32_16x16x32_bf16 v[128:131], a[136:139], a[8:11], v[128:131]
s_add_u32 m0, s30, s29
v_exp_f32 v158, v158
v_mfma_f32_16x16x32_bf16 v[128:131], a[140:143], a[12:15], v[128:131]
ds_read_b64_tr_b16 a[162:163], v196 offset:4096
v_add_f32 v211, v211, v149
v_mfma_f32_16x16x32_bf16 v[144:147], a[144:147], a[0:3], v[176:179]
v_exp_f32 v159, v159
v_mfma_f32_16x16x32_bf16 v[144:147], a[148:151], a[4:7], v[144:147]
ds_read_b64_tr_b16 a[164:165], v197 offset:0
v_cvt_pk_bf16_f32 v166, v148, v149
v_mfma_f32_16x16x32_bf16 v[144:147], a[152:155], a[8:11], v[144:147]
v_add_f32 v211, v211, v150
v_add_f32 v211, v211, v151
v_mfma_f32_16x16x32_bf16 v[144:147], a[156:159], a[12:15], v[144:147]
ds_read_b64_tr_b16 a[166:167], v197 offset:4096
v_cvt_pk_bf16_f32 v167, v150, v151
v_mfma_f32_16x16x32_bf16 v[132:135], a[128:131], a[16:19], v[180:183]
buffer_load_dwordx4 v204, s[12:15], s33 offen offset:0 nt lds
v_add_f32 v212, v212, v136
v_mfma_f32_16x16x32_bf16 v[132:135], a[132:135], a[20:23], v[132:135]
ds_read_b64_tr_b16 a[168:169], v198 offset:0
v_add_f32 v212, v212, v137
v_mfma_f32_16x16x32_bf16 v[132:135], a[136:139], a[24:27], v[132:135]
v_exp_f32 v128, v128
v_mfma_f32_16x16x32_bf16 v[132:135], a[140:143], a[28:31], v[132:135]
ds_read_b64_tr_b16 a[170:171], v198 offset:4096
v_cvt_pk_bf16_f32 v168, v136, v137
v_mfma_f32_16x16x32_bf16 v[148:151], a[144:147], a[16:19], v[180:183]
v_exp_f32 v129, v129
v_mfma_f32_16x16x32_bf16 v[148:151], a[148:151], a[20:23], v[148:151]
ds_read_b64_tr_b16 a[172:173], v199 offset:0
v_add_f32 v212, v212, v138
v_mfma_f32_16x16x32_bf16 v[148:151], a[152:155], a[24:27], v[148:151]
v_exp_f32 v130, v130
v_mfma_f32_16x16x32_bf16 v[148:151], a[156:159], a[28:31], v[148:151]
ds_read_b64_tr_b16 a[174:175], v199 offset:4096
v_add_f32 v212, v212, v139
v_cvt_pk_bf16_f32 v169, v138, v139
v_add_f32 v212, v212, v152
v_add_f32 v212, v212, v153
v_cvt_pk_bf16_f32 v170, v152, v153
v_add_f32 v212, v212, v154
v_add_f32 v212, v212, v155
v_cvt_pk_bf16_f32 v171, v154, v155
v_mfma_f32_16x16x32_bf16 v[136:139], a[128:131], a[32:35], v[184:187]
v_exp_f32 v131, v131
v_mfma_f32_16x16x32_bf16 v[136:139], a[132:135], a[36:39], v[136:139]
ds_read_b64_tr_b16 a[176:177], v200 offset:0
v_add_f32 v213, v213, v140
v_mfma_f32_16x16x32_bf16 v[136:139], a[136:139], a[40:43], v[136:139]
v_exp_f32 v144, v144
v_mfma_f32_16x16x32_bf16 v[136:139], a[140:143], a[44:47], v[136:139]
ds_read_b64_tr_b16 a[178:179], v200 offset:4096
v_add_f32 v213, v213, v141
v_mfma_f32_16x16x32_bf16 v[152:155], a[144:147], a[32:35], v[184:187]
v_exp_f32 v145, v145
v_mfma_f32_16x16x32_bf16 v[152:155], a[148:151], a[36:39], v[152:155]
ds_read_b64_tr_b16 a[180:181], v201 offset:0
v_cvt_pk_bf16_f32 v172, v140, v141
v_mfma_f32_16x16x32_bf16 v[152:155], a[152:155], a[40:43], v[152:155]
v_exp_f32 v146, v146
v_mfma_f32_16x16x32_bf16 v[152:155], a[156:159], a[44:47], v[152:155]
ds_read_b64_tr_b16 a[182:183], v201 offset:4096
v_add_f32 v213, v213, v142
v_add_f32 v213, v213, v143
v_cvt_pk_bf16_f32 v173, v142, v143
v_add_f32 v213, v213, v156
v_add_f32 v213, v213, v157
v_cvt_pk_bf16_f32 v174, v156, v157
v_add_f32 v213, v213, v158
v_add_f32 v213, v213, v159
v_cvt_pk_bf16_f32 v175, v158, v159
v_mfma_f32_16x16x32_bf16 v[140:143], a[128:131], a[48:51], v[188:191]
buffer_load_dwordx4 v205, s[12:15], s33 offen offset:1024 nt lds
v_add_f32 v210, v210, v128
v_mfma_f32_16x16x32_bf16 v[140:143], a[132:135], a[52:55], v[140:143]
ds_read_b64_tr_b16 a[184:185], v202 offset:0
v_add_f32 v210, v210, v129
v_mfma_f32_16x16x32_bf16 v[140:143], a[136:139], a[56:59], v[140:143]
v_exp_f32 v147, v147
v_mfma_f32_16x16x32_bf16 v[140:143], a[140:143], a[60:63], v[140:143]
ds_read_b64_tr_b16 a[186:187], v202 offset:4096
v_add_f32 v210, v210, v130
v_mfma_f32_16x16x32_bf16 v[156:159], a[144:147], a[48:51], v[188:191]
s_waitcnt lgkmcnt(4)
v_exp_f32 v132, v132
v_mfma_f32_16x16x32_bf16 v[156:159], a[148:151], a[52:55], v[156:159]
ds_read_b64_tr_b16 a[188:189], v203 offset:0
v_add_f32 v210, v210, v131
v_mfma_f32_16x16x32_bf16 v[156:159], a[152:155], a[56:59], v[156:159]
s_sub_u32 s37, s35, s48
s_mov_b32 s48, s35
v_add_f32 v210, v210, v144
v_mfma_f32_16x16x32_bf16 v[156:159], a[156:159], a[60:63], v[156:159]
ds_read_b64_tr_b16 a[190:191], v203 offset:4096
v_add_u32 v192, s37, v192
v_mfma_f32_16x16x32_bf16 v[0:3], a[160:163], v[160:163], v[0:3]
s_add_u32 s35, s35, 16384
v_exp_f32 v133, v133
v_mfma_f32_16x16x32_bf16 v[16:19], a[164:167], v[160:163], v[16:19]
v_exp_f32 v134, v134
v_mfma_f32_16x16x32_bf16 v[32:35], a[168:171], v[160:163], v[32:35]
s_cmp_eq_u32 s35, 163840
s_cselect_b32 s35, 0, s35
v_add_u32 v193, s37, v193
v_mfma_f32_16x16x32_bf16 v[48:51], a[172:175], v[160:163], v[48:51]
v_exp_f32 v135, v135
v_mfma_f32_16x16x32_bf16 v[64:67], a[176:179], v[160:163], v[64:67]
s_waitcnt lgkmcnt(0)
v_exp_f32 v148, v148
v_mfma_f32_16x16x32_bf16 v[80:83], a[180:183], v[160:163], v[80:83]
v_add_u32 v194, s37, v194
v_add_u32 v195, s37, v195
ds_read_b128 a[128:131], v192 offset:0
v_add_f32 v210, v210, v145
v_mfma_f32_16x16x32_bf16 v[96:99], a[184:187], v[160:163], v[96:99]
v_exp_f32 v149, v149
v_mfma_f32_16x16x32_bf16 v[112:115], a[188:191], v[160:163], v[112:115]
ds_read_b128 a[132:135], v193 offset:0
v_add_f32 v210, v210, v146
v_mfma_f32_16x16x32_bf16 v[4:7], a[160:163], v[164:167], v[4:7]
buffer_load_dwordx4 v206, s[12:15], s33 offen offset:2048 nt lds
v_cvt_pk_bf16_f32 v160, v128, v129
v_mfma_f32_16x16x32_bf16 v[20:23], a[164:167], v[164:167], v[20:23]
ds_read_b128 a[136:139], v194 offset:0
v_cvt_pk_bf16_f32 v161, v130, v131
v_mfma_f32_16x16x32_bf16 v[36:39], a[168:171], v[164:167], v[36:39]
v_exp_f32 v150, v150
v_mfma_f32_16x16x32_bf16 v[52:55], a[172:175], v[164:167], v[52:55]
ds_read_b128 a[140:143], v195 offset:0
v_cvt_pk_bf16_f32 v162, v144, v145
v_mfma_f32_16x16x32_bf16 v[68:71], a[176:179], v[164:167], v[68:71]
v_exp_f32 v151, v151
v_mfma_f32_16x16x32_bf16 v[84:87], a[180:183], v[164:167], v[84:87]
ds_read_b128 a[144:147], v192 offset:4096
v_add_f32 v210, v210, v147
v_mfma_f32_16x16x32_bf16 v[100:103], a[184:187], v[164:167], v[100:103]
v_exp_f32 v136, v136
v_mfma_f32_16x16x32_bf16 v[116:119], a[188:191], v[164:167], v[116:119]
ds_read_b128 a[148:151], v193 offset:4096
v_cvt_pk_bf16_f32 v163, v146, v147
v_mfma_f32_16x16x32_bf16 v[8:11], a[160:163], v[168:171], v[8:11]
v_exp_f32 v137, v137
v_mfma_f32_16x16x32_bf16 v[24:27], a[164:167], v[168:171], v[24:27]
ds_read_b128 a[152:155], v194 offset:4096
v_add_f32 v211, v211, v132
v_mfma_f32_16x16x32_bf16 v[40:43], a[168:171], v[168:171], v[40:43]
v_exp_f32 v138, v138
v_mfma_f32_16x16x32_bf16 v[56:59], a[172:175], v[168:171], v[56:59]
ds_read_b128 a[156:159], v195 offset:4096
v_add_f32 v211, v211, v133
v_mfma_f32_16x16x32_bf16 v[72:75], a[176:179], v[168:171], v[72:75]
v_exp_f32 v139, v139
v_mfma_f32_16x16x32_bf16 v[88:91], a[180:183], v[168:171], v[88:91]
v_exp_f32 v152, v152
v_mfma_f32_16x16x32_bf16 v[104:107], a[184:187], v[168:171], v[104:107]
v_exp_f32 v153, v153
v_mfma_f32_16x16x32_bf16 v[120:123], a[188:191], v[168:171], v[120:123]
v_exp_f32 v154, v154
v_mfma_f32_16x16x32_bf16 v[12:15], a[160:163], v[172:175], v[12:15]
buffer_load_dwordx4 v207, s[12:15], s33 offen offset:3072 nt lds
v_cvt_pk_bf16_f32 v164, v132, v133
v_mfma_f32_16x16x32_bf16 v[28:31], a[164:167], v[172:175], v[28:31]
v_exp_f32 v155, v155
v_mfma_f32_16x16x32_bf16 v[44:47], a[168:171], v[172:175], v[44:47]
s_add_u32 s33, s33, 16384
v_exp_f32 v140, v140
v_mfma_f32_16x16x32_bf16 v[60:63], a[172:175], v[172:175], v[60:63]
v_exp_f32 v141, v141
v_mfma_f32_16x16x32_bf16 v[76:79], a[176:179], v[172:175], v[76:79]
s_add_u32 s30, s30, 16384
v_exp_f32 v142, v142
v_mfma_f32_16x16x32_bf16 v[92:95], a[180:183], v[172:175], v[92:95]
v_exp_f32 v143, v143
v_mfma_f32_16x16x32_bf16 v[108:111], a[184:187], v[172:175], v[108:111]
s_cmp_eq_u32 s30, 163840
s_cselect_b32 s30, 0, s30
v_add_f32 v211, v211, v134
v_mfma_f32_16x16x32_bf16 v[124:127], a[188:191], v[172:175], v[124:127]
s_waitcnt lgkmcnt(0)
v_exp_f32 v156, v156
s_sub_u32 s40, s40, 1
s_cmp_lg_u32 s40, 0
s_cbranch_scc1 L_loop1
v_mfma_f32_16x16x32_bf16 v[128:131], a[128:131], a[64:67], 0
s_barrier
v_exp_f32 v157, v157
v_mfma_f32_16x16x32_bf16 v[128:131], a[132:135], a[68:71], v[128:131]
ds_read_b64_tr_b16 a[160:161], v196 offset:8192
v_add_f32 v211, v211, v135
v_mfma_f32_16x16x32_bf16 v[128:131], a[136:139], a[72:75], v[128:131]
s_add_u32 m0, s30, s29
v_exp_f32 v158, v158
v_mfma_f32_16x16x32_bf16 v[128:131], a[140:143], a[76:79], v[128:131]
ds_read_b64_tr_b16 a[162:163], v196 offset:12288
v_cvt_pk_bf16_f32 v165, v134, v135
v_mfma_f32_16x16x32_bf16 v[144:147], a[144:147], a[64:67], 0
v_exp_f32 v159, v159
v_mfma_f32_16x16x32_bf16 v[144:147], a[148:151], a[68:71], v[144:147]
ds_read_b64_tr_b16 a[164:165], v197 offset:8192
v_add_f32 v211, v211, v148
v_mfma_f32_16x16x32_bf16 v[144:147], a[152:155], a[72:75], v[144:147]
v_add_f32 v211, v211, v149
v_cvt_pk_bf16_f32 v166, v148, v149
v_mfma_f32_16x16x32_bf16 v[144:147], a[156:159], a[76:79], v[144:147]
ds_read_b64_tr_b16 a[166:167], v197 offset:12288
v_add_f32 v211, v211, v150
v_add_f32 v211, v211, v151
v_cvt_pk_bf16_f32 v167, v150, v151
v_mfma_f32_16x16x32_bf16 v[132:135], a[128:131], a[80:83], 0
buffer_load_dwordx4 v208, s[16:19], s34 offen offset:0 nt lds
v_add_f32 v212, v212, v136
v_mfma_f32_16x16x32_bf16 v[132:135], a[132:135], a[84:87], v[132:135]
ds_read_b64_tr_b16 a[168:169], v198 offset:8192
v_add_f32 v212, v212, v137
v_mfma_f32_16x16x32_bf16 v[132:135], a[136:139], a[88:91], v[132:135]
v_cvt_pk_bf16_f32 v168, v136, v137
v_add_f32 v212, v212, v138
v_mfma_f32_16x16x32_bf16 v[132:135], a[140:143], a[92:95], v[132:135]
ds_read_b64_tr_b16 a[170:171], v198 offset:12288
v_add_f32 v212, v212, v139
v_mfma_f32_16x16x32_bf16 v[148:151], a[144:147], a[80:83], 0
v_cvt_pk_bf16_f32 v169, v138, v139
v_add_f32 v212, v212, v152
v_mfma_f32_16x16x32_bf16 v[148:151], a[148:151], a[84:87], v[148:151]
ds_read_b64_tr_b16 a[172:173], v199 offset:8192
v_add_f32 v212, v212, v153
v_mfma_f32_16x16x32_bf16 v[148:151], a[152:155], a[88:91], v[148:151]
v_cvt_pk_bf16_f32 v170, v152, v153
v_add_f32 v212, v212, v154
v_mfma_f32_16x16x32_bf16 v[148:151], a[156:159], a[92:95], v[148:151]
ds_read_b64_tr_b16 a[174:175], v199 offset:12288
v_add_f32 v212, v212, v155
v_cvt_pk_bf16_f32 v171, v154, v155
v_mfma_f32_16x16x32_bf16 v[136:139], a[128:131], a[96:99], 0
v_add_f32 v213, v213, v140
v_add_f32 v213, v213, v141
v_mfma_f32_16x16x32_bf16 v[136:139], a[132:135], a[100:103], v[136:139]
ds_read_b64_tr_b16 a[176:177], v200 offset:8192
v_cvt_pk_bf16_f32 v172, v140, v141
v_mfma_f32_16x16x32_bf16 v[136:139], a[136:139], a[104:107], v[136:139]
v_add_f32 v213, v213, v142
v_add_f32 v213, v213, v143
v_mfma_f32_16x16x32_bf16 v[136:139], a[140:143], a[108:111], v[136:139]
ds_read_b64_tr_b16 a[178:179], v200 offset:12288
v_cvt_pk_bf16_f32 v173, v142, v143
v_mfma_f32_16x16x32_bf16 v[152:155], a[144:147], a[96:99], 0
v_add_f32 v213, v213, v156
v_add_f32 v213, v213, v157
v_mfma_f32_16x16x32_bf16 v[152:155], a[148:151], a[100:103], v[152:155]
ds_read_b64_tr_b16 a[180:181], v201 offset:8192
v_cvt_pk_bf16_f32 v174, v156, v157
v_mfma_f32_16x16x32_bf16 v[152:155], a[152:155], a[104:107], v[152:155]
v_add_f32 v213, v213, v158
v_add_f32 v213, v213, v159
v_mfma_f32_16x16x32_bf16 v[152:155], a[156:159], a[108:111], v[152:155]
ds_read_b64_tr_b16 a[182:183], v201 offset:12288
v_cvt_pk_bf16_f32 v175, v158, v159
v_mfma_f32_16x16x32_bf16 v[140:143], a[128:131], a[112:115], 0
buffer_load_dwordx4 v209, s[16:19], s34 offen offset:1024 nt lds
v_mov_b32 v252, 0
v_mfma_f32_16x16x32_bf16 v[140:143], a[132:135], a[116:119], v[140:143]
ds_read_b64_tr_b16 a[184:185], v202 offset:8192
v_mov_b32 v253, 0
v_mfma_f32_16x16x32_bf16 v[140:143], a[136:139], a[120:123], v[140:143]
v_max3_f32 v246, v210, v211, v212
v_max_f32 v246, v246, v213
s_mov_b32 s38, 0x57800000
v_cmp_lt_f32 vcc, s38, v246
s_nop 1
s_cmp_lg_u64 vcc, 0
s_cbranch_scc1 L_slow0
L_back0:
v_mfma_f32_16x16x32_bf16 v[140:143], a[140:143], a[124:127], v[140:143]
ds_read_b64_tr_b16 a[186:187], v202 offset:12288
v_mov_b32 v254, 0
v_mfma_f32_16x16x32_bf16 v[156:159], a[144:147], a[112:115], 0
s_waitcnt lgkmcnt(4)
v_max3_f32 v226, v128, v129, v130
v_max3_f32 v230, v131, v144, v145
v_max3_f32 v226, v226, v146, v147
v_max_f32 v226, v226, v230
v_max3_f32 v227, v132, v133, v134
v_max3_f32 v231, v135, v148, v149
v_max3_f32 v227, v227, v150, v151
v_max_f32 v227, v227, v231
v_mfma_f32_16x16x32_bf16 v[156:159], a[148:151], a[116:119], v[156:159]
ds_read_b64_tr_b16 a[188:189], v203 offset:8192
v_mfma_f32_16x16x32_bf16 v[156:159], a[152:155], a[120:123], v[156:159]
v_mov_b32 v230, v226
v_mov_b32 v231, v227
s_nop 1
v_permlane16_swap_b32 v226, v230
v_permlane16_swap_b32 v227, v231
s_nop 0
v_max_f32 v226, v226, v230
v_max_f32 v227, v227, v231
v_mov_b32 v230, v226
v_mov_b32 v231, v227
s_nop 1
v_permlane32_swap_b32 v226, v230
v_permlane32_swap_b32 v227, v231
s_nop 0
v_max_f32 v226, v226, v230
v_max_f32 v227, v227, v231
v_mfma_f32_16x16x32_bf16 v[156:159], a[156:159], a[124:127], v[156:159]
ds_read_b64_tr_b16 a[190:191], v203 offset:12288
v_sub_f32 v176, 0, v226
v_mfma_f32_16x16x32_bf16 v[0:3], a[160:163], v[160:163], v[0:3]
v_mov_b32 v246, v210
v_mov_b32 v247, v211
v_mov_b32 v248, v212
v_mov_b32 v249, v213
s_nop 0
v_permlane16_swap_b32 v210, v246
v_permlane16_swap_b32 v211, v247
v_permlane16_swap_b32 v212, v248
v_permlane16_swap_b32 v213, v249
s_nop 0
v_add_f32 v210, v210, v246
v_add_f32 v211, v211, v247
v_add_f32 v212, v212, v248
v_add_f32 v213, v213, v249
v_mov_b32 v246, v210
v_mov_b32 v247, v211
v_mov_b32 v248, v212
v_mov_b32 v249, v213
s_nop 0
v_permlane32_swap_b32 v210, v246
v_permlane32_swap_b32 v211, v247
v_permlane32_swap_b32 v212, v248
v_permlane32_swap_b32 v213, v249
s_nop 0
v_add_f32 v210, v210, v246
v_add_f32 v211, v211, v247
v_add_f32 v212, v212, v248
v_add_f32 v213, v213, v249
v_rcp_f32 v246, v210
v_rcp_f32 v247, v211
v_rcp_f32 v248, v212
v_rcp_f32 v249, v213
v_mfma_f32_16x16x32_bf16 v[16:19], a[164:167], v[160:163], v[16:19]
v_sub_f32 v177, 0, v226
v_sub_f32 v178, 0, v226
v_mfma_f32_16x16x32_bf16 v[32:35], a[168:171], v[160:163], v[32:35]
v_max3_f32 v228, v136, v137, v138
v_max3_f32 v232, v139, v152, v153
v_max3_f32 v228, v228, v154, v155
v_max_f32 v228, v228, v232
v_max3_f32 v229, v140, v141, v142
v_max3_f32 v233, v143, v156, v157
v_max3_f32 v229, v229, v158, v159
v_max_f32 v229, v229, v233
v_mfma_f32_16x16x32_bf16 v[48:51], a[172:175], v[160:163], v[48:51]
v_mov_b32 v232, v228
v_mov_b32 v233, v229
s_nop 1
v_permlane16_swap_b32 v228, v232
v_permlane16_swap_b32 v229, v233
s_nop 0
v_max_f32 v228, v228, v232
v_max_f32 v229, v229, v233
v_mov_b32 v232, v228
v_mov_b32 v233, v229
s_nop 1
v_permlane32_swap_b32 v228, v232
v_permlane32_swap_b32 v229, v233
s_nop 0
v_max_f32 v228, v228, v232
v_max_f32 v229, v229, v233
v_max_f32 v229, s53, v229
v_mfma_f32_16x16x32_bf16 v[64:67], a[176:179], v[160:163], v[64:67]
s_waitcnt lgkmcnt(0)
v_sub_f32 v179, 0, v226
v_sub_f32 v128, v128, v226
v_mfma_f32_16x16x32_bf16 v[80:83], a[180:183], v[160:163], v[80:83]
ds_read_b128 a[128:131], v192 offset:8192
v_sub_f32 v129, v129, v226
v_mfma_f32_16x16x32_bf16 v[96:99], a[184:187], v[160:163], v[96:99]
v_exp_f32 v128, v128
v_mfma_f32_16x16x32_bf16 v[112:115], a[188:191], v[160:163], v[112:115]
ds_read_b128 a[132:135], v193 offset:8192
v_sub_f32 v130, v130, v226
v_mfma_f32_16x16x32_bf16 v[4:7], a[160:163], v[164:167], v[4:7]
buffer_load_dwordx4 v208, s[16:19], s34 offen offset:2048 nt lds
v_sub_f32 v131, v131, v226
v_mfma_f32_16x16x32_bf16 v[20:23], a[164:167], v[164:167], v[20:23]
ds_read_b128 a[136:139], v194 offset:8192
v_sub_f32 v144, v144, v226
v_mfma_f32_16x16x32_bf16 v[36:39], a[168:171], v[164:167], v[36:39]
v_exp_f32 v129, v129
v_mfma_f32_16x16x32_bf16 v[52:55], a[172:175], v[164:167], v[52:55]
ds_read_b128 a[140:143], v195 offset:8192
v_sub_f32 v145, v145, v226
v_mfma_f32_16x16x32_bf16 v[68:71], a[176:179], v[164:167], v[68:71]
v_exp_f32 v130, v130
v_mfma_f32_16x16x32_bf16 v[84:87], a[180:183], v[164:167], v[84:87]
ds_read_b128 a[144:147], v192 offset:12288
v_sub_f32 v146, v146, v226
v_mfma_f32_16x16x32_bf16 v[100:103], a[184:187], v[164:167], v[100:103]
v_exp_f32 v131, v131
v_mfma_f32_16x16x32_bf16 v[116:119], a[188:191], v[164:167], v[116:119]
ds_read_b128 a[148:151], v193 offset:12288
v_sub_f32 v147, v147, v226
v_mfma_f32_16x16x32_bf16 v[8:11], a[160:163], v[168:171], v[8:11]
s_sub_u32 s37, s35, s49
s_mov_b32 s49, s35
v_add_f32 v252, v252, v128
v_mfma_f32_16x16x32_bf16 v[24:27], a[164:167], v[168:171], v[24:27]
ds_read_b128 a[152:155], v194 offset:12288
v_add_f32 v252, v252, v129
v_mfma_f32_16x16x32_bf16 v[40:43], a[168:171], v[168:171], v[40:43]
s_add_u32 s35, s35, 16384
v_exp_f32 v144, v144
v_mfma_f32_16x16x32_bf16 v[56:59], a[172:175], v[168:171], v[56:59]
ds_read_b128 a[156:159], v195 offset:12288
v_cvt_pk_bf16_f32 v160, v128, v129
v_mfma_f32_16x16x32_bf16 v[72:75], a[176:179], v[168:171], v[72:75]
s_cmp_eq_u32 s35, 163840
s_cselect_b32 s35, 0, s35
v_add_f32 v252, v252, v130
v_mfma_f32_16x16x32_bf16 v[88:91], a[180:183], v[168:171], v[88:91]
v_exp_f32 v145, v145
v_mfma_f32_16x16x32_bf16 v[104:107], a[184:187], v[168:171], v[104:107]
v_exp_f32 v146, v146
v_mfma_f32_16x16x32_bf16 v[120:123], a[188:191], v[168:171], v[120:123]
v_exp_f32 v147, v147
v_mfma_f32_16x16x32_bf16 v[12:15], a[160:163], v[172:175], v[12:15]
buffer_load_dwordx4 v209, s[16:19], s34 offen offset:3072 nt lds
v_add_f32 v252, v252, v131
v_mfma_f32_16x16x32_bf16 v[28:31], a[164:167], v[172:175], v[28:31]
v_cvt_pk_bf16_f32 v161, v130, v131
v_add_f32 v252, v252, v144
v_mfma_f32_16x16x32_bf16 v[44:47], a[168:171], v[172:175], v[44:47]
s_add_u32 s34, s34, 16384
v_add_f32 v252, v252, v145
v_cvt_pk_bf16_f32 v162, v144, v145
v_mfma_f32_16x16x32_bf16 v[60:63], a[172:175], v[172:175], v[60:63]
v_add_f32 v252, v252, v146
v_add_f32 v252, v252, v147
v_mfma_f32_16x16x32_bf16 v[76:79], a[176:179], v[172:175], v[76:79]
s_add_u32 s30, s30, 16384
v_cvt_pk_bf16_f32 v163, v146, v147
v_sub_f32 v180, 0, v227
v_mfma_f32_16x16x32_bf16 v[92:95], a[180:183], v[172:175], v[92:95]
v_sub_f32 v181, 0, v227
v_sub_f32 v182, 0, v227
v_mfma_f32_16x16x32_bf16 v[108:111], a[184:187], v[172:175], v[108:111]
s_cmp_eq_u32 s30, 163840
s_cselect_b32 s30, 0, s30
v_sub_f32 v183, 0, v227
v_mfma_f32_16x16x32_bf16 v[124:127], a[188:191], v[172:175], v[124:127]
s_waitcnt lgkmcnt(0)
v_sub_f32 v132, v132, v227
v_sub_f32 v133, v133, v227
v_add_u32 v196, s37, v196
v_add_u32 v197, s37, v197
v_add_u32 v198, s37, v198
v_add_u32 v199, s37, v199
v_add_u32 v200, s37, v200
v_add_u32 v201, s37, v201
v_add_u32 v202, s37, v202
v_add_u32 v203, s37, v203
v_mfma_f32_16x16x32_bf16 v[128:131], a[128:131], a[64:67], v[176:179]
s_waitcnt vmcnt(20)
s_barrier
s_cmp_lg_u32 s28, 0
s_cbranch_scc1 L_go
v_readfirstlane_b32 s38, v250
v_lshlrev_b32 v251, 3, v214
v_mov_b32 v250, 0x10000
s_and_b32 s38, s38, 255
s_cmp_lg_u32 s38, 255
s_cbranch_scc1 L_go
s_mov_b32 s38, 35651584
buffer_atomic_add v250, v251, s[20:23], s38 offen sc1
s_mov_b32 s38, 35659776
buffer_atomic_add v250, v251, s[20:23], s38 offen sc1
s_mov_b32 s38, 35667968
buffer_atomic_add v250, v251, s[20:23], s38 offen sc1
s_mov_b32 s38, 35676160
buffer_atomic_add v250, v251, s[20:23], s38 offen sc1
L_go:
v_exp_f32 v132, v132
v_mfma_f32_16x16x32_bf16 v[128:131], a[132:135], a[68:71], v[128:131]
ds_read_b64_tr_b16 a[160:161], v196 offset:0
v_sub_f32 v134, v134, v227
v_mfma_f32_16x16x32_bf16 v[128:131], a[136:139], a[72:75], v[128:131]
s_add_u32 m0, s30, s29
v_exp_f32 v133, v133
v_mfma_f32_16x16x32_bf16 v[128:131], a[140:143], a[76:79], v[128:131]
ds_read_b64_tr_b16 a[162:163], v196 offset:4096
v_sub_f32 v135, v135, v227
v_mfma_f32_16x16x32_bf16 v[144:147], a[144:147], a[64:67], v[176:179]
v_exp_f32 v134, v134
v_mfma_f32_16x16x32_bf16 v[144:147], a[148:151], a[68:71], v[144:147]
ds_read_b64_tr_b16 a[164:165], v197 offset:0
v_sub_f32 v148, v148, v227
v_mfma_f32_16x16x32_bf16 v[144:147], a[152:155], a[72:75], v[144:147]
v_exp_f32 v135, v135
v_mfma_f32_16x16x32_bf16 v[144:147], a[156:159], a[76:79], v[144:147]
ds_read_b64_tr_b16 a[166:167], v197 offset:4096
v_sub_f32 v149, v149, v227
v_sub_f32 v150, v150, v227
v_sub_f32 v151, v151, v227
v_add_f32 v253, v253, v132
v_add_f32 v253, v253, v133
v_cvt_pk_bf16_f32 v164, v132, v133
v_add_f32 v253, v253, v134
v_add_f32 v253, v253, v135
v_cvt_pk_bf16_f32 v165, v134, v135
v_exp_f32 v148, v148
s_nop 0
v_add_f32 v253, v253, v148
v_exp_f32 v149, v149
s_nop 0
v_add_f32 v253, v253, v149
v_cvt_pk_bf16_f32 v166, v148, v149
v_exp_f32 v150, v150
s_nop 0
v_add_f32 v253, v253, v150
v_exp_f32 v151, v151
s_nop 0
v_add_f32 v253, v253, v151
v_cvt_pk_bf16_f32 v167, v150, v151
v_mfma_f32_16x16x32_bf16 v[132:135], a[128:131], a[80:83], v[180:183]
buffer_load_dwordx4 v204, s[12:15], s33 offen offset:0 nt lds
v_mul_f32 v0, v0, v246
v_mfma_f32_16x16x32_bf16 v[132:135], a[132:135], a[84:87], v[132:135]
ds_read_b64_tr_b16 a[168:169], v198 offset:0
v_mul_f32 v1, v1, v246
v_mfma_f32_16x16x32_bf16 v[132:135], a[136:139], a[88:91], v[132:135]
v_exp_f32 v128, v128
v_mfma_f32_16x16x32_bf16 v[132:135], a[140:143], a[92:95], v[132:135]
ds_read_b64_tr_b16 a[170:171], v198 offset:4096
v_mul_f32 v2, v2, v246
v_mfma_f32_16x16x32_bf16 v[148:151], a[144:147], a[80:83], v[180:183]
v_exp_f32 v129, v129
v_mfma_f32_16x16x32_bf16 v[148:151], a[148:151], a[84:87], v[148:151]
ds_read_b64_tr_b16 a[172:173], v199 offset:0
v_mul_f32 v3, v3, v246
v_mfma_f32_16x16x32_bf16 v[148:151], a[152:155], a[88:91], v[148:151]
v_exp_f32 v130, v130
v_mfma_f32_16x16x32_bf16 v[148:151], a[156:159], a[92:95], v[148:151]
ds_read_b64_tr_b16 a[174:175], v199 offset:4096
v_cvt_pk_bf16_f32 v234, v0, v1
v_sub_f32 v136, v136, v228
v_sub_f32 v137, v137, v228
v_sub_f32 v138, v138, v228
v_sub_f32 v139, v139, v228
v_sub_f32 v152, v152, v228
v_sub_f32 v153, v153, v228
v_sub_f32 v154, v154, v228
v_sub_f32 v155, v155, v228
v_exp_f32 v136, v136
s_nop 0
v_add_f32 v254, v254, v136
v_exp_f32 v137, v137
s_nop 0
v_add_f32 v254, v254, v137
v_cvt_pk_bf16_f32 v168, v136, v137
v_exp_f32 v138, v138
s_nop 0
v_add_f32 v254, v254, v138
v_exp_f32 v139, v139
s_nop 0
v_add_f32 v254, v254, v139
v_cvt_pk_bf16_f32 v169, v138, v139
v_exp_f32 v152, v152
s_nop 0
v_add_f32 v254, v254, v152
v_exp_f32 v153, v153
s_nop 0
v_add_f32 v254, v254, v153
v_cvt_pk_bf16_f32 v170, v152, v153
v_exp_f32 v154, v154
s_nop 0
v_add_f32 v254, v254, v154
v_exp_f32 v155, v155
s_nop 0
v_add_f32 v254, v254, v155
v_cvt_pk_bf16_f32 v171, v154, v155
v_sub_f32 v184, 0, v228
v_sub_f32 v185, 0, v228
v_sub_f32 v186, 0, v228
v_sub_f32 v187, 0, v228
s_nop 1
v_mfma_f32_16x16x32_bf16 v[136:139], a[128:131], a[96:99], v[184:187]
v_exp_f32 v131, v131
v_mfma_f32_16x16x32_bf16 v[136:139], a[132:135], a[100:103], v[136:139]
ds_read_b64_tr_b16 a[176:177], v200 offset:0
v_cvt_pk_bf16_f32 v235, v2, v3
v_mfma_f32_16x16x32_bf16 v[136:139], a[136:139], a[104:107], v[136:139]
v_exp_f32 v144, v144
v_mfma_f32_16x16x32_bf16 v[136:139], a[140:143], a[108:111], v[136:139]
ds_read_b64_tr_b16 a[178:179], v200 offset:4096
v_mul_f32 v16, v16, v246
v_mfma_f32_16x16x32_bf16 v[152:155], a[144:147], a[96:99], v[184:187]
v_exp_f32 v145, v145
v_mfma_f32_16x16x32_bf16 v[152:155], a[148:151], a[100:103], v[152:155]
ds_read_b64_tr_b16 a[180:181], v201 offset:0
v_mul_f32 v17, v17, v246
v_mfma_f32_16x16x32_bf16 v[152:155], a[152:155], a[104:107], v[152:155]
v_exp_f32 v146, v146
v_mfma_f32_16x16x32_bf16 v[152:155], a[156:159], a[108:111], v[152:155]
ds_read_b64_tr_b16 a[182:183], v201 offset:4096
v_mul_f32 v18, v18, v246
v_mov_b32 v255, 0
v_sub_f32 v140, v140, v229
v_sub_f32 v141, v141, v229
v_sub_f32 v142, v142, v229
v_sub_f32 v143, v143, v229
v_sub_f32 v156, v156, v229
v_sub_f32 v157, v157, v229
v_sub_f32 v158, v158, v229
v_sub_f32 v159, v159, v229
v_exp_f32 v140, v140
s_nop 0
v_add_f32 v255, v255, v140
v_exp_f32 v141, v141
s_nop 0
v_add_f32 v255, v255, v141
v_cvt_pk_bf16_f32 v172, v140, v141
v_exp_f32 v142, v142
s_nop 0
v_add_f32 v255, v255, v142
v_exp_f32 v143, v143
s_nop 0
v_add_f32 v255, v255, v143
v_cvt_pk_bf16_f32 v173, v142, v143
v_exp_f32 v156, v156
s_nop 0
v_add_f32 v255, v255, v156
v_exp_f32 v157, v157
s_nop 0
v_add_f32 v255, v255, v157
v_cvt_pk_bf16_f32 v174, v156, v157
v_exp_f32 v158, v158
s_nop 0
v_add_f32 v255, v255, v158
v_exp_f32 v159, v159
s_nop 0
v_add_f32 v255, v255, v159
v_cvt_pk_bf16_f32 v175, v158, v159
v_sub_f32 v188, 0, v229
v_sub_f32 v189, 0, v229
v_sub_f32 v190, 0, v229
v_sub_f32 v191, 0, v229
s_nop 1
v_mfma_f32_16x16x32_bf16 v[140:143], a[128:131], a[112:115], v[188:191]
buffer_load_dwordx4 v205, s[12:15], s33 offen offset:1024 nt lds
v_mul_f32 v19, v19, v246
v_mfma_f32_16x16x32_bf16 v[140:143], a[132:135], a[116:119], v[140:143]
ds_read_b64_tr_b16 a[184:185], v202 offset:0
v_cvt_pk_bf16_f32 v236, v16, v17
v_mfma_f32_16x16x32_bf16 v[140:143], a[136:139], a[120:123], v[140:143]
v_exp_f32 v147, v147
v_mfma_f32_16x16x32_bf16 v[140:143], a[140:143], a[124:127], v[140:143]
ds_read_b64_tr_b16 a[186:187], v202 offset:4096
v_cvt_pk_bf16_f32 v237, v18, v19
v_mfma_f32_16x16x32_bf16 v[156:159], a[144:147], a[112:115], v[188:191]
s_waitcnt lgkmcnt(4)
v_exp_f32 v132, v132
v_mfma_f32_16x16x32_bf16 v[156:159], a[148:151], a[116:119], v[156:159]
ds_read_b64_tr_b16 a[188:189], v203 offset:0
v_accvgpr_write_b32 a192, v234
v_mfma_f32_16x16x32_bf16 v[156:159], a[152:155], a[120:123], v[156:159]
s_sub_u32 s37, s35, s48
s_mov_b32 s48, s35
v_accvgpr_write_b32 a193, v235
v_mfma_f32_16x16x32_bf16 v[156:159], a[156:159], a[124:127], v[156:159]
ds_read_b64_tr_b16 a[190:191], v203 offset:4096
v_add_u32 v192, s37, v192
v_mfma_f32_16x16x32_bf16 v[0:3], a[160:163], v[160:163], 0
s_add_u32 s35, s35, 16384
v_exp_f32 v133, v133
v_mfma_f32_16x16x32_bf16 v[16:19], a[164:167], v[160:163], 0
v_exp_f32 v134, v134
v_mul_f32 v32, v32, v246
v_mul_f32 v33, v33, v246
v_mul_f32 v34, v34, v246
v_mul_f32 v35, v35, v246
v_cvt_pk_bf16_f32 v238, v32, v33
v_cvt_pk_bf16_f32 v239, v34, v35
s_nop 1
v_mfma_f32_16x16x32_bf16 v[32:35], a[168:171], v[160:163], 0
s_cmp_eq_u32 s35, 163840
s_cselect_b32 s35, 0, s35
v_add_u32 v193, s37, v193
v_mul_f32 v48, v48, v246
v_mul_f32 v49, v49, v246
v_mul_f32 v50, v50, v246
v_mul_f32 v51, v51, v246
v_cvt_pk_bf16_f32 v240, v48, v49
v_cvt_pk_bf16_f32 v241, v50, v51
s_nop 1
v_mfma_f32_16x16x32_bf16 v[48:51], a[172:175], v[160:163], 0
v_exp_f32 v135, v135
v_mul_f32 v64, v64, v246
v_mul_f32 v65, v65, v246
v_mul_f32 v66, v66, v246
v_mul_f32 v67, v67, v246
v_cvt_pk_bf16_f32 v242, v64, v65
v_cvt_pk_bf16_f32 v243, v66, v67
s_nop 1
v_mfma_f32_16x16x32_bf16 v[64:67], a[176:179], v[160:163], 0
s_waitcnt lgkmcnt(0)
v_exp_f32 v148, v148
v_mul_f32 v80, v80, v246
v_mul_f32 v81, v81, v246
v_mul_f32 v82, v82, v246
v_mul_f32 v83, v83, v246
v_cvt_pk_bf16_f32 v244, v80, v81
v_cvt_pk_bf16_f32 v245, v82, v83
s_nop 1
v_mfma_f32_16x16x32_bf16 v[80:83], a[180:183], v[160:163], 0
v_add_u32 v194, s37, v194
v_add_u32 v195, s37, v195
ds_read_b128 a[128:131], v192 offset:0
v_accvgpr_write_b32 a194, v236
v_accvgpr_write_b32 a195, v237
v_mul_f32 v96, v96, v246
v_mul_f32 v97, v97, v246
v_mul_f32 v98, v98, v246
v_mul_f32 v99, v99, v246
v_cvt_pk_bf16_f32 v234, v96, v97
v_cvt_pk_bf16_f32 v235, v98, v99
s_nop 1
v_mfma_f32_16x16x32_bf16 v[96:99], a[184:187], v[160:163], 0
v_exp_f32 v149, v149
v_mul_f32 v112, v112, v246
v_mul_f32 v113, v113, v246
v_mul_f32 v114, v114, v246
v_mul_f32 v115, v115, v246
v_cvt_pk_bf16_f32 v236, v112, v113
v_cvt_pk_bf16_f32 v237, v114, v115
s_nop 1
v_mfma_f32_16x16x32_bf16 v[112:115], a[188:191], v[160:163], 0
ds_read_b128 a[132:135], v193 offset:0
v_accvgpr_write_b32 a196, v238
v_accvgpr_write_b32 a197, v239
v_accvgpr_write_b32 a198, v240
v_accvgpr_write_b32 a199, v241
v_mul_f32 v4, v4, v247
v_mul_f32 v5, v5, v247
v_mul_f32 v6, v6, v247
v_mul_f32 v7, v7, v247
v_cvt_pk_bf16_f32 v238, v4, v5
v_cvt_pk_bf16_f32 v239, v6, v7
s_nop 1
v_mfma_f32_16x16x32_bf16 v[4:7], a[160:163], v[164:167], 0
buffer_load_dwordx4 v206, s[12:15], s33 offen offset:2048 nt lds
v_accvgpr_write_b32 a200, v242
v_mul_f32 v20, v20, v247
v_mul_f32 v21, v21, v247
v_mul_f32 v22, v22, v247
v_mul_f32 v23, v23, v247
v_cvt_pk_bf16_f32 v240, v20, v21
v_cvt_pk_bf16_f32 v241, v22, v23
s_nop 1
v_mfma_f32_16x16x32_bf16 v[20:23], a[164:167], v[164:167], 0
ds_read_b128 a[136:139], v194 offset:0
v_accvgpr_write_b32 a201, v243
v_accvgpr_write_b32 a202, v244
v_accvgpr_write_b32 a203, v245
v_mul_f32 v36, v36, v247
v_mul_f32 v37, v37, v247
v_mul_f32 v38, v38, v247
v_mul_f32 v39, v39, v247
v_cvt_pk_bf16_f32 v242, v36, v37
v_cvt_pk_bf16_f32 v243, v38, v39
s_nop 1
v_mfma_f32_16x16x32_bf16 v[36:39], a[168:171], v[164:167], 0
v_exp_f32 v150, v150
v_mul_f32 v52, v52, v247
v_mul_f32 v53, v53, v247
v_mul_f32 v54, v54, v247
v_mul_f32 v55, v55, v247
v_cvt_pk_bf16_f32 v244, v52, v53
v_cvt_pk_bf16_f32 v245, v54, v55
s_nop 1
v_mfma_f32_16x16x32_bf16 v[52:55], a[172:175], v[164:167], 0
ds_read_b128 a[140:143], v195 offset:0
v_accvgpr_write_b32 a204, v234
v_accvgpr_write_b32 a205, v235
v_accvgpr_write_b32 a206, v236
v_accvgpr_write_b32 a207, v237
v_mul_f32 v68, v68, v247
v_mul_f32 v69, v69, v247
v_mul_f32 v70, v70, v247
v_mul_f32 v71, v71, v247
v_cvt_pk_bf16_f32 v234, v68, v69
v_cvt_pk_bf16_f32 v235, v70, v71
s_nop 1
v_mfma_f32_16x16x32_bf16 v[68:71], a[176:179], v[164:167], 0
v_exp_f32 v151, v151
v_mul_f32 v84, v84, v247
v_mul_f32 v85, v85, v247
v_mul_f32 v86, v86, v247
v_mul_f32 v87, v87, v247
v_cvt_pk_bf16_f32 v236, v84, v85
v_cvt_pk_bf16_f32 v237, v86, v87
s_nop 1
v_mfma_f32_16x16x32_bf16 v[84:87], a[180:183], v[164:167], 0
ds_read_b128 a[144:147], v192 offset:4096
v_accvgpr_write_b32 a208, v238
v_accvgpr_write_b32 a209, v239
v_accvgpr_write_b32 a210, v240
v_accvgpr_write_b32 a211, v241
v_mul_f32 v100, v100, v247
v_mul_f32 v101, v101, v247
v_mul_f32 v102, v102, v247
v_mul_f32 v103, v103, v247
v_cvt_pk_bf16_f32 v238, v100, v101
v_cvt_pk_bf16_f32 v239, v102, v103
s_nop 1
v_mfma_f32_16x16x32_bf16 v[100:103], a[184:187], v[164:167], 0
v_exp_f32 v136, v136
v_mul_f32 v116, v116, v247
v_mul_f32 v117, v117, v247
v_mul_f32 v118, v118, v247
v_mul_f32 v119, v119, v247
v_cvt_pk_bf16_f32 v240, v116, v117
v_cvt_pk_bf16_f32 v241, v118, v119
s_nop 1
v_mfma_f32_16x16x32_bf16 v[116:119], a[188:191], v[164:167], 0
ds_read_b128 a[148:151], v193 offset:4096
v_accvgpr_write_b32 a212, v242
v_accvgpr_write_b32 a213, v243
v_accvgpr_write_b32 a214, v244
v_accvgpr_write_b32 a215, v245
v_mul_f32 v8, v8, v248
v_mul_f32 v9, v9, v248
v_mul_f32 v10, v10, v248
v_mul_f32 v11, v11, v248
v_cvt_pk_bf16_f32 v242, v8, v9
v_cvt_pk_bf16_f32 v243, v10, v11
s_nop 1
v_mfma_f32_16x16x32_bf16 v[8:11], a[160:163], v[168:171], 0
v_exp_f32 v137, v137
v_mul_f32 v24, v24, v248
v_mul_f32 v25, v25, v248
v_mul_f32 v26, v26, v248
v_mul_f32 v27, v27, v248
v_cvt_pk_bf16_f32 v244, v24, v25
v_cvt_pk_bf16_f32 v245, v26, v27
s_nop 1
v_mfma_f32_16x16x32_bf16 v[24:27], a[164:167], v[168:171], 0
ds_read_b128 a[152:155], v194 offset:4096
v_accvgpr_write_b32 a216, v234
v_accvgpr_write_b32 a217, v235
v_accvgpr_write_b32 a218, v236
v_accvgpr_write_b32 a219, v237
v_mul_f32 v40, v40, v248
v_mul_f32 v41, v41, v248
v_mul_f32 v42, v42, v248
v_mul_f32 v43, v43, v248
v_cvt_pk_bf16_f32 v234, v40, v41
v_cvt_pk_bf16_f32 v235, v42, v43
s_nop 1
v_mfma_f32_16x16x32_bf16 v[40:43], a[168:171], v[168:171], 0
v_exp_f32 v138, v138
v_mul_f32 v56, v56, v248
v_mul_f32 v57, v57, v248
v_mul_f32 v58, v58, v248
v_mul_f32 v59, v59, v248
v_cvt_pk_bf16_f32 v236, v56, v57
v_cvt_pk_bf16_f32 v237, v58, v59
s_nop 1
v_mfma_f32_16x16x32_bf16 v[56:59], a[172:175], v[168:171], 0
ds_read_b128 a[156:159], v195 offset:4096
v_accvgpr_write_b32 a220, v238
v_accvgpr_write_b32 a221, v239
v_accvgpr_write_b32 a222, v240
v_accvgpr_write_b32 a223, v241
v_mul_f32 v72, v72, v248
v_mul_f32 v73, v73, v248
v_mul_f32 v74, v74, v248
v_mul_f32 v75, v75, v248
v_cvt_pk_bf16_f32 v238, v72, v73
v_cvt_pk_bf16_f32 v239, v74, v75
s_nop 1
v_mfma_f32_16x16x32_bf16 v[72:75], a[176:179], v[168:171], 0
v_exp_f32 v139, v139
v_mul_f32 v88, v88, v248
v_mul_f32 v89, v89, v248
v_mul_f32 v90, v90, v248
v_mul_f32 v91, v91, v248
v_cvt_pk_bf16_f32 v240, v88, v89
v_cvt_pk_bf16_f32 v241, v90, v91
s_nop 1
v_mfma_f32_16x16x32_bf16 v[88:91], a[180:183], v[168:171], 0
v_exp_f32 v152, v152
v_accvgpr_write_b32 a224, v242
v_accvgpr_write_b32 a225, v243
v_accvgpr_write_b32 a226, v244
v_accvgpr_write_b32 a227, v245
v_mul_f32 v104, v104, v248
v_mul_f32 v105, v105, v248
v_mul_f32 v106, v106, v248
v_mul_f32 v107, v107, v248
v_cvt_pk_bf16_f32 v242, v104, v105
v_cvt_pk_bf16_f32 v243, v106, v107
s_nop 1
v_mfma_f32_16x16x32_bf16 v[104:107], a[184:187], v[168:171], 0
v_exp_f32 v153, v153
v_mul_f32 v120, v120, v248
v_mul_f32 v121, v121, v248
v_mul_f32 v122, v122, v248
v_mul_f32 v123, v123, v248
v_cvt_pk_bf16_f32 v244, v120, v121
v_cvt_pk_bf16_f32 v245, v122, v123
s_nop 1
v_mfma_f32_16x16x32_bf16 v[120:123], a[188:191], v[168:171], 0
v_exp_f32 v154, v154
v_accvgpr_write_b32 a228, v234
v_accvgpr_write_b32 a229, v235
v_accvgpr_write_b32 a230, v236
v_accvgpr_write_b32 a231, v237
v_mul_f32 v12, v12, v249
v_mul_f32 v13, v13, v249
v_mul_f32 v14, v14, v249
v_mul_f32 v15, v15, v249
v_cvt_pk_bf16_f32 v234, v12, v13
v_cvt_pk_bf16_f32 v235, v14, v15
s_nop 1
v_mfma_f32_16x16x32_bf16 v[12:15], a[160:163], v[172:175], 0
buffer_load_dwordx4 v207, s[12:15], s33 offen offset:3072 nt lds
v_accvgpr_write_b32 a232, v238
v_mul_f32 v28, v28, v249
v_mul_f32 v29, v29, v249
v_mul_f32 v30, v30, v249
v_mul_f32 v31, v31, v249
v_cvt_pk_bf16_f32 v236, v28, v29
v_cvt_pk_bf16_f32 v237, v30, v31
s_nop 1
v_mfma_f32_16x16x32_bf16 v[28:31], a[164:167], v[172:175], 0
v_exp_f32 v155, v155
v_accvgpr_write_b32 a233, v239
v_accvgpr_write_b32 a234, v240
v_accvgpr_write_b32 a235, v241
v_mul_f32 v44, v44, v249
v_mul_f32 v45, v45, v249
v_mul_f32 v46, v46, v249
v_mul_f32 v47, v47, v249
v_cvt_pk_bf16_f32 v238, v44, v45
v_cvt_pk_bf16_f32 v239, v46, v47
s_nop 1
v_mfma_f32_16x16x32_bf16 v[44:47], a[168:171], v[172:175], 0
s_add_u32 s33, s33, 16384
v_exp_f32 v140, v140
v_mul_f32 v60, v60, v249
v_mul_f32 v61, v61, v249
v_mul_f32 v62, v62, v249
v_mul_f32 v63, v63, v249
v_cvt_pk_bf16_f32 v240, v60, v61
v_cvt_pk_bf16_f32 v241, v62, v63
s_nop 1
v_mfma_f32_16x16x32_bf16 v[60:63], a[172:175], v[172:175], 0
v_exp_f32 v141, v141
v_accvgpr_write_b32 a236, v242
v_accvgpr_write_b32 a237, v243
v_accvgpr_write_b32 a238, v244
v_accvgpr_write_b32 a239, v245
v_mul_f32 v76, v76, v249
v_mul_f32 v77, v77, v249
v_mul_f32 v78, v78, v249
v_mul_f32 v79, v79, v249
v_cvt_pk_bf16_f32 v242, v76, v77
v_cvt_pk_bf16_f32 v243, v78, v79
s_nop 1
v_mfma_f32_16x16x32_bf16 v[76:79], a[176:179], v[172:175], 0
s_add_u32 s30, s30, 16384
v_exp_f32 v142, v142
v_mul_f32 v92, v92, v249
v_mul_f32 v93, v93, v249
v_mul_f32 v94, v94, v249
v_mul_f32 v95, v95, v249
v_cvt_pk_bf16_f32 v244, v92, v93
v_cvt_pk_bf16_f32 v245, v94, v95
s_nop 1
v_mfma_f32_16x16x32_bf16 v[92:95], a[180:183], v[172:175], 0
v_exp_f32 v143, v143
v_accvgpr_write_b32 a240, v234
v_accvgpr_write_b32 a241, v235
v_accvgpr_write_b32 a242, v236
v_accvgpr_write_b32 a243, v237
v_mul_f32 v108, v108, v249
v_mul_f32 v109, v109, v249
v_mul_f32 v110, v110, v249
v_mul_f32 v111, v111, v249
v_cvt_pk_bf16_f32 v234, v108, v109
v_cvt_pk_bf16_f32 v235, v110, v111
s_nop 1
v_mfma_f32_16x16x32_bf16 v[108:111], a[184:187], v[172:175], 0
s_cmp_eq_u32 s30, 163840
s_cselect_b32 s30, 0, s30
v_accvgpr_write_b32 a244, v238
v_mul_f32 v124, v124, v249
v_mul_f32 v125, v125, v249
v_mul_f32 v126, v126, v249
v_mul_f32 v127, v127, v249
v_cvt_pk_bf16_f32 v236, v124, v125
v_cvt_pk_bf16_f32 v237, v126, v127
s_nop 1
v_mfma_f32_16x16x32_bf16 v[124:127], a[188:191], v[172:175], 0
s_waitcnt lgkmcnt(0)
v_exp_f32 v156, v156
v_accvgpr_write_b32 a245, v239
v_accvgpr_write_b32 a246, v240
v_accvgpr_write_b32 a247, v241
v_accvgpr_write_b32 a248, v242
v_accvgpr_write_b32 a249, v243
v_accvgpr_write_b32 a250, v244
v_accvgpr_write_b32 a251, v245
v_accvgpr_write_b32 a252, v234
v_accvgpr_write_b32 a253, v235
v_accvgpr_write_b32 a254, v236
v_accvgpr_write_b32 a255, v237
v_add_f32 v252, v252, v128
v_add_f32 v252, v252, v129
v_cvt_pk_bf16_f32 v160, v128, v129
v_add_f32 v252, v252, v130
v_add_f32 v252, v252, v131
v_cvt_pk_bf16_f32 v161, v130, v131
v_add_f32 v252, v252, v144
v_add_f32 v252, v252, v145
v_cvt_pk_bf16_f32 v162, v144, v145
v_add_f32 v252, v252, v146
v_add_f32 v252, v252, v147
v_cvt_pk_bf16_f32 v163, v146, v147
v_add_f32 v253, v253, v132
v_add_f32 v253, v253, v133
v_cvt_pk_bf16_f32 v164, v132, v133
v_add_f32 v253, v253, v134
s_nop 1
s_mov_b32 s40, 3
L_loop2:
v_mfma_f32_16x16x32_bf16 v[128:131], a[128:131], a[64:67], v[176:179]
s_barrier
v_exp_f32 v157, v157
v_mfma_f32_16x16x32_bf16 v[128:131], a[132:135], a[68:71], v[128:131]
ds_read_b64_tr_b16 a[160:161], v196 offset:8192
v_add_f32 v253, v253, v135
v_mfma_f32_16x16x32_bf16 v[128:131], a[136:139], a[72:75], v[128:131]
s_add_u32 m0, s30, s29
v_exp_f32 v158, v158
v_mfma_f32_16x16x32_bf16 v[128:131], a[140:143], a[76:79], v[128:131]
ds_read_b64_tr_b16 a[162:163], v196 offset:12288
v_cvt_pk_bf16_f32 v165, v134, v135
v_mfma_f32_16x16x32_bf16 v[144:147], a[144:147], a[64:67], v[176:179]
v_exp_f32 v159, v159
v_mfma_f32_16x16x32_bf16 v[144:147], a[148:151], a[68:71], v[144:147]
ds_read_b64_tr_b16 a[164:165], v197 offset:8192
v_add_f32 v253, v253, v148
v_mfma_f32_16x16x32_bf16 v[144:147], a[152:155], a[72:75], v[144:147]
v_add_f32 v253, v253, v149
v_cvt_pk_bf16_f32 v166, v148, v149
v_mfma_f32_16x16x32_bf16 v[144:147], a[156:159], a[76:79], v[144:147]
ds_read_b64_tr_b16 a[166:167], v197 offset:12288
v_add_f32 v253, v253, v150
v_add_f32 v253, v253, v151
v_cvt_pk_bf16_f32 v167, v150, v151
v_mfma_f32_16x16x32_bf16 v[132:135], a[128:131], a[80:83], v[180:183]
buffer_load_dwordx4 v208, s[16:19], s34 offen offset:0 nt lds
v_add_f32 v254, v254, v136
v_mfma_f32_16x16x32_bf16 v[132:135], a[132:135], a[84:87], v[132:135]
ds_read_b64_tr_b16 a[168:169], v198 offset:8192
v_add_f32 v254, v254, v137
v_mfma_f32_16x16x32_bf16 v[132:135], a[136:139], a[88:91], v[132:135]
v_exp_f32 v128, v128
v_mfma_f32_16x16x32_bf16 v[132:135], a[140:143], a[92:95], v[132:135]
ds_read_b64_tr_b16 a[170:171], v198 offset:12288
v_cvt_pk_bf16_f32 v168, v136, v137
v_mfma_f32_16x16x32_bf16 v[148:151], a[144:147], a[80:83], v[180:183]
v_exp_f32 v129, v129
v_mfma_f32_16x16x32_bf16 v[148:151], a[148:151], a[84:87], v[148:151]
ds_read_b64_tr_b16 a[172:173], v199 offset:8192
v_add_f32 v254, v254, v138
v_mfma_f32_16x16x32_bf16 v[148:151], a[152:155], a[88:91], v[148:151]
v_exp_f32 v130, v130
v_mfma_f32_16x16x32_bf16 v[148:151], a[156:159], a[92:95], v[148:151]
ds_read_b64_tr_b16 a[174:175], v199 offset:12288
v_add_f32 v254, v254, v139
v_cvt_pk_bf16_f32 v169, v138, v139
v_add_f32 v254, v254, v152
v_add_f32 v254, v254, v153
v_cvt_pk_bf16_f32 v170, v152, v153
v_add_f32 v254, v254, v154
v_add_f32 v254, v254, v155
v_cvt_pk_bf16_f32 v171, v154, v155
v_mfma_f32_16x16x32_bf16 v[136:139], a[128:131], a[96:99], v[184:187]
v_exp_f32 v131, v131
v_mfma_f32_16x16x32_bf16 v[136:139], a[132:135], a[100:103], v[136:139]
ds_read_b64_tr_b16 a[176:177], v200 offset:8192
v_add_f32 v255, v255, v140
v_mfma_f32_16x16x32_bf16 v[136:139], a[136:139], a[104:107], v[136:139]
v_exp_f32 v144, v144
v_mfma_f32_16x16x32_bf16 v[136:139], a[140:143], a[108:111], v[136:139]
ds_read_b64_tr_b16 a[178:179], v200 offset:12288
v_add_f32 v255, v255, v141
v_mfma_f32_16x16x32_bf16 v[152:155], a[144:147], a[96:99], v[184:187]
v_exp_f32 v145, v145
v_mfma_f32_16x16x32_bf16 v[152:155], a[148:151], a[100:103], v[152:155]
ds_read_b64_tr_b16 a[180:181], v201 offset:8192
v_cvt_pk_bf16_f32 v172, v140, v141
v_mfma_f32_16x16x32_bf16 v[152:155], a[152:155], a[104:107], v[152:155]
v_exp_f32 v146, v146
v_mfma_f32_16x16x32_bf16 v[152:155], a[156:159], a[108:111], v[152:155]
ds_read_b64_tr_b16 a[182:183], v201 offset:12288
v_add_f32 v255, v255, v142
v_add_f32 v255, v255, v143
v_cvt_pk_bf16_f32 v173, v142, v143
v_add_f32 v255, v255, v156
v_add_f32 v255, v255, v157
v_cvt_pk_bf16_f32 v174, v156, v157
v_add_f32 v255, v255, v158
v_add_f32 v255, v255, v159
v_cvt_pk_bf16_f32 v175, v158, v159
v_mfma_f32_16x16x32_bf16 v[140:143], a[128:131], a[112:115], v[188:191]
buffer_load_dwordx4 v209, s[16:19], s34 offen offset:1024 nt lds
v_add_f32 v252, v252, v128
v_mfma_f32_16x16x32_bf16 v[140:143], a[132:135], a[116:119], v[140:143]
ds_read_b64_tr_b16 a[184:185], v202 offset:8192
v_add_f32 v252, v252, v129
v_mfma_f32_16x16x32_bf16 v[140:143], a[136:139], a[120:123], v[140:143]
v_exp_f32 v147, v147
v_mfma_f32_16x16x32_bf16 v[140:143], a[140:143], a[124:127], v[140:143]
ds_read_b64_tr_b16 a[186:187], v202 offset:12288
v_add_f32 v252, v252, v130
v_mfma_f32_16x16x32_bf16 v[156:159], a[144:147], a[112:115], v[188:191]
s_waitcnt lgkmcnt(4)
v_exp_f32 v132, v132
v_mfma_f32_16x16x32_bf16 v[156:159], a[148:151], a[116:119], v[156:159]
ds_read_b64_tr_b16 a[188:189], v203 offset:8192
v_add_f32 v252, v252, v131
v_mfma_f32_16x16x32_bf16 v[156:159], a[152:155], a[120:123], v[156:159]
v_exp_f32 v133, v133
v_mfma_f32_16x16x32_bf16 v[156:159], a[156:159], a[124:127], v[156:159]
ds_read_b64_tr_b16 a[190:191], v203 offset:12288
v_add_f32 v252, v252, v144
v_mfma_f32_16x16x32_bf16 v[0:3], a[160:163], v[160:163], v[0:3]
v_exp_f32 v134, v134
v_mfma_f32_16x16x32_bf16 v[16:19], a[164:167], v[160:163], v[16:19]
v_exp_f32 v135, v135
v_mfma_f32_16x16x32_bf16 v[32:35], a[168:171], v[160:163], v[32:35]
v_exp_f32 v148, v148
v_mfma_f32_16x16x32_bf16 v[48:51], a[172:175], v[160:163], v[48:51]
v_exp_f32 v149, v149
v_mfma_f32_16x16x32_bf16 v[64:67], a[176:179], v[160:163], v[64:67]
s_waitcnt lgkmcnt(0)
v_exp_f32 v150, v150
v_mfma_f32_16x16x32_bf16 v[80:83], a[180:183], v[160:163], v[80:83]
ds_read_b128 a[128:131], v192 offset:8192
v_add_f32 v252, v252, v145
v_mfma_f32_16x16x32_bf16 v[96:99], a[184:187], v[160:163], v[96:99]
v_exp_f32 v151, v151
v_mfma_f32_16x16x32_bf16 v[112:115], a[188:191], v[160:163], v[112:115]
ds_read_b128 a[132:135], v193 offset:8192
v_add_f32 v252, v252, v146
v_mfma_f32_16x16x32_bf16 v[4:7], a[160:163], v[164:167], v[4:7]
buffer_load_dwordx4 v208, s[16:19], s34 offen offset:2048 nt lds
v_cvt_pk_bf16_f32 v160, v128, v129
v_mfma_f32_16x16x32_bf16 v[20:23], a[164:167], v[164:167], v[20:23]
ds_read_b128 a[136:139], v194 offset:8192
v_cvt_pk_bf16_f32 v161, v130, v131
v_mfma_f32_16x16x32_bf16 v[36:39], a[168:171], v[164:167], v[36:39]
v_exp_f32 v136, v136
v_mfma_f32_16x16x32_bf16 v[52:55], a[172:175], v[164:167], v[52:55]
ds_read_b128 a[140:143], v195 offset:8192
v_cvt_pk_bf16_f32 v162, v144, v145
v_mfma_f32_16x16x32_bf16 v[68:71], a[176:179], v[164:167], v[68:71]
v_exp_f32 v137, v137
v_mfma_f32_16x16x32_bf16 v[84:87], a[180:183], v[164:167], v[84:87]
ds_read_b128 a[144:147], v192 offset:12288
v_add_f32 v252, v252, v147
v_mfma_f32_16x16x32_bf16 v[100:103], a[184:187], v[164:167], v[100:103]
v_exp_f32 v138, v138
v_mfma_f32_16x16x32_bf16 v[116:119], a[188:191], v[164:167], v[116:119]
ds_read_b128 a[148:151], v193 offset:12288
v_cvt_pk_bf16_f32 v163, v146, v147
v_mfma_f32_16x16x32_bf16 v[8:11], a[160:163], v[168:171], v[8:11]
s_sub_u32 s37, s35, s49
s_mov_b32 s49, s35
v_add_f32 v253, v253, v132
v_mfma_f32_16x16x32_bf16 v[24:27], a[164:167], v[168:171], v[24:27]
ds_read_b128 a[152:155], v194 offset:12288
v_add_f32 v253, v253, v133
v_mfma_f32_16x16x32_bf16 v[40:43], a[168:171], v[168:171], v[40:43]
s_add_u32 s35, s35, 16384
v_exp_f32 v139, v139
v_mfma_f32_16x16x32_bf16 v[56:59], a[172:175], v[168:171], v[56:59]
ds_read_b128 a[156:159], v195 offset:12288
v_cvt_pk_bf16_f32 v164, v132, v133
v_mfma_f32_16x16x32_bf16 v[72:75], a[176:179], v[168:171], v[72:75]
s_cmp_eq_u32 s35, 163840
s_cselect_b32 s35, 0, s35
v_add_f32 v253, v253, v134
v_mfma_f32_16x16x32_bf16 v[88:91], a[180:183], v[168:171], v[88:91]
v_exp_f32 v152, v152
v_mfma_f32_16x16x32_bf16 v[104:107], a[184:187], v[168:171], v[104:107]
v_exp_f32 v153, v153
v_mfma_f32_16x16x32_bf16 v[120:123], a[188:191], v[168:171], v[120:123]
v_exp_f32 v154, v154
v_mfma_f32_16x16x32_bf16 v[12:15], a[160:163], v[172:175], v[12:15]
buffer_load_dwordx4 v209, s[16:19], s34 offen offset:3072 nt lds
v_add_f32 v253, v253, v135
v_mfma_f32_16x16x32_bf16 v[28:31], a[164:167], v[172:175], v[28:31]
v_exp_f32 v155, v155
v_mfma_f32_16x16x32_bf16 v[44:47], a[168:171], v[172:175], v[44:47]
s_add_u32 s34, s34, 16384
v_exp_f32 v140, v140
v_mfma_f32_16x16x32_bf16 v[60:63], a[172:175], v[172:175], v[60:63]
v_exp_f32 v141, v141
v_mfma_f32_16x16x32_bf16 v[76:79], a[176:179], v[172:175], v[76:79]
s_add_u32 s30, s30, 16384
v_exp_f32 v142, v142
v_mfma_f32_16x16x32_bf16 v[92:95], a[180:183], v[172:175], v[92:95]
v_exp_f32 v143, v143
v_mfma_f32_16x16x32_bf16 v[108:111], a[184:187], v[172:175], v[108:111]
s_cmp_eq_u32 s30, 163840
s_cselect_b32 s30, 0, s30
v_cvt_pk_bf16_f32 v165, v134, v135
v_mfma_f32_16x16x32_bf16 v[124:127], a[188:191], v[172:175], v[124:127]
s_waitcnt lgkmcnt(0)
v_exp_f32 v156, v156
v_add_u32 v196, s37, v196
v_add_u32 v197, s37, v197
v_add_u32 v198, s37, v198
v_add_u32 v199, s37, v199
v_add_u32 v200, s37, v200
v_add_u32 v201, s37, v201
v_add_u32 v202, s37, v202
v_add_u32 v203, s37, v203
v_mfma_f32_16x16x32_bf16 v[128:131], a[128:131], a[64:67], v[176:179]
s_waitcnt vmcnt(20)
s_barrier
v_exp_f32 v157, v157
v_mfma_f32_16x16x32_bf16 v[128:131], a[132:135], a[68:71], v[128:131]
ds_read_b64_tr_b16 a[160:161], v196 offset:0
v_add_f32 v253, v253, v148
v_mfma_f32_16x16x32_bf16 v[128:131], a[136:139], a[72:75], v[128:131]
s_add_u32 m0, s30, s29
v_exp_f32 v158, v158
v_mfma_f32_16x16x32_bf16 v[128:131], a[140:143], a[76:79], v[128:131]
ds_read_b64_tr_b16 a[162:163], v196 offset:4096
v_add_f32 v253, v253, v149
v_mfma_f32_16x16x32_bf16 v[144:147], a[144:147], a[64:67], v[176:179]
v_exp_f32 v159, v159
v_mfma_f32_16x16x32_bf16 v[144:147], a[148:151], a[68:71], v[144:147]
ds_read_b64_tr_b16 a[164:165], v197 offset:0
v_cvt_pk_bf16_f32 v166, v148, v149
v_mfma_f32_16x16x32_bf16 v[144:147], a[152:155], a[72:75], v[144:147]
v_add_f32 v253, v253, v150
v_add_f32 v253, v253, v151
v_mfma_f32_16x16x32_bf16 v[144:147], a[156:159], a[76:79], v[144:147]
ds_read_b64_tr_b16 a[166:167], v197 offset:4096
v_cvt_pk_bf16_f32 v167, v150, v151
v_mfma_f32_16x16x32_bf16 v[132:135], a[128:131], a[80:83], v[180:183]
buffer_load_dwordx4 v204, s[12:15], s33 offen offset:0 nt lds
v_add_f32 v254, v254, v136
v_mfma_f32_16x16x32_bf16 v[132:135], a[132:135], a[84:87], v[132:135]
ds_read_b64_tr_b16 a[168:169], v198 offset:0
v_add_f32 v254, v254, v137
v_mfma_f32_16x16x32_bf16 v[132:135], a[136:139], a[88:91], v[132:135]
v_exp_f32 v128, v128
v_mfma_f32_16x16x32_bf16 v[132:135], a[140:143], a[92:95], v[132:135]
ds_read_b64_tr_b16 a[170:171], v198 offset:4096
v_cvt_pk_bf16_f32 v168, v136, v137
v_mfma_f32_16x16x32_bf16 v[148:151], a[144:147], a[80:83], v[180:183]
v_exp_f32 v129, v129
v_mfma_f32_16x16x32_bf16 v[148:151], a[148:151], a[84:87], v[148:151]
ds_read_b64_tr_b16 a[172:173], v199 offset:0
v_add_f32 v254, v254, v138
v_mfma_f32_16x16x32_bf16 v[148:151], a[152:155], a[88:91], v[148:151]
v_exp_f32 v130, v130
v_mfma_f32_16x16x32_bf16 v[148:151], a[156:159], a[92:95], v[148:151]
ds_read_b64_tr_b16 a[174:175], v199 offset:4096
v_add_f32 v254, v254, v139
v_cvt_pk_bf16_f32 v169, v138, v139
v_add_f32 v254, v254, v152
v_add_f32 v254, v254, v153
v_cvt_pk_bf16_f32 v170, v152, v153
v_add_f32 v254, v254, v154
v_add_f32 v254, v254, v155
v_cvt_pk_bf16_f32 v171, v154, v155
v_mfma_f32_16x16x32_bf16 v[136:139], a[128:131], a[96:99], v[184:187]
v_exp_f32 v131, v131
v_mfma_f32_16x16x32_bf16 v[136:139], a[132:135], a[100:103], v[136:139]
ds_read_b64_tr_b16 a[176:177], v200 offset:0
v_add_f32 v255, v255, v140
v_mfma_f32_16x16x32_bf16 v[136:139], a[136:139], a[104:107], v[136:139]
v_exp_f32 v144, v144
v_mfma_f32_16x16x32_bf16 v[136:139], a[140:143], a[108:111], v[136:139]
ds_read_b64_tr_b16 a[178:179], v200 offset:4096
v_add_f32 v255, v255, v141
v_mfma_f32_16x16x32_bf16 v[152:155], a[144:147], a[96:99], v[184:187]
v_exp_f32 v145, v145
v_mfma_f32_16x16x32_bf16 v[152:155], a[148:151], a[100:103], v[152:155]
ds_read_b64_tr_b16 a[180:181], v201 offset:0
v_cvt_pk_bf16_f32 v172, v140, v141
v_mfma_f32_16x16x32_bf16 v[152:155], a[152:155], a[104:107], v[152:155]
v_exp_f32 v146, v146
v_mfma_f32_16x16x32_bf16 v[152:155], a[156:159], a[108:111], v[152:155]
ds_read_b64_tr_b16 a[182:183], v201 offset:4096
v_add_f32 v255, v255, v142
v_add_f32 v255, v255, v143
v_cvt_pk_bf16_f32 v173, v142, v143
v_add_f32 v255, v255, v156
v_add_f32 v255, v255, v157
v_cvt_pk_bf16_f32 v174, v156, v157
v_add_f32 v255, v255, v158
v_add_f32 v255, v255, v159
v_cvt_pk_bf16_f32 v175, v158, v159
v_mfma_f32_16x16x32_bf16 v[140:143], a[128:131], a[112:115], v[188:191]
buffer_load_dwordx4 v205, s[12:15], s33 offen offset:1024 nt lds
v_add_f32 v252, v252, v128
v_mfma_f32_16x16x32_bf16 v[140:143], a[132:135], a[116:119], v[140:143]
ds_read_b64_tr_b16 a[184:185], v202 offset:0
v_add_f32 v252, v252, v129
v_mfma_f32_16x16x32_bf16 v[140:143], a[136:139], a[120:123], v[140:143]
v_exp_f32 v147, v147
v_mfma_f32_16x16x32_bf16 v[140:143], a[140:143], a[124:127], v[140:143]
ds_read_b64_tr_b16 a[186:187], v202 offset:4096
v_add_f32 v252, v252, v130
v_mfma_f32_16x16x32_bf16 v[156:159], a[144:147], a[112:115], v[188:191]
s_waitcnt lgkmcnt(4)
v_exp_f32 v132, v132
v_mfma_f32_16x16x32_bf16 v[156:159], a[148:151], a[116:119], v[156:159]
ds_read_b64_tr_b16 a[188:189], v203 offset:0
v_add_f32 v252, v252, v131
v_mfma_f32_16x16x32_bf16 v[156:159], a[152:155], a[120:123], v[156:159]
s_sub_u32 s37, s35, s48
s_mov_b32 s48, s35
v_add_f32 v252, v252, v144
v_mfma_f32_16x16x32_bf16 v[156:159], a[156:159], a[124:127], v[156:159]
ds_read_b64_tr_b16 a[190:191], v203 offset:4096
v_add_u32 v192, s37, v192
v_mfma_f32_16x16x32_bf16 v[0:3], a[160:163], v[160:163], v[0:3]
s_add_u32 s35, s35, 16384
v_exp_f32 v133, v133
v_mfma_f32_16x16x32_bf16 v[16:19], a[164:167], v[160:163], v[16:19]
v_exp_f32 v134, v134
v_mfma_f32_16x16x32_bf16 v[32:35], a[168:171], v[160:163], v[32:35]
s_cmp_eq_u32 s35, 163840
s_cselect_b32 s35, 0, s35
v_add_u32 v193, s37, v193
v_mfma_f32_16x16x32_bf16 v[48:51], a[172:175], v[160:163], v[48:51]
v_exp_f32 v135, v135
v_mfma_f32_16x16x32_bf16 v[64:67], a[176:179], v[160:163], v[64:67]
s_waitcnt lgkmcnt(0)
v_exp_f32 v148, v148
v_mfma_f32_16x16x32_bf16 v[80:83], a[180:183], v[160:163], v[80:83]
v_add_u32 v194, s37, v194
v_add_u32 v195, s37, v195
ds_read_b128 a[128:131], v192 offset:0
v_add_f32 v252, v252, v145
v_mfma_f32_16x16x32_bf16 v[96:99], a[184:187], v[160:163], v[96:99]
v_exp_f32 v149, v149
v_mfma_f32_16x16x32_bf16 v[112:115], a[188:191], v[160:163], v[112:115]
ds_read_b128 a[132:135], v193 offset:0
v_add_f32 v252, v252, v146
v_mfma_f32_16x16x32_bf16 v[4:7], a[160:163], v[164:167], v[4:7]
buffer_load_dwordx4 v206, s[12:15], s33 offen offset:2048 nt lds
v_cvt_pk_bf16_f32 v160, v128, v129
v_mfma_f32_16x16x32_bf16 v[20:23], a[164:167], v[164:167], v[20:23]
ds_read_b128 a[136:139], v194 offset:0
v_cvt_pk_bf16_f32 v161, v130, v131
v_mfma_f32_16x16x32_bf16 v[36:39], a[168:171], v[164:167], v[36:39]
v_exp_f32 v150, v150
v_mfma_f32_16x16x32_bf16 v[52:55], a[172:175], v[164:167], v[52:55]
ds_read_b128 a[140:143], v195 offset:0
v_cvt_pk_bf16_f32 v162, v144, v145
v_mfma_f32_16x16x32_bf16 v[68:71], a[176:179], v[164:167], v[68:71]
v_exp_f32 v151, v151
v_mfma_f32_16x16x32_bf16 v[84:87], a[180:183], v[164:167], v[84:87]
ds_read_b128 a[144:147], v192 offset:4096
v_add_f32 v252, v252, v147
v_mfma_f32_16x16x32_bf16 v[100:103], a[184:187], v[164:167], v[100:103]
v_exp_f32 v136, v136
v_mfma_f32_16x16x32_bf16 v[116:119], a[188:191], v[164:167], v[116:119]
ds_read_b128 a[148:151], v193 offset:4096
v_cvt_pk_bf16_f32 v163, v146, v147
v_mfma_f32_16x16x32_bf16 v[8:11], a[160:163], v[168:171], v[8:11]
v_exp_f32 v137, v137
v_mfma_f32_16x16x32_bf16 v[24:27], a[164:167], v[168:171], v[24:27]
ds_read_b128 a[152:155], v194 offset:4096
v_add_f32 v253, v253, v132
v_mfma_f32_16x16x32_bf16 v[40:43], a[168:171], v[168:171], v[40:43]
v_exp_f32 v138, v138
v_mfma_f32_16x16x32_bf16 v[56:59], a[172:175], v[168:171], v[56:59]
ds_read_b128 a[156:159], v195 offset:4096
v_add_f32 v253, v253, v133
v_mfma_f32_16x16x32_bf16 v[72:75], a[176:179], v[168:171], v[72:75]
v_exp_f32 v139, v139
v_mfma_f32_16x16x32_bf16 v[88:91], a[180:183], v[168:171], v[88:91]
v_exp_f32 v152, v152
v_mfma_f32_16x16x32_bf16 v[104:107], a[184:187], v[168:171], v[104:107]
v_exp_f32 v153, v153
v_mfma_f32_16x16x32_bf16 v[120:123], a[188:191], v[168:171], v[120:123]
v_exp_f32 v154, v154
v_mfma_f32_16x16x32_bf16 v[12:15], a[160:163], v[172:175], v[12:15]
buffer_load_dwordx4 v207, s[12:15], s33 offen offset:3072 nt lds
v_cvt_pk_bf16_f32 v164, v132, v133
v_mfma_f32_16x16x32_bf16 v[28:31], a[164:167], v[172:175], v[28:31]
v_exp_f32 v155, v155
v_mfma_f32_16x16x32_bf16 v[44:47], a[168:171], v[172:175], v[44:47]
s_add_u32 s33, s33, 16384
v_exp_f32 v140, v140
v_mfma_f32_16x16x32_bf16 v[60:63], a[172:175], v[172:175], v[60:63]
v_exp_f32 v141, v141
v_mfma_f32_16x16x32_bf16 v[76:79], a[176:179], v[172:175], v[76:79]
s_add_u32 s30, s30, 16384
v_exp_f32 v142, v142
v_mfma_f32_16x16x32_bf16 v[92:95], a[180:183], v[172:175], v[92:95]
v_exp_f32 v143, v143
v_mfma_f32_16x16x32_bf16 v[108:111], a[184:187], v[172:175], v[108:111]
s_cmp_eq_u32 s30, 163840
s_cselect_b32 s30, 0, s30
v_add_f32 v253, v253, v134
v_mfma_f32_16x16x32_bf16 v[124:127], a[188:191], v[172:175], v[124:127]
s_waitcnt lgkmcnt(0)
v_exp_f32 v156, v156
s_sub_u32 s40, s40, 1
s_cmp_lg_u32 s40, 0
s_cbranch_scc1 L_loop2
v_mfma_f32_16x16x32_bf16 v[128:131], a[128:131], a[64:67], v[176:179]
s_barrier
v_exp_f32 v157, v157
v_mfma_f32_16x16x32_bf16 v[128:131], a[132:135], a[68:71], v[128:131]
ds_read_b64_tr_b16 a[160:161], v196 offset:8192
v_add_f32 v253, v253, v135
v_mfma_f32_16x16x32_bf16 v[128:131], a[136:139], a[72:75], v[128:131]
s_add_u32 m0, s30, s29
v_exp_f32 v158, v158
v_mfma_f32_16x16x32_bf16 v[128:131], a[140:143], a[76:79], v[128:131]
ds_read_b64_tr_b16 a[162:163], v196 offset:12288
v_cvt_pk_bf16_f32 v165, v134, v135
v_mfma_f32_16x16x32_bf16 v[144:147], a[144:147], a[64:67], v[176:179]
v_exp_f32 v159, v159
v_mfma_f32_16x16x32_bf16 v[144:147], a[148:151], a[68:71], v[144:147]
ds_read_b64_tr_b16 a[164:165], v197 offset:8192
v_add_f32 v253, v253, v148
v_mfma_f32_16x16x32_bf16 v[144:147], a[152:155], a[72:75], v[144:147]
v_add_f32 v253, v253, v149
v_cvt_pk_bf16_f32 v166, v148, v149
v_mfma_f32_16x16x32_bf16 v[144:147], a[156:159], a[76:79], v[144:147]
ds_read_b64_tr_b16 a[166:167], v197 offset:12288
v_add_f32 v253, v253, v150
v_add_f32 v253, v253, v151
v_cvt_pk_bf16_f32 v167, v150, v151
v_mfma_f32_16x16x32_bf16 v[132:135], a[128:131], a[80:83], v[180:183]
buffer_load_dwordx4 v208, s[16:19], s34 offen offset:0 nt lds
v_add_f32 v254, v254, v136
v_mfma_f32_16x16x32_bf16 v[132:135], a[132:135], a[84:87], v[132:135]
ds_read_b64_tr_b16 a[168:169], v198 offset:8192
v_add_f32 v254, v254, v137
v_mfma_f32_16x16x32_bf16 v[132:135], a[136:139], a[88:91], v[132:135]
v_exp_f32 v128, v128
v_mfma_f32_16x16x32_bf16 v[132:135], a[140:143], a[92:95], v[132:135]
ds_read_b64_tr_b16 a[170:171], v198 offset:12288
v_cvt_pk_bf16_f32 v168, v136, v137
v_mfma_f32_16x16x32_bf16 v[148:151], a[144:147], a[80:83], v[180:183]
v_exp_f32 v129, v129
v_mfma_f32_16x16x32_bf16 v[148:151], a[148:151], a[84:87], v[148:151]
ds_read_b64_tr_b16 a[172:173], v199 offset:8192
v_add_f32 v254, v254, v138
v_mfma_f32_16x16x32_bf16 v[148:151], a[152:155], a[88:91], v[148:151]
v_exp_f32 v130, v130
v_mfma_f32_16x16x32_bf16 v[148:151], a[156:159], a[92:95], v[148:151]
ds_read_b64_tr_b16 a[174:175], v199 offset:12288
v_add_f32 v254, v254, v139
v_cvt_pk_bf16_f32 v169, v138, v139
v_add_f32 v254, v254, v152
v_add_f32 v254, v254, v153
v_cvt_pk_bf16_f32 v170, v152, v153
v_add_f32 v254, v254, v154
v_add_f32 v254, v254, v155
v_cvt_pk_bf16_f32 v171, v154, v155
v_mfma_f32_16x16x32_bf16 v[136:139], a[128:131], a[96:99], v[184:187]
v_exp_f32 v131, v131
v_mfma_f32_16x16x32_bf16 v[136:139], a[132:135], a[100:103], v[136:139]
ds_read_b64_tr_b16 a[176:177], v200 offset:8192
v_add_f32 v255, v255, v140
v_mfma_f32_16x16x32_bf16 v[136:139], a[136:139], a[104:107], v[136:139]
v_exp_f32 v144, v144
v_mfma_f32_16x16x32_bf16 v[136:139], a[140:143], a[108:111], v[136:139]
ds_read_b64_tr_b16 a[178:179], v200 offset:12288
v_add_f32 v255, v255, v141
v_mfma_f32_16x16x32_bf16 v[152:155], a[144:147], a[96:99], v[184:187]
v_exp_f32 v145, v145
v_mfma_f32_16x16x32_bf16 v[152:155], a[148:151], a[100:103], v[152:155]
ds_read_b64_tr_b16 a[180:181], v201 offset:8192
v_cvt_pk_bf16_f32 v172, v140, v141
v_mfma_f32_16x16x32_bf16 v[152:155], a[152:155], a[104:107], v[152:155]
v_exp_f32 v146, v146
v_mfma_f32_16x16x32_bf16 v[152:155], a[156:159], a[108:111], v[152:155]
ds_read_b64_tr_b16 a[182:183], v201 offset:12288
v_add_f32 v255, v255, v142
v_add_f32 v255, v255, v143
v_cvt_pk_bf16_f32 v173, v142, v143
v_add_f32 v255, v255, v156
v_add_f32 v255, v255, v157
v_cvt_pk_bf16_f32 v174, v156, v157
v_add_f32 v255, v255, v158
v_add_f32 v255, v255, v159
v_cvt_pk_bf16_f32 v175, v158, v159
v_mfma_f32_16x16x32_bf16 v[140:143], a[128:131], a[112:115], v[188:191]
buffer_load_dwordx4 v209, s[16:19], s34 offen offset:1024 nt lds
v_add_f32 v252, v252, v128
v_mfma_f32_16x16x32_bf16 v[140:143], a[132:135], a[116:119], v[140:143]
ds_read_b64_tr_b16 a[184:185], v202 offset:8192
v_add_f32 v252, v252, v129
v_mfma_f32_16x16x32_bf16 v[140:143], a[136:139], a[120:123], v[140:143]
v_exp_f32 v147, v147
v_mfma_f32_16x16x32_bf16 v[140:143], a[140:143], a[124:127], v[140:143]
ds_read_b64_tr_b16 a[186:187], v202 offset:12288
v_add_f32 v252, v252, v130
v_mfma_f32_16x16x32_bf16 v[156:159], a[144:147], a[112:115], v[188:191]
s_waitcnt lgkmcnt(4)
v_exp_f32 v132, v132
v_mfma_f32_16x16x32_bf16 v[156:159], a[148:151], a[116:119], v[156:159]
ds_read_b64_tr_b16 a[188:189], v203 offset:8192
v_add_f32 v252, v252, v131
v_mfma_f32_16x16x32_bf16 v[156:159], a[152:155], a[120:123], v[156:159]
v_exp_f32 v133, v133
v_mfma_f32_16x16x32_bf16 v[156:159], a[156:159], a[124:127], v[156:159]
ds_read_b64_tr_b16 a[190:191], v203 offset:12288
v_add_f32 v252, v252, v144
v_mfma_f32_16x16x32_bf16 v[0:3], a[160:163], v[160:163], v[0:3]
v_exp_f32 v134, v134
v_mfma_f32_16x16x32_bf16 v[16:19], a[164:167], v[160:163], v[16:19]
v_exp_f32 v135, v135
v_mfma_f32_16x16x32_bf16 v[32:35], a[168:171], v[160:163], v[32:35]
v_exp_f32 v148, v148
v_mfma_f32_16x16x32_bf16 v[48:51], a[172:175], v[160:163], v[48:51]
v_exp_f32 v149, v149
v_mfma_f32_16x16x32_bf16 v[64:67], a[176:179], v[160:163], v[64:67]
s_waitcnt lgkmcnt(0)
v_exp_f32 v150, v150
v_mfma_f32_16x16x32_bf16 v[80:83], a[180:183], v[160:163], v[80:83]
ds_read_b128 a[128:131], v192 offset:8192
v_add_f32 v252, v252, v145
v_mfma_f32_16x16x32_bf16 v[96:99], a[184:187], v[160:163], v[96:99]
v_exp_f32 v151, v151
v_mfma_f32_16x16x32_bf16 v[112:115], a[188:191], v[160:163], v[112:115]
ds_read_b128 a[132:135], v193 offset:8192
v_add_f32 v252, v252, v146
v_mfma_f32_16x16x32_bf16 v[4:7], a[160:163], v[164:167], v[4:7]
buffer_load_dwordx4 v208, s[16:19], s34 offen offset:2048 nt lds
v_cvt_pk_bf16_f32 v160, v128, v129
v_mfma_f32_16x16x32_bf16 v[20:23], a[164:167], v[164:167], v[20:23]
ds_read_b128 a[136:139], v194 offset:8192
v_cvt_pk_bf16_f32 v161, v130, v131
v_mfma_f32_16x16x32_bf16 v[36:39], a[168:171], v[164:167], v[36:39]
v_exp_f32 v136, v136
v_mfma_f32_16x16x32_bf16 v[52:55], a[172:175], v[164:167], v[52:55]
ds_read_b128 a[140:143], v195 offset:8192
v_cvt_pk_bf16_f32 v162, v144, v145
v_mfma_f32_16x16x32_bf16 v[68:71], a[176:179], v[164:167], v[68:71]
v_exp_f32 v137, v137
v_mfma_f32_16x16x32_bf16 v[84:87], a[180:183], v[164:167], v[84:87]
ds_read_b128 a[144:147], v192 offset:12288
v_add_f32 v252, v252, v147
v_mfma_f32_16x16x32_bf16 v[100:103], a[184:187], v[164:167], v[100:103]
v_exp_f32 v138, v138
v_mfma_f32_16x16x32_bf16 v[116:119], a[188:191], v[164:167], v[116:119]
ds_read_b128 a[148:151], v193 offset:12288
v_cvt_pk_bf16_f32 v163, v146, v147
v_mfma_f32_16x16x32_bf16 v[8:11], a[160:163], v[168:171], v[8:11]
s_sub_u32 s37, s35, s49
s_mov_b32 s49, s35
v_add_f32 v253, v253, v132
v_mfma_f32_16x16x32_bf16 v[24:27], a[164:167], v[168:171], v[24:27]
ds_read_b128 a[152:155], v194 offset:12288
v_add_f32 v253, v253, v133
v_mfma_f32_16x16x32_bf16 v[40:43], a[168:171], v[168:171], v[40:43]
s_add_u32 s35, s35, 16384
v_exp_f32 v139, v139
v_mfma_f32_16x16x32_bf16 v[56:59], a[172:175], v[168:171], v[56:59]
ds_read_b128 a[156:159], v195 offset:12288
v_cvt_pk_bf16_f32 v164, v132, v133
v_mfma_f32_16x16x32_bf16 v[72:75], a[176:179], v[168:171], v[72:75]
s_cmp_eq_u32 s35, 163840
s_cselect_b32 s35, 0, s35
v_add_f32 v253, v253, v134
v_mfma_f32_16x16x32_bf16 v[88:91], a[180:183], v[168:171], v[88:91]
v_exp_f32 v152, v152
v_mfma_f32_16x16x32_bf16 v[104:107], a[184:187], v[168:171], v[104:107]
v_exp_f32 v153, v153
v_mfma_f32_16x16x32_bf16 v[120:123], a[188:191], v[168:171], v[120:123]
v_exp_f32 v154, v154
v_mfma_f32_16x16x32_bf16 v[12:15], a[160:163], v[172:175], v[12:15]
buffer_load_dwordx4 v209, s[16:19], s34 offen offset:3072 nt lds
v_add_f32 v253, v253, v135
v_mfma_f32_16x16x32_bf16 v[28:31], a[164:167], v[172:175], v[28:31]
v_exp_f32 v155, v155
v_mfma_f32_16x16x32_bf16 v[44:47], a[168:171], v[172:175], v[44:47]
s_add_u32 s34, s34, 16384
v_exp_f32 v140, v140
v_mfma_f32_16x16x32_bf16 v[60:63], a[172:175], v[172:175], v[60:63]
v_exp_f32 v141, v141
v_mfma_f32_16x16x32_bf16 v[76:79], a[176:179], v[172:175], v[76:79]
s_add_u32 s30, s30, 16384
v_exp_f32 v142, v142
v_mfma_f32_16x16x32_bf16 v[92:95], a[180:183], v[172:175], v[92:95]
v_exp_f32 v143, v143
v_mfma_f32_16x16x32_bf16 v[108:111], a[184:187], v[172:175], v[108:111]
s_cmp_eq_u32 s30, 163840
s_cselect_b32 s30, 0, s30
v_cvt_pk_bf16_f32 v165, v134, v135
v_mfma_f32_16x16x32_bf16 v[124:127], a[188:191], v[172:175], v[124:127]
s_waitcnt lgkmcnt(0)
v_exp_f32 v156, v156
v_add_u32 v196, s37, v196
v_add_u32 v197, s37, v197
v_add_u32 v198, s37, v198
v_add_u32 v199, s37, v199
v_add_u32 v200, s37, v200
v_add_u32 v201, s37, v201
v_add_u32 v202, s37, v202
v_add_u32 v203, s37, v203
v_mfma_f32_16x16x32_bf16 v[128:131], a[128:131], a[64:67], v[176:179]
s_waitcnt vmcnt(20)
s_barrier
buffer_store_dwordx4 a[192:195], v214, s[20:23], s44 offen offset:0 sc1
v_add_f32 v253, v253, v148
v_mfma_f32_16x16x32_bf16 v[128:131], a[132:135], a[68:71], v[128:131]
ds_read_b64_tr_b16 a[160:161], v196 offset:0
v_add_f32 v253, v253, v149
v_mfma_f32_16x16x32_bf16 v[128:131], a[136:139], a[72:75], v[128:131]
s_add_u32 m0, s30, s29
v_exp_f32 v157, v157
v_mfma_f32_16x16x32_bf16 v[128:131], a[140:143], a[76:79], v[128:131]
ds_read_b64_tr_b16 a[162:163], v196 offset:4096
v_cvt_pk_bf16_f32 v166, v148, v149
v_mfma_f32_16x16x32_bf16 v[144:147], a[144:147], a[64:67], v[176:179]
v_exp_f32 v158, v158
v_mfma_f32_16x16x32_bf16 v[144:147], a[148:151], a[68:71], v[144:147]
ds_read_b64_tr_b16 a[164:165], v197 offset:0
v_add_f32 v253, v253, v150
v_mfma_f32_16x16x32_bf16 v[144:147], a[152:155], a[72:75], v[144:147]
v_exp_f32 v159, v159
v_mfma_f32_16x16x32_bf16 v[144:147], a[156:159], a[76:79], v[144:147]
ds_read_b64_tr_b16 a[166:167], v197 offset:4096
v_add_f32 v253, v253, v151
v_cvt_pk_bf16_f32 v167, v150, v151
v_mfma_f32_16x16x32_bf16 v[132:135], a[128:131], a[80:83], v[180:183]
buffer_load_dwordx4 v204, s[12:15], s33 offen offset:0 nt lds
v_add_f32 v254, v254, v136
v_mfma_f32_16x16x32_bf16 v[132:135], a[132:135], a[84:87], v[132:135]
ds_read_b64_tr_b16 a[168:169], v198 offset:0
v_add_f32 v254, v254, v137
v_mfma_f32_16x16x32_bf16 v[132:135], a[136:139], a[88:91], v[132:135]
buffer_store_dwordx4 a[196:199], v214, s[20:23], s44 offen offset:1024 sc1
v_cvt_pk_bf16_f32 v168, v136, v137
v_mfma_f32_16x16x32_bf16 v[132:135], a[140:143], a[92:95], v[132:135]
ds_read_b64_tr_b16 a[170:171], v198 offset:4096
v_add_f32 v254, v254, v138
v_mfma_f32_16x16x32_bf16 v[148:151], a[144:147], a[80:83], v[180:183]
v_exp_f32 v128, v128
v_mfma_f32_16x16x32_bf16 v[148:151], a[148:151], a[84:87], v[148:151]
ds_read_b64_tr_b16 a[172:173], v199 offset:0
v_add_f32 v254, v254, v139
v_mfma_f32_16x16x32_bf16 v[148:151], a[152:155], a[88:91], v[148:151]
v_exp_f32 v129, v129
v_mfma_f32_16x16x32_bf16 v[148:151], a[156:159], a[92:95], v[148:151]
ds_read_b64_tr_b16 a[174:175], v199 offset:4096
v_cvt_pk_bf16_f32 v169, v138, v139
v_add_f32 v254, v254, v152
v_add_f32 v254, v254, v153
v_cvt_pk_bf16_f32 v170, v152, v153
v_add_f32 v254, v254, v154
v_add_f32 v254, v254, v155
v_cvt_pk_bf16_f32 v171, v154, v155
v_mfma_f32_16x16x32_bf16 v[136:139], a[128:131], a[96:99], v[184:187]
buffer_store_dwordx4 a[200:203], v214, s[20:23], s44 offen offset:2048 sc1
v_add_f32 v255, v255, v140
v_mfma_f32_16x16x32_bf16 v[136:139], a[132:135], a[100:103], v[136:139]
ds_read_b64_tr_b16 a[176:177], v200 offset:0
v_add_f32 v255, v255, v141
v_mfma_f32_16x16x32_bf16 v[136:139], a[136:139], a[104:107], v[136:139]
v_exp_f32 v130, v130
v_mfma_f32_16x16x32_bf16 v[136:139], a[140:143], a[108:111], v[136:139]
ds_read_b64_tr_b16 a[178:179], v200 offset:4096
v_cvt_pk_bf16_f32 v172, v140, v141
v_mfma_f32_16x16x32_bf16 v[152:155], a[144:147], a[96:99], v[184:187]
v_exp_f32 v131, v131
v_mfma_f32_16x16x32_bf16 v[152:155], a[148:151], a[100:103], v[152:155]
ds_read_b64_tr_b16 a[180:181], v201 offset:0
v_add_f32 v255, v255, v142
v_mfma_f32_16x16x32_bf16 v[152:155], a[152:155], a[104:107], v[152:155]
v_exp_f32 v144, v144
v_mfma_f32_16x16x32_bf16 v[152:155], a[156:159], a[108:111], v[152:155]
ds_read_b64_tr_b16 a[182:183], v201 offset:4096
v_add_f32 v255, v255, v143
v_cvt_pk_bf16_f32 v173, v142, v143
v_add_f32 v255, v255, v156
v_add_f32 v255, v255, v157
v_cvt_pk_bf16_f32 v174, v156, v157
v_add_f32 v255, v255, v158
v_add_f32 v255, v255, v159
v_cvt_pk_bf16_f32 v175, v158, v159
v_mfma_f32_16x16x32_bf16 v[140:143], a[128:131], a[112:115], v[188:191]
buffer_load_dwordx4 v205, s[12:15], s33 offen offset:1024 nt lds
v_add_f32 v252, v252, v128
v_mfma_f32_16x16x32_bf16 v[140:143], a[132:135], a[116:119], v[140:143]
ds_read_b64_tr_b16 a[184:185], v202 offset:0
v_add_f32 v252, v252, v129
v_mfma_f32_16x16x32_bf16 v[140:143], a[136:139], a[120:123], v[140:143]
buffer_store_dwordx4 a[204:207], v214, s[20:23], s44 offen offset:3072 sc1
v_add_f32 v252, v252, v130
v_mfma_f32_16x16x32_bf16 v[140:143], a[140:143], a[124:127], v[140:143]
ds_read_b64_tr_b16 a[186:187], v202 offset:4096
v_add_f32 v252, v252, v131
v_mfma_f32_16x16x32_bf16 v[156:159], a[144:147], a[112:115], v[188:191]
s_waitcnt lgkmcnt(4)
v_exp_f32 v145, v145
v_mfma_f32_16x16x32_bf16 v[156:159], a[148:151], a[116:119], v[156:159]
ds_read_b64_tr_b16 a[188:189], v203 offset:0
v_add_f32 v252, v252, v144
v_mfma_f32_16x16x32_bf16 v[156:159], a[152:155], a[120:123], v[156:159]
s_sub_u32 s37, s35, s48
s_mov_b32 s48, s35
v_add_f32 v252, v252, v145
v_mfma_f32_16x16x32_bf16 v[156:159], a[156:159], a[124:127], v[156:159]
ds_read_b64_tr_b16 a[190:191], v203 offset:4096
v_add_u32 v192, s37, v192
v_mfma_f32_16x16x32_bf16 v[0:3], a[160:163], v[160:163], v[0:3]
s_add_u32 s35, s35, 16384
v_exp_f32 v146, v146
v_mfma_f32_16x16x32_bf16 v[16:19], a[164:167], v[160:163], v[16:19]
buffer_store_dwordx4 a[208:211], v214, s[20:23], s45 offen offset:0 sc1
v_add_u32 v193, s37, v193
v_mfma_f32_16x16x32_bf16 v[32:35], a[168:171], v[160:163], v[32:35]
s_cmp_eq_u32 s35, 163840
s_cselect_b32 s35, 0, s35
v_add_u32 v194, s37, v194
v_mfma_f32_16x16x32_bf16 v[48:51], a[172:175], v[160:163], v[48:51]
v_exp_f32 v147, v147
v_mfma_f32_16x16x32_bf16 v[64:67], a[176:179], v[160:163], v[64:67]
s_waitcnt lgkmcnt(0)
v_exp_f32 v132, v132
v_mfma_f32_16x16x32_bf16 v[80:83], a[180:183], v[160:163], v[80:83]
v_add_u32 v195, s37, v195
ds_read_b128 a[128:131], v192 offset:0
v_add_f32 v252, v252, v146
v_mfma_f32_16x16x32_bf16 v[96:99], a[184:187], v[160:163], v[96:99]
v_exp_f32 v133, v133
v_mfma_f32_16x16x32_bf16 v[112:115], a[188:191], v[160:163], v[112:115]
ds_read_b128 a[132:135], v193 offset:0
v_add_f32 v252, v252, v147
v_mfma_f32_16x16x32_bf16 v[4:7], a[160:163], v[164:167], v[4:7]
buffer_load_dwordx4 v206, s[12:15], s33 offen offset:2048 nt lds
v_cvt_pk_bf16_f32 v160, v128, v129
v_mfma_f32_16x16x32_bf16 v[20:23], a[164:167], v[164:167], v[20:23]
ds_read_b128 a[136:139], v194 offset:0
v_cvt_pk_bf16_f32 v161, v130, v131
v_mfma_f32_16x16x32_bf16 v[36:39], a[168:171], v[164:167], v[36:39]
buffer_store_dwordx4 a[212:215], v214, s[20:23], s45 offen offset:1024 sc1
v_cvt_pk_bf16_f32 v162, v144, v145
v_mfma_f32_16x16x32_bf16 v[52:55], a[172:175], v[164:167], v[52:55]
ds_read_b128 a[140:143], v195 offset:0
v_cvt_pk_bf16_f32 v163, v146, v147
v_mfma_f32_16x16x32_bf16 v[68:71], a[176:179], v[164:167], v[68:71]
v_exp_f32 v134, v134
v_mfma_f32_16x16x32_bf16 v[84:87], a[180:183], v[164:167], v[84:87]
ds_read_b128 a[144:147], v192 offset:4096
v_add_f32 v253, v253, v132
v_mfma_f32_16x16x32_bf16 v[100:103], a[184:187], v[164:167], v[100:103]
v_exp_f32 v135, v135
v_mfma_f32_16x16x32_bf16 v[116:119], a[188:191], v[164:167], v[116:119]
ds_read_b128 a[148:151], v193 offset:4096
v_add_f32 v253, v253, v133
v_mfma_f32_16x16x32_bf16 v[8:11], a[160:163], v[168:171], v[8:11]
buffer_store_dwordx4 a[216:219], v214, s[20:23], s45 offen offset:2048 sc1
v_cvt_pk_bf16_f32 v164, v132, v133
v_mfma_f32_16x16x32_bf16 v[24:27], a[164:167], v[168:171], v[24:27]
ds_read_b128 a[152:155], v194 offset:4096
v_add_f32 v253, v253, v134
v_mfma_f32_16x16x32_bf16 v[40:43], a[168:171], v[168:171], v[40:43]
v_exp_f32 v148, v148
v_mfma_f32_16x16x32_bf16 v[56:59], a[172:175], v[168:171], v[56:59]
ds_read_b128 a[156:159], v195 offset:4096
v_add_f32 v253, v253, v135
v_mfma_f32_16x16x32_bf16 v[72:75], a[176:179], v[168:171], v[72:75]
v_exp_f32 v149, v149
v_mfma_f32_16x16x32_bf16 v[88:91], a[180:183], v[168:171], v[88:91]
v_exp_f32 v150, v150
v_mfma_f32_16x16x32_bf16 v[104:107], a[184:187], v[168:171], v[104:107]
v_exp_f32 v151, v151
v_mfma_f32_16x16x32_bf16 v[120:123], a[188:191], v[168:171], v[120:123]
v_exp_f32 v136, v136
v_mfma_f32_16x16x32_bf16 v[12:15], a[160:163], v[172:175], v[12:15]
buffer_load_dwordx4 v207, s[12:15], s33 offen offset:3072 nt lds
v_cvt_pk_bf16_f32 v165, v134, v135
v_mfma_f32_16x16x32_bf16 v[28:31], a[164:167], v[172:175], v[28:31]
buffer_store_dwordx4 a[220:223], v214, s[20:23], s45 offen offset:3072 sc1
v_add_f32 v253, v253, v148
v_mfma_f32_16x16x32_bf16 v[44:47], a[168:171], v[172:175], v[44:47]
s_add_u32 s33, s33, 16384
v_exp_f32 v137, v137
v_mfma_f32_16x16x32_bf16 v[60:63], a[172:175], v[172:175], v[60:63]
v_exp_f32 v138, v138
v_mfma_f32_16x16x32_bf16 v[76:79], a[176:179], v[172:175], v[76:79]
s_add_u32 s30, s30, 16384
v_exp_f32 v139, v139
v_mfma_f32_16x16x32_bf16 v[92:95], a[180:183], v[172:175], v[92:95]
v_exp_f32 v152, v152
v_mfma_f32_16x16x32_bf16 v[108:111], a[184:187], v[172:175], v[108:111]
s_cmp_eq_u32 s30, 163840
s_cselect_b32 s30, 0, s30
v_add_f32 v253, v253, v149
v_mfma_f32_16x16x32_bf16 v[124:127], a[188:191], v[172:175], v[124:127]
s_waitcnt lgkmcnt(0)
v_exp_f32 v153, v153
v_mfma_f32_16x16x32_bf16 v[128:131], a[128:131], a[64:67], v[176:179]
s_barrier
buffer_store_dwordx4 a[224:227], v214, s[20:23], s46 offen offset:0 sc1
v_cvt_pk_bf16_f32 v166, v148, v149
v_mfma_f32_16x16x32_bf16 v[128:131], a[132:135], a[68:71], v[128:131]
ds_read_b64_tr_b16 a[160:161], v196 offset:8192
v_add_f32 v253, v253, v150
v_mfma_f32_16x16x32_bf16 v[128:131], a[136:139], a[72:75], v[128:131]
s_add_u32 m0, s30, s29
v_exp_f32 v154, v154
v_mfma_f32_16x16x32_bf16 v[128:131], a[140:143], a[76:79], v[128:131]
ds_read_b64_tr_b16 a[162:163], v196 offset:12288
v_add_f32 v253, v253, v151
v_mfma_f32_16x16x32_bf16 v[144:147], a[144:147], a[64:67], v[176:179]
v_exp_f32 v155, v155
v_mfma_f32_16x16x32_bf16 v[144:147], a[148:151], a[68:71], v[144:147]
ds_read_b64_tr_b16 a[164:165], v197 offset:8192
v_cvt_pk_bf16_f32 v167, v150, v151
v_mfma_f32_16x16x32_bf16 v[144:147], a[152:155], a[72:75], v[144:147]
v_exp_f32 v140, v140
v_mfma_f32_16x16x32_bf16 v[144:147], a[156:159], a[76:79], v[144:147]
ds_read_b64_tr_b16 a[166:167], v197 offset:12288
v_add_f32 v254, v254, v136
v_mfma_f32_16x16x32_bf16 v[132:135], a[128:131], a[80:83], v[180:183]
buffer_load_dwordx4 v208, s[16:19], s34 offen offset:0 nt lds
v_add_f32 v254, v254, v137
v_mfma_f32_16x16x32_bf16 v[132:135], a[132:135], a[84:87], v[132:135]
ds_read_b64_tr_b16 a[168:169], v198 offset:8192
v_cvt_pk_bf16_f32 v168, v136, v137
v_mfma_f32_16x16x32_bf16 v[132:135], a[136:139], a[88:91], v[132:135]
buffer_store_dwordx4 a[228:231], v214, s[20:23], s46 offen offset:1024 sc1
v_add_f32 v254, v254, v138
v_mfma_f32_16x16x32_bf16 v[132:135], a[140:143], a[92:95], v[132:135]
ds_read_b64_tr_b16 a[170:171], v198 offset:12288
v_add_f32 v254, v254, v139
v_mfma_f32_16x16x32_bf16 v[148:151], a[144:147], a[80:83], v[180:183]
v_exp_f32 v141, v141
v_mfma_f32_16x16x32_bf16 v[148:151], a[148:151], a[84:87], v[148:151]
ds_read_b64_tr_b16 a[172:173], v199 offset:8192
v_cvt_pk_bf16_f32 v169, v138, v139
v_mfma_f32_16x16x32_bf16 v[148:151], a[152:155], a[88:91], v[148:151]
v_exp_f32 v142, v142
v_mfma_f32_16x16x32_bf16 v[148:151], a[156:159], a[92:95], v[148:151]
ds_read_b64_tr_b16 a[174:175], v199 offset:12288
v_add_f32 v254, v254, v152
v_add_f32 v254, v254, v153
v_cvt_pk_bf16_f32 v170, v152, v153
v_add_f32 v254, v254, v154
v_add_f32 v254, v254, v155
v_cvt_pk_bf16_f32 v171, v154, v155
v_mfma_f32_16x16x32_bf16 v[136:139], a[128:131], a[96:99], v[184:187]
buffer_store_dwordx4 a[232:235], v214, s[20:23], s46 offen offset:2048 sc1
v_add_f32 v255, v255, v140
v_mfma_f32_16x16x32_bf16 v[136:139], a[132:135], a[100:103], v[136:139]
ds_read_b64_tr_b16 a[176:177], v200 offset:8192
v_add_f32 v255, v255, v141
v_mfma_f32_16x16x32_bf16 v[136:139], a[136:139], a[104:107], v[136:139]
v_exp_f32 v143, v143
v_mfma_f32_16x16x32_bf16 v[136:139], a[140:143], a[108:111], v[136:139]
ds_read_b64_tr_b16 a[178:179], v200 offset:12288
v_cvt_pk_bf16_f32 v172, v140, v141
v_mfma_f32_16x16x32_bf16 v[152:155], a[144:147], a[96:99], v[184:187]
v_exp_f32 v156, v156
v_mfma_f32_16x16x32_bf16 v[152:155], a[148:151], a[100:103], v[152:155]
ds_read_b64_tr_b16 a[180:181], v201 offset:8192
v_add_f32 v255, v255, v142
v_mfma_f32_16x16x32_bf16 v[152:155], a[152:155], a[104:107], v[152:155]
v_exp_f32 v157, v157
v_mfma_f32_16x16x32_bf16 v[152:155], a[156:159], a[108:111], v[152:155]
ds_read_b64_tr_b16 a[182:183], v201 offset:12288
v_add_f32 v255, v255, v143
v_cvt_pk_bf16_f32 v173, v142, v143
v_add_f32 v255, v255, v156
v_add_f32 v255, v255, v157
v_cvt_pk_bf16_f32 v174, v156, v157
v_exp_f32 v158, v158
s_nop 0
v_add_f32 v255, v255, v158
v_exp_f32 v159, v159
s_nop 0
v_add_f32 v255, v255, v159
v_cvt_pk_bf16_f32 v175, v158, v159
v_mfma_f32_16x16x32_bf16 v[140:143], a[128:131], a[112:115], v[188:191]
buffer_load_dwordx4 v209, s[16:19], s34 offen offset:1024 nt lds
v_mfma_f32_16x16x32_bf16 v[140:143], a[132:135], a[116:119], v[140:143]
ds_read_b64_tr_b16 a[184:185], v202 offset:8192
v_mfma_f32_16x16x32_bf16 v[140:143], a[136:139], a[120:123], v[140:143]
buffer_store_dwordx4 a[236:239], v214, s[20:23], s46 offen offset:3072 sc1
v_mfma_f32_16x16x32_bf16 v[140:143], a[140:143], a[124:127], v[140:143]
ds_read_b64_tr_b16 a[186:187], v202 offset:12288
v_mfma_f32_16x16x32_bf16 v[156:159], a[144:147], a[112:115], v[188:191]
s_waitcnt lgkmcnt(4)
v_exp_f32 v128, v128
v_mfma_f32_16x16x32_bf16 v[156:159], a[148:151], a[116:119], v[156:159]
ds_read_b64_tr_b16 a[188:189], v203 offset:8192
v_add_f32 v252, v252, v128
v_mfma_f32_16x16x32_bf16 v[156:159], a[152:155], a[120:123], v[156:159]
v_exp_f32 v129, v129
v_mfma_f32_16x16x32_bf16 v[156:159], a[156:159], a[124:127], v[156:159]
ds_read_b64_tr_b16 a[190:191], v203 offset:12288
v_add_f32 v252, v252, v129
v_mfma_f32_16x16x32_bf16 v[0:3], a[160:163], v[160:163], v[0:3]
buffer_store_dwordx4 a[240:243], v214, s[20:23], s47 offen offset:0 sc1
v_mfma_f32_16x16x32_bf16 v[16:19], a[164:167], v[160:163], v[16:19]
v_exp_f32 v130, v130
v_mfma_f32_16x16x32_bf16 v[32:35], a[168:171], v[160:163], v[32:35]
v_exp_f32 v131, v131
v_mfma_f32_16x16x32_bf16 v[48:51], a[172:175], v[160:163], v[48:51]
v_exp_f32 v144, v144
v_mfma_f32_16x16x32_bf16 v[64:67], a[176:179], v[160:163], v[64:67]
s_waitcnt lgkmcnt(0)
v_exp_f32 v145, v145
v_mfma_f32_16x16x32_bf16 v[80:83], a[180:183], v[160:163], v[80:83]
ds_read_b128 a[128:131], v192 offset:8192
v_add_f32 v252, v252, v130
v_mfma_f32_16x16x32_bf16 v[96:99], a[184:187], v[160:163], v[96:99]
v_exp_f32 v146, v146
v_mfma_f32_16x16x32_bf16 v[112:115], a[188:191], v[160:163], v[112:115]
ds_read_b128 a[132:135], v193 offset:8192
v_add_f32 v252, v252, v131
v_mfma_f32_16x16x32_bf16 v[4:7], a[160:163], v[164:167], v[4:7]
buffer_load_dwordx4 v208, s[16:19], s34 offen offset:2048 nt lds
v_cvt_pk_bf16_f32 v160, v128, v129
v_mfma_f32_16x16x32_bf16 v[20:23], a[164:167], v[164:167], v[20:23]
ds_read_b128 a[136:139], v194 offset:8192
v_cvt_pk_bf16_f32 v161, v130, v131
v_mfma_f32_16x16x32_bf16 v[36:39], a[168:171], v[164:167], v[36:39]
buffer_store_dwordx4 a[244:247], v214, s[20:23], s47 offen offset:1024 sc1
v_add_f32 v252, v252, v144
v_mfma_f32_16x16x32_bf16 v[52:55], a[172:175], v[164:167], v[52:55]
ds_read_b128 a[140:143], v195 offset:8192
v_add_f32 v252, v252, v145
v_mfma_f32_16x16x32_bf16 v[68:71], a[176:179], v[164:167], v[68:71]
v_exp_f32 v147, v147
v_mfma_f32_16x16x32_bf16 v[84:87], a[180:183], v[164:167], v[84:87]
ds_read_b128 a[144:147], v192 offset:12288
v_cvt_pk_bf16_f32 v162, v144, v145
v_mfma_f32_16x16x32_bf16 v[100:103], a[184:187], v[164:167], v[100:103]
v_exp_f32 v132, v132
v_mfma_f32_16x16x32_bf16 v[116:119], a[188:191], v[164:167], v[116:119]
ds_read_b128 a[148:151], v193 offset:12288
v_add_f32 v252, v252, v146
v_mfma_f32_16x16x32_bf16 v[8:11], a[160:163], v[168:171], v[8:11]
s_sub_u32 s37, s35, s49
s_mov_b32 s49, s35
v_add_f32 v252, v252, v147
v_mfma_f32_16x16x32_bf16 v[24:27], a[164:167], v[168:171], v[24:27]
ds_read_b128 a[152:155], v194 offset:12288
v_cvt_pk_bf16_f32 v163, v146, v147
v_mfma_f32_16x16x32_bf16 v[40:43], a[168:171], v[168:171], v[40:43]
s_add_u32 s35, s35, 16384
v_exp_f32 v133, v133
v_mfma_f32_16x16x32_bf16 v[56:59], a[172:175], v[168:171], v[56:59]
ds_read_b128 a[156:159], v195 offset:12288
v_add_f32 v253, v253, v132
v_mfma_f32_16x16x32_bf16 v[72:75], a[176:179], v[168:171], v[72:75]
s_cmp_eq_u32 s35, 163840
s_cselect_b32 s35, 0, s35
v_add_f32 v253, v253, v133
v_mfma_f32_16x16x32_bf16 v[88:91], a[180:183], v[168:171], v[88:91]
buffer_store_dwordx4 a[248:251], v214, s[20:23], s47 offen offset:2048 sc1
v_cvt_pk_bf16_f32 v164, v132, v133
v_mfma_f32_16x16x32_bf16 v[104:107], a[184:187], v[168:171], v[104:107]
v_exp_f32 v134, v134
v_mfma_f32_16x16x32_bf16 v[120:123], a[188:191], v[168:171], v[120:123]
v_exp_f32 v135, v135
v_mfma_f32_16x16x32_bf16 v[12:15], a[160:163], v[172:175], v[12:15]
buffer_load_dwordx4 v209, s[16:19], s34 offen offset:3072 nt lds
v_add_f32 v253, v253, v134
v_mfma_f32_16x16x32_bf16 v[28:31], a[164:167], v[172:175], v[28:31]
buffer_store_dwordx4 a[252:255], v214, s[20:23], s47 offen offset:3072 sc1
v_add_f32 v253, v253, v135
v_mfma_f32_16x16x32_bf16 v[44:47], a[168:171], v[172:175], v[44:47]
s_add_u32 s34, s34, 16384
v_exp_f32 v148, v148
v_mfma_f32_16x16x32_bf16 v[60:63], a[172:175], v[172:175], v[60:63]
v_exp_f32 v149, v149
v_mfma_f32_16x16x32_bf16 v[76:79], a[176:179], v[172:175], v[76:79]
s_add_u32 s30, s30, 16384
v_exp_f32 v150, v150
v_mfma_f32_16x16x32_bf16 v[92:95], a[180:183], v[172:175], v[92:95]
v_exp_f32 v151, v151
v_mfma_f32_16x16x32_bf16 v[108:111], a[184:187], v[172:175], v[108:111]
s_cmp_eq_u32 s30, 163840
s_cselect_b32 s30, 0, s30
v_cvt_pk_bf16_f32 v165, v134, v135
v_mfma_f32_16x16x32_bf16 v[124:127], a[188:191], v[172:175], v[124:127]
s_waitcnt lgkmcnt(0)
v_exp_f32 v136, v136
v_add_u32 v196, s37, v196
v_add_u32 v197, s37, v197
v_add_u32 v198, s37, v198
v_add_u32 v199, s37, v199
v_add_u32 v200, s37, v200
v_add_u32 v201, s37, v201
v_add_u32 v202, s37, v202
v_add_u32 v203, s37, v203
v_mfma_f32_16x16x32_bf16 v[128:131], a[128:131], a[64:67], v[176:179]
s_waitcnt vmcnt(36)
s_barrier
v_exp_f32 v137, v137
v_mfma_f32_16x16x32_bf16 v[128:131], a[132:135], a[68:71], v[128:131]
ds_read_b64_tr_b16 a[160:161], v196 offset:0
v_add_f32 v253, v253, v148
v_mfma_f32_16x16x32_bf16 v[128:131], a[136:139], a[72:75], v[128:131]
s_add_u32 m0, s30, s29
v_exp_f32 v138, v138
v_mfma_f32_16x16x32_bf16 v[128:131], a[140:143], a[76:79], v[128:131]
ds_read_b64_tr_b16 a[162:163], v196 offset:4096
v_add_f32 v253, v253, v149
v_mfma_f32_16x16x32_bf16 v[144:147], a[144:147], a[64:67], v[176:179]
v_exp_f32 v139, v139
v_mfma_f32_16x16x32_bf16 v[144:147], a[148:151], a[68:71], v[144:147]
ds_read_b64_tr_b16 a[164:165], v197 offset:0
v_cvt_pk_bf16_f32 v166, v148, v149
v_mfma_f32_16x16x32_bf16 v[144:147], a[152:155], a[72:75], v[144:147]
v_exp_f32 v152, v152
v_mfma_f32_16x16x32_bf16 v[144:147], a[156:159], a[76:79], v[144:147]
ds_read_b64_tr_b16 a[166:167], v197 offset:4096
v_add_f32 v253, v253, v150
v_add_f32 v253, v253, v151
v_cvt_pk_bf16_f32 v167, v150, v151
v_mfma_f32_16x16x32_bf16 v[132:135], a[128:131], a[80:83], v[180:183]
buffer_load_dwordx4 v204, s[12:15], s33 offen offset:0 nt lds
v_add_f32 v254, v254, v136
v_mfma_f32_16x16x32_bf16 v[132:135], a[132:135], a[84:87], v[132:135]
ds_read_b64_tr_b16 a[168:169], v198 offset:0
v_add_f32 v254, v254, v137
v_mfma_f32_16x16x32_bf16 v[132:135], a[136:139], a[88:91], v[132:135]
v_exp_f32 v153, v153
v_mfma_f32_16x16x32_bf16 v[132:135], a[140:143], a[92:95], v[132:135]
ds_read_b64_tr_b16 a[170:171], v198 offset:4096
v_cvt_pk_bf16_f32 v168, v136, v137
v_mfma_f32_16x16x32_bf16 v[148:151], a[144:147], a[80:83], v[180:183]
v_exp_f32 v154, v154
v_mfma_f32_16x16x32_bf16 v[148:151], a[148:151], a[84:87], v[148:151]
ds_read_b64_tr_b16 a[172:173], v199 offset:0
v_add_f32 v254, v254, v138
v_mfma_f32_16x16x32_bf16 v[148:151], a[152:155], a[88:91], v[148:151]
v_exp_f32 v155, v155
v_mfma_f32_16x16x32_bf16 v[148:151], a[156:159], a[92:95], v[148:151]
ds_read_b64_tr_b16 a[174:175], v199 offset:4096
v_add_f32 v254, v254, v139
v_cvt_pk_bf16_f32 v169, v138, v139
v_add_f32 v254, v254, v152
v_add_f32 v254, v254, v153
v_cvt_pk_bf16_f32 v170, v152, v153
v_add_f32 v254, v254, v154
v_add_f32 v254, v254, v155
v_cvt_pk_bf16_f32 v171, v154, v155
v_mfma_f32_16x16x32_bf16 v[136:139], a[128:131], a[96:99], v[184:187]
v_exp_f32 v140, v140
v_mfma_f32_16x16x32_bf16 v[136:139], a[132:135], a[100:103], v[136:139]
ds_read_b64_tr_b16 a[176:177], v200 offset:0
v_add_f32 v255, v255, v140
v_mfma_f32_16x16x32_bf16 v[136:139], a[136:139], a[104:107], v[136:139]
v_exp_f32 v141, v141
v_mfma_f32_16x16x32_bf16 v[136:139], a[140:143], a[108:111], v[136:139]
ds_read_b64_tr_b16 a[178:179], v200 offset:4096
v_add_f32 v255, v255, v141
v_mfma_f32_16x16x32_bf16 v[152:155], a[144:147], a[96:99], v[184:187]
v_exp_f32 v142, v142
v_mfma_f32_16x16x32_bf16 v[152:155], a[148:151], a[100:103], v[152:155]
ds_read_b64_tr_b16 a[180:181], v201 offset:0
v_cvt_pk_bf16_f32 v172, v140, v141
v_mfma_f32_16x16x32_bf16 v[152:155], a[152:155], a[104:107], v[152:155]
v_exp_f32 v143, v143
v_mfma_f32_16x16x32_bf16 v[152:155], a[156:159], a[108:111], v[152:155]
ds_read_b64_tr_b16 a[182:183], v201 offset:4096
v_add_f32 v255, v255, v142
v_add_f32 v255, v255, v143
v_cvt_pk_bf16_f32 v173, v142, v143
v_exp_f32 v156, v156
s_nop 0
v_add_f32 v255, v255, v156
v_exp_f32 v157, v157
s_nop 0
v_add_f32 v255, v255, v157
v_cvt_pk_bf16_f32 v174, v156, v157
v_exp_f32 v158, v158
s_nop 0
v_add_f32 v255, v255, v158
v_exp_f32 v159, v159
s_nop 0
v_add_f32 v255, v255, v159
v_cvt_pk_bf16_f32 v175, v158, v159
v_mfma_f32_16x16x32_bf16 v[140:143], a[128:131], a[112:115], v[188:191]
buffer_load_dwordx4 v205, s[12:15], s33 offen offset:1024 nt lds
v_mfma_f32_16x16x32_bf16 v[140:143], a[132:135], a[116:119], v[140:143]
ds_read_b64_tr_b16 a[184:185], v202 offset:0
v_mfma_f32_16x16x32_bf16 v[140:143], a[136:139], a[120:123], v[140:143]
v_exp_f32 v128, v128
v_mfma_f32_16x16x32_bf16 v[140:143], a[140:143], a[124:127], v[140:143]
ds_read_b64_tr_b16 a[186:187], v202 offset:4096
v_add_f32 v252, v252, v128
v_mfma_f32_16x16x32_bf16 v[156:159], a[144:147], a[112:115], v[188:191]
s_waitcnt lgkmcnt(4)
v_exp_f32 v129, v129
v_mfma_f32_16x16x32_bf16 v[156:159], a[148:151], a[116:119], v[156:159]
ds_read_b64_tr_b16 a[188:189], v203 offset:0
v_add_f32 v252, v252, v129
v_mfma_f32_16x16x32_bf16 v[156:159], a[152:155], a[120:123], v[156:159]
s_sub_u32 s37, s35, s48
s_mov_b32 s48, s35
v_mfma_f32_16x16x32_bf16 v[156:159], a[156:159], a[124:127], v[156:159]
ds_read_b64_tr_b16 a[190:191], v203 offset:4096
v_add_u32 v192, s37, v192
v_mfma_f32_16x16x32_bf16 v[0:3], a[160:163], v[160:163], v[0:3]
s_add_u32 s35, s35, 16384
v_exp_f32 v130, v130
v_mfma_f32_16x16x32_bf16 v[16:19], a[164:167], v[160:163], v[16:19]
v_exp_f32 v131, v131
v_mfma_f32_16x16x32_bf16 v[32:35], a[168:171], v[160:163], v[32:35]
s_cmp_eq_u32 s35, 163840
s_cselect_b32 s35, 0, s35
v_add_u32 v193, s37, v193
v_mfma_f32_16x16x32_bf16 v[48:51], a[172:175], v[160:163], v[48:51]
v_exp_f32 v144, v144
v_mfma_f32_16x16x32_bf16 v[64:67], a[176:179], v[160:163], v[64:67]
s_waitcnt lgkmcnt(0)
v_exp_f32 v145, v145
v_mfma_f32_16x16x32_bf16 v[80:83], a[180:183], v[160:163], v[80:83]
v_add_u32 v194, s37, v194
v_add_u32 v195, s37, v195
ds_read_b128 a[128:131], v192 offset:0
v_add_f32 v252, v252, v130
v_mfma_f32_16x16x32_bf16 v[96:99], a[184:187], v[160:163], v[96:99]
v_exp_f32 v146, v146
v_mfma_f32_16x16x32_bf16 v[112:115], a[188:191], v[160:163], v[112:115]
ds_read_b128 a[132:135], v193 offset:0
v_add_f32 v252, v252, v131
v_mfma_f32_16x16x32_bf16 v[4:7], a[160:163], v[164:167], v[4:7]
buffer_load_dwordx4 v206, s[12:15], s33 offen offset:2048 nt lds
v_cvt_pk_bf16_f32 v160, v128, v129
v_mfma_f32_16x16x32_bf16 v[20:23], a[164:167], v[164:167], v[20:23]
ds_read_b128 a[136:139], v194 offset:0
v_cvt_pk_bf16_f32 v161, v130, v131
v_mfma_f32_16x16x32_bf16 v[36:39], a[168:171], v[164:167], v[36:39]
v_exp_f32 v147, v147
v_mfma_f32_16x16x32_bf16 v[52:55], a[172:175], v[164:167], v[52:55]
ds_read_b128 a[140:143], v195 offset:0
v_add_f32 v252, v252, v144
v_mfma_f32_16x16x32_bf16 v[68:71], a[176:179], v[164:167], v[68:71]
v_exp_f32 v132, v132
v_mfma_f32_16x16x32_bf16 v[84:87], a[180:183], v[164:167], v[84:87]
ds_read_b128 a[144:147], v192 offset:4096
v_add_f32 v252, v252, v145
v_mfma_f32_16x16x32_bf16 v[100:103], a[184:187], v[164:167], v[100:103]
v_exp_f32 v133, v133
v_mfma_f32_16x16x32_bf16 v[116:119], a[188:191], v[164:167], v[116:119]
ds_read_b128 a[148:151], v193 offset:4096
v_cvt_pk_bf16_f32 v162, v144, v145
v_mfma_f32_16x16x32_bf16 v[8:11], a[160:163], v[168:171], v[8:11]
v_exp_f32 v134, v134
v_mfma_f32_16x16x32_bf16 v[24:27], a[164:167], v[168:171], v[24:27]
ds_read_b128 a[152:155], v194 offset:4096
v_add_f32 v252, v252, v146
v_mfma_f32_16x16x32_bf16 v[40:43], a[168:171], v[168:171], v[40:43]
v_exp_f32 v135, v135
v_mfma_f32_16x16x32_bf16 v[56:59], a[172:175], v[168:171], v[56:59]
ds_read_b128 a[156:159], v195 offset:4096
v_add_f32 v252, v252, v147
v_mfma_f32_16x16x32_bf16 v[72:75], a[176:179], v[168:171], v[72:75]
v_exp_f32 v148, v148
v_mfma_f32_16x16x32_bf16 v[88:91], a[180:183], v[168:171], v[88:91]
v_exp_f32 v149, v149
v_mfma_f32_16x16x32_bf16 v[104:107], a[184:187], v[168:171], v[104:107]
v_exp_f32 v150, v150
v_mfma_f32_16x16x32_bf16 v[120:123], a[188:191], v[168:171], v[120:123]
v_exp_f32 v151, v151
v_mfma_f32_16x16x32_bf16 v[12:15], a[160:163], v[172:175], v[12:15]
buffer_load_dwordx4 v207, s[12:15], s33 offen offset:3072 nt lds
v_cvt_pk_bf16_f32 v163, v146, v147
v_mfma_f32_16x16x32_bf16 v[28:31], a[164:167], v[172:175], v[28:31]
v_exp_f32 v136, v136
v_mfma_f32_16x16x32_bf16 v[44:47], a[168:171], v[172:175], v[44:47]
s_add_u32 s33, s33, 16384
v_exp_f32 v137, v137
v_mfma_f32_16x16x32_bf16 v[60:63], a[172:175], v[172:175], v[60:63]
v_exp_f32 v138, v138
v_mfma_f32_16x16x32_bf16 v[76:79], a[176:179], v[172:175], v[76:79]
s_add_u32 s30, s30, 16384
v_exp_f32 v139, v139
v_mfma_f32_16x16x32_bf16 v[92:95], a[180:183], v[172:175], v[92:95]
v_exp_f32 v152, v152
v_mfma_f32_16x16x32_bf16 v[108:111], a[184:187], v[172:175], v[108:111]
s_cmp_eq_u32 s30, 163840
s_cselect_b32 s30, 0, s30
v_add_f32 v253, v253, v132
v_mfma_f32_16x16x32_bf16 v[124:127], a[188:191], v[172:175], v[124:127]
s_waitcnt lgkmcnt(0)
v_exp_f32 v153, v153
v_add_f32 v253, v253, v133
v_cvt_pk_bf16_f32 v164, v132, v133
v_add_f32 v253, v253, v134
v_exp_f32 v154, v154
v_exp_f32 v155, v155
v_exp_f32 v140, v140
v_exp_f32 v141, v141
v_exp_f32 v142, v142
v_exp_f32 v143, v143
v_exp_f32 v156, v156
s_nop 1
v_mfma_f32_16x16x32_bf16 v[128:131], a[128:131], a[64:67], v[176:179]
s_barrier
v_exp_f32 v157, v157
v_mfma_f32_16x16x32_bf16 v[128:131], a[132:135], a[68:71], v[128:131]
ds_read_b64_tr_b16 a[160:161], v196 offset:8192
v_add_f32 v253, v253, v135
v_mfma_f32_16x16x32_bf16 v[128:131], a[136:139], a[72:75], v[128:131]
s_add_u32 m0, s30, s29
v_exp_f32 v158, v158
v_mfma_f32_16x16x32_bf16 v[128:131], a[140:143], a[76:79], v[128:131]
ds_read_b64_tr_b16 a[162:163], v196 offset:12288
v_cvt_pk_bf16_f32 v165, v134, v135
v_mfma_f32_16x16x32_bf16 v[144:147], a[144:147], a[64:67], v[176:179]
v_exp_f32 v159, v159
v_mfma_f32_16x16x32_bf16 v[144:147], a[148:151], a[68:71], v[144:147]
ds_read_b64_tr_b16 a[164:165], v197 offset:8192
v_add_f32 v253, v253, v148
v_mfma_f32_16x16x32_bf16 v[144:147], a[152:155], a[72:75], v[144:147]
v_add_f32 v253, v253, v149
v_cvt_pk_bf16_f32 v166, v148, v149
v_mfma_f32_16x16x32_bf16 v[144:147], a[156:159], a[76:79], v[144:147]
ds_read_b64_tr_b16 a[166:167], v197 offset:12288
v_add_f32 v253, v253, v150
v_add_f32 v253, v253, v151
v_cvt_pk_bf16_f32 v167, v150, v151
v_mfma_f32_16x16x32_bf16 v[132:135], a[128:131], a[80:83], v[180:183]
buffer_load_dwordx4 v208, s[16:19], s34 offen offset:0 nt lds
v_add_f32 v254, v254, v136
v_mfma_f32_16x16x32_bf16 v[132:135], a[132:135], a[84:87], v[132:135]
ds_read_b64_tr_b16 a[168:169], v198 offset:8192
v_add_f32 v254, v254, v137
v_mfma_f32_16x16x32_bf16 v[132:135], a[136:139], a[88:91], v[132:135]
v_exp_f32 v128, v128
v_mfma_f32_16x16x32_bf16 v[132:135], a[140:143], a[92:95], v[132:135]
ds_read_b64_tr_b16 a[170:171], v198 offset:12288
v_cvt_pk_bf16_f32 v168, v136, v137
v_mfma_f32_16x16x32_bf16 v[148:151], a[144:147], a[80:83], v[180:183]
v_exp_f32 v129, v129
v_mfma_f32_16x16x32_bf16 v[148:151], a[148:151], a[84:87], v[148:151]
ds_read_b64_tr_b16 a[172:173], v199 offset:8192
v_add_f32 v254, v254, v138
v_mfma_f32_16x16x32_bf16 v[148:151], a[152:155], a[88:91], v[148:151]
v_exp_f32 v130, v130
v_mfma_f32_16x16x32_bf16 v[148:151], a[156:159], a[92:95], v[148:151]
ds_read_b64_tr_b16 a[174:175], v199 offset:12288
v_add_f32 v254, v254, v139
v_cvt_pk_bf16_f32 v169, v138, v139
v_add_f32 v254, v254, v152
v_add_f32 v254, v254, v153
v_cvt_pk_bf16_f32 v170, v152, v153
v_add_f32 v254, v254, v154
v_add_f32 v254, v254, v155
v_cvt_pk_bf16_f32 v171, v154, v155
v_mfma_f32_16x16x32_bf16 v[136:139], a[128:131], a[96:99], v[184:187]
v_exp_f32 v131, v131
v_mfma_f32_16x16x32_bf16 v[136:139], a[132:135], a[100:103], v[136:139]
ds_read_b64_tr_b16 a[176:177], v200 offset:8192
v_add_f32 v255, v255, v140
v_mfma_f32_16x16x32_bf16 v[136:139], a[136:139], a[104:107], v[136:139]
v_exp_f32 v144, v144
v_mfma_f32_16x16x32_bf16 v[136:139], a[140:143], a[108:111], v[136:139]
ds_read_b64_tr_b16 a[178:179], v200 offset:12288
v_add_f32 v255, v255, v141
v_mfma_f32_16x16x32_bf16 v[152:155], a[144:147], a[96:99], v[184:187]
v_exp_f32 v145, v145
v_mfma_f32_16x16x32_bf16 v[152:155], a[148:151], a[100:103], v[152:155]
ds_read_b64_tr_b16 a[180:181], v201 offset:8192
v_cvt_pk_bf16_f32 v172, v140, v141
v_mfma_f32_16x16x32_bf16 v[152:155], a[152:155], a[104:107], v[152:155]
v_exp_f32 v146, v146
v_mfma_f32_16x16x32_bf16 v[152:155], a[156:159], a[108:111], v[152:155]
ds_read_b64_tr_b16 a[182:183], v201 offset:12288
v_add_f32 v255, v255, v142
v_add_f32 v255, v255, v143
v_cvt_pk_bf16_f32 v173, v142, v143
v_add_f32 v255, v255, v156
v_add_f32 v255, v255, v157
v_cvt_pk_bf16_f32 v174, v156, v157
v_add_f32 v255, v255, v158
v_add_f32 v255, v255, v159
v_cvt_pk_bf16_f32 v175, v158, v159
v_mfma_f32_16x16x32_bf16 v[140:143], a[128:131], a[112:115], v[188:191]
buffer_load_dwordx4 v209, s[16:19], s34 offen offset:1024 nt lds
v_add_f32 v252, v252, v128
v_mfma_f32_16x16x32_bf16 v[140:143], a[132:135], a[116:119], v[140:143]
ds_read_b64_tr_b16 a[184:185], v202 offset:8192
v_add_f32 v252, v252, v129
v_mfma_f32_16x16x32_bf16 v[140:143], a[136:139], a[120:123], v[140:143]
v_exp_f32 v147, v147
v_mfma_f32_16x16x32_bf16 v[140:143], a[140:143], a[124:127], v[140:143]
ds_read_b64_tr_b16 a[186:187], v202 offset:12288
v_add_f32 v252, v252, v130
v_mfma_f32_16x16x32_bf16 v[156:159], a[144:147], a[112:115], v[188:191]
s_waitcnt lgkmcnt(4)
v_exp_f32 v132, v132
v_mfma_f32_16x16x32_bf16 v[156:159], a[148:151], a[116:119], v[156:159]
ds_read_b64_tr_b16 a[188:189], v203 offset:8192
v_add_f32 v252, v252, v131
v_mfma_f32_16x16x32_bf16 v[156:159], a[152:155], a[120:123], v[156:159]
v_exp_f32 v133, v133
v_mfma_f32_16x16x32_bf16 v[156:159], a[156:159], a[124:127], v[156:159]
ds_read_b64_tr_b16 a[190:191], v203 offset:12288
v_add_f32 v252, v252, v144
v_mfma_f32_16x16x32_bf16 v[0:3], a[160:163], v[160:163], v[0:3]
v_exp_f32 v134, v134
v_mfma_f32_16x16x32_bf16 v[16:19], a[164:167], v[160:163], v[16:19]
v_exp_f32 v135, v135
v_mfma_f32_16x16x32_bf16 v[32:35], a[168:171], v[160:163], v[32:35]
v_exp_f32 v148, v148
v_mfma_f32_16x16x32_bf16 v[48:51], a[172:175], v[160:163], v[48:51]
v_exp_f32 v149, v149
v_mfma_f32_16x16x32_bf16 v[64:67], a[176:179], v[160:163], v[64:67]
s_waitcnt lgkmcnt(0)
v_exp_f32 v150, v150
v_mfma_f32_16x16x32_bf16 v[80:83], a[180:183], v[160:163], v[80:83]
ds_read_b128 a[128:131], v192 offset:8192
v_add_f32 v252, v252, v145
v_mfma_f32_16x16x32_bf16 v[96:99], a[184:187], v[160:163], v[96:99]
v_exp_f32 v151, v151
v_mfma_f32_16x16x32_bf16 v[112:115], a[188:191], v[160:163], v[112:115]
ds_read_b128 a[132:135], v193 offset:8192
v_add_f32 v252, v252, v146
v_mfma_f32_16x16x32_bf16 v[4:7], a[160:163], v[164:167], v[4:7]
buffer_load_dwordx4 v208, s[16:19], s34 offen offset:2048 nt lds
v_cvt_pk_bf16_f32 v160, v128, v129
v_mfma_f32_16x16x32_bf16 v[20:23], a[164:167], v[164:167], v[20:23]
ds_read_b128 a[136:139], v194 offset:8192
v_cvt_pk_bf16_f32 v161, v130, v131
v_mfma_f32_16x16x32_bf16 v[36:39], a[168:171], v[164:167], v[36:39]
v_exp_f32 v136, v136
v_mfma_f32_16x16x32_bf16 v[52:55], a[172:175], v[164:167], v[52:55]
ds_read_b128 a[140:143], v195 offset:8192
v_cvt_pk_bf16_f32 v162, v144, v145
v_mfma_f32_16x16x32_bf16 v[68:71], a[176:179], v[164:167], v[68:71]
v_exp_f32 v137, v137
v_mfma_f32_16x16x32_bf16 v[84:87], a[180:183], v[164:167], v[84:87]
ds_read_b128 a[144:147], v192 offset:12288
v_add_f32 v252, v252, v147
v_mfma_f32_16x16x32_bf16 v[100:103], a[184:187], v[164:167], v[100:103]
v_exp_f32 v138, v138
v_mfma_f32_16x16x32_bf16 v[116:119], a[188:191], v[164:167], v[116:119]
ds_read_b128 a[148:151], v193 offset:12288
v_cvt_pk_bf16_f32 v163, v146, v147
v_mfma_f32_16x16x32_bf16 v[8:11], a[160:163], v[168:171], v[8:11]
s_sub_u32 s37, s35, s49
s_mov_b32 s49, s35
v_add_f32 v253, v253, v132
v_mfma_f32_16x16x32_bf16 v[24:27], a[164:167], v[168:171], v[24:27]
ds_read_b128 a[152:155], v194 offset:12288
v_add_f32 v253, v253, v133
v_mfma_f32_16x16x32_bf16 v[40:43], a[168:171], v[168:171], v[40:43]
s_add_u32 s35, s35, 16384
v_exp_f32 v139, v139
v_mfma_f32_16x16x32_bf16 v[56:59], a[172:175], v[168:171], v[56:59]
ds_read_b128 a[156:159], v195 offset:12288
v_cvt_pk_bf16_f32 v164, v132, v133
v_mfma_f32_16x16x32_bf16 v[72:75], a[176:179], v[168:171], v[72:75]
s_cmp_eq_u32 s35, 163840
s_cselect_b32 s35, 0, s35
v_add_f32 v253, v253, v134
v_mfma_f32_16x16x32_bf16 v[88:91], a[180:183], v[168:171], v[88:91]
v_exp_f32 v152, v152
v_mfma_f32_16x16x32_bf16 v[104:107], a[184:187], v[168:171], v[104:107]
v_exp_f32 v153, v153
v_mfma_f32_16x16x32_bf16 v[120:123], a[188:191], v[168:171], v[120:123]
v_exp_f32 v154, v154
v_mfma_f32_16x16x32_bf16 v[12:15], a[160:163], v[172:175], v[12:15]
buffer_load_dwordx4 v209, s[16:19], s34 offen offset:3072 nt lds
v_add_f32 v253, v253, v135
v_mfma_f32_16x16x32_bf16 v[28:31], a[164:167], v[172:175], v[28:31]
v_exp_f32 v155, v155
v_mfma_f32_16x16x32_bf16 v[44:47], a[168:171], v[172:175], v[44:47]
s_add_u32 s34, s34, 16384
v_exp_f32 v140, v140
v_mfma_f32_16x16x32_bf16 v[60:63], a[172:175], v[172:175], v[60:63]
v_exp_f32 v141, v141
v_mfma_f32_16x16x32_bf16 v[76:79], a[176:179], v[172:175], v[76:79]
s_add_u32 s30, s30, 16384
v_exp_f32 v142, v142
v_mfma_f32_16x16x32_bf16 v[92:95], a[180:183], v[172:175], v[92:95]
v_exp_f32 v143, v143
v_mfma_f32_16x16x32_bf16 v[108:111], a[184:187], v[172:175], v[108:111]
s_cmp_eq_u32 s30, 163840
s_cselect_b32 s30, 0, s30
v_cvt_pk_bf16_f32 v165, v134, v135
v_mfma_f32_16x16x32_bf16 v[124:127], a[188:191], v[172:175], v[124:127]
s_waitcnt lgkmcnt(0)
v_exp_f32 v156, v156
v_add_u32 v196, s37, v196
v_add_u32 v197, s37, v197
v_add_u32 v198, s37, v198
v_add_u32 v199, s37, v199
v_add_u32 v200, s37, v200
v_add_u32 v201, s37, v201
v_add_u32 v202, s37, v202
v_add_u32 v203, s37, v203
v_mfma_f32_16x16x32_bf16 v[128:131], a[128:131], a[64:67], v[176:179]
s_waitcnt vmcnt(36)
s_barrier
s_lshl_b32 s39, s2, 7
s_add_u32 s39, s39, 35651584
v_mov_b32 v251, 0
buffer_load_dword v250, v251, s[20:23], s39 offen sc1
v_exp_f32 v157, v157
v_mfma_f32_16x16x32_bf16 v[128:131], a[132:135], a[68:71], v[128:131]
ds_read_b64_tr_b16 a[160:161], v196 offset:0
v_add_f32 v253, v253, v148
v_mfma_f32_16x16x32_bf16 v[128:131], a[136:139], a[72:75], v[128:131]
s_add_u32 m0, s30, s29
v_exp_f32 v158, v158
v_mfma_f32_16x16x32_bf16 v[128:131], a[140:143], a[76:79], v[128:131]
ds_read_b64_tr_b16 a[162:163], v196 offset:4096
v_add_f32 v253, v253, v149
v_mfma_f32_16x16x32_bf16 v[144:147], a[144:147], a[64:67], v[176:179]
v_exp_f32 v159, v159
v_mfma_f32_16x16x32_bf16 v[144:147], a[148:151], a[68:71], v[144:147]
ds_read_b64_tr_b16 a[164:165], v197 offset:0
v_cvt_pk_bf16_f32 v166, v148, v149
v_mfma_f32_16x16x32_bf16 v[144:147], a[152:155], a[72:75], v[144:147]
v_add_f32 v253, v253, v150
v_add_f32 v253, v253, v151
v_mfma_f32_16x16x32_bf16 v[144:147], a[156:159], a[76:79], v[144:147]
ds_read_b64_tr_b16 a[166:167], v197 offset:4096
v_cvt_pk_bf16_f32 v167, v150, v151
v_mfma_f32_16x16x32_bf16 v[132:135], a[128:131], a[80:83], v[180:183]
buffer_load_dwordx4 v204, s[12:15], s33 offen offset:0 nt lds
v_add_f32 v254, v254, v136
v_mfma_f32_16x16x32_bf16 v[132:135], a[132:135], a[84:87], v[132:135]
ds_read_b64_tr_b16 a[168:169], v198 offset:0
v_add_f32 v254, v254, v137
v_mfma_f32_16x16x32_bf16 v[132:135], a[136:139], a[88:91], v[132:135]
v_exp_f32 v128, v128
v_mfma_f32_16x16x32_bf16 v[132:135], a[140:143], a[92:95], v[132:135]
ds_read_b64_tr_b16 a[170:171], v198 offset:4096
v_cvt_pk_bf16_f32 v168, v136, v137
v_mfma_f32_16x16x32_bf16 v[148:151], a[144:147], a[80:83], v[180:183]
v_exp_f32 v129, v129
v_mfma_f32_16x16x32_bf16 v[148:151], a[148:151], a[84:87], v[148:151]
ds_read_b64_tr_b16 a[172:173], v199 offset:0
v_add_f32 v254, v254, v138
v_mfma_f32_16x16x32_bf16 v[148:151], a[152:155], a[88:91], v[148:151]
v_exp_f32 v130, v130
v_mfma_f32_16x16x32_bf16 v[148:151], a[156:159], a[92:95], v[148:151]
ds_read_b64_tr_b16 a[174:175], v199 offset:4096
v_add_f32 v254, v254, v139
v_cvt_pk_bf16_f32 v169, v138, v139
v_add_f32 v254, v254, v152
v_add_f32 v254, v254, v153
v_cvt_pk_bf16_f32 v170, v152, v153
v_add_f32 v254, v254, v154
v_add_f32 v254, v254, v155
v_cvt_pk_bf16_f32 v171, v154, v155
v_mfma_f32_16x16x32_bf16 v[136:139], a[128:131], a[96:99], v[184:187]
v_exp_f32 v131, v131
v_mfma_f32_16x16x32_bf16 v[136:139], a[132:135], a[100:103], v[136:139]
ds_read_b64_tr_b16 a[176:177], v200 offset:0
v_add_f32 v255, v255, v140
v_mfma_f32_16x16x32_bf16 v[136:139], a[136:139], a[104:107], v[136:139]
v_exp_f32 v144, v144
v_mfma_f32_16x16x32_bf16 v[136:139], a[140:143], a[108:111], v[136:139]
ds_read_b64_tr_b16 a[178:179], v200 offset:4096
v_add_f32 v255, v255, v141
v_mfma_f32_16x16x32_bf16 v[152:155], a[144:147], a[96:99], v[184:187]
v_exp_f32 v145, v145
v_mfma_f32_16x16x32_bf16 v[152:155], a[148:151], a[100:103], v[152:155]
ds_read_b64_tr_b16 a[180:181], v201 offset:0
v_cvt_pk_bf16_f32 v172, v140, v141
v_mfma_f32_16x16x32_bf16 v[152:155], a[152:155], a[104:107], v[152:155]
v_exp_f32 v146, v146
v_mfma_f32_16x16x32_bf16 v[152:155], a[156:159], a[108:111], v[152:155]
ds_read_b64_tr_b16 a[182:183], v201 offset:4096
v_add_f32 v255, v255, v142
v_add_f32 v255, v255, v143
v_cvt_pk_bf16_f32 v173, v142, v143
v_add_f32 v255, v255, v156
v_add_f32 v255, v255, v157
v_cvt_pk_bf16_f32 v174, v156, v157
v_add_f32 v255, v255, v158
v_add_f32 v255, v255, v159
v_cvt_pk_bf16_f32 v175, v158, v159
v_mfma_f32_16x16x32_bf16 v[140:143], a[128:131], a[112:115], v[188:191]
buffer_load_dwordx4 v205, s[12:15], s33 offen offset:1024 nt lds
v_add_f32 v252, v252, v128
v_mfma_f32_16x16x32_bf16 v[140:143], a[132:135], a[116:119], v[140:143]
ds_read_b64_tr_b16 a[184:185], v202 offset:0
v_add_f32 v252, v252, v129
v_mfma_f32_16x16x32_bf16 v[140:143], a[136:139], a[120:123], v[140:143]
v_exp_f32 v147, v147
v_mfma_f32_16x16x32_bf16 v[140:143], a[140:143], a[124:127], v[140:143]
ds_read_b64_tr_b16 a[186:187], v202 offset:4096
v_add_f32 v252, v252, v130
v_mfma_f32_16x16x32_bf16 v[156:159], a[144:147], a[112:115], v[188:191]
s_waitcnt lgkmcnt(4)
v_exp_f32 v132, v132
v_mfma_f32_16x16x32_bf16 v[156:159], a[148:151], a[116:119], v[156:159]
ds_read_b64_tr_b16 a[188:189], v203 offset:0
v_add_f32 v252, v252, v131
v_mfma_f32_16x16x32_bf16 v[156:159], a[152:155], a[120:123], v[156:159]
s_sub_u32 s37, s35, s48
s_mov_b32 s48, s35
v_add_f32 v252, v252, v144
v_mfma_f32_16x16x32_bf16 v[156:159], a[156:159], a[124:127], v[156:159]
ds_read_b64_tr_b16 a[190:191], v203 offset:4096
v_add_u32 v192, s37, v192
v_mfma_f32_16x16x32_bf16 v[0:3], a[160:163], v[160:163], v[0:3]
s_add_u32 s35, s35, 16384
v_exp_f32 v133, v133
v_mfma_f32_16x16x32_bf16 v[16:19], a[164:167], v[160:163], v[16:19]
v_exp_f32 v134, v134
v_mfma_f32_16x16x32_bf16 v[32:35], a[168:171], v[160:163], v[32:35]
s_cmp_eq_u32 s35, 163840
s_cselect_b32 s35, 0, s35
v_add_u32 v193, s37, v193
v_mfma_f32_16x16x32_bf16 v[48:51], a[172:175], v[160:163], v[48:51]
v_exp_f32 v135, v135
v_mfma_f32_16x16x32_bf16 v[64:67], a[176:179], v[160:163], v[64:67]
s_waitcnt lgkmcnt(0)
v_exp_f32 v148, v148
v_mfma_f32_16x16x32_bf16 v[80:83], a[180:183], v[160:163], v[80:83]
v_add_u32 v194, s37, v194
v_add_u32 v195, s37, v195
ds_read_b128 a[128:131], v192 offset:0
v_add_f32 v252, v252, v145
v_mfma_f32_16x16x32_bf16 v[96:99], a[184:187], v[160:163], v[96:99]
v_exp_f32 v149, v149
v_mfma_f32_16x16x32_bf16 v[112:115], a[188:191], v[160:163], v[112:115]
ds_read_b128 a[132:135], v193 offset:0
v_add_f32 v252, v252, v146
v_mfma_f32_16x16x32_bf16 v[4:7], a[160:163], v[164:167], v[4:7]
buffer_load_dwordx4 v206, s[12:15], s33 offen offset:2048 nt lds
v_cvt_pk_bf16_f32 v160, v128, v129
v_mfma_f32_16x16x32_bf16 v[20:23], a[164:167], v[164:167], v[20:23]
ds_read_b128 a[136:139], v194 offset:0
v_cvt_pk_bf16_f32 v161, v130, v131
v_mfma_f32_16x16x32_bf16 v[36:39], a[168:171], v[164:167], v[36:39]
v_exp_f32 v150, v150
v_mfma_f32_16x16x32_bf16 v[52:55], a[172:175], v[164:167], v[52:55]
ds_read_b128 a[140:143], v195 offset:0
v_cvt_pk_bf16_f32 v162, v144, v145
v_mfma_f32_16x16x32_bf16 v[68:71], a[176:179], v[164:167], v[68:71]
v_exp_f32 v151, v151
v_mfma_f32_16x16x32_bf16 v[84:87], a[180:183], v[164:167], v[84:87]
ds_read_b128 a[144:147], v192 offset:4096
v_add_f32 v252, v252, v147
v_mfma_f32_16x16x32_bf16 v[100:103], a[184:187], v[164:167], v[100:103]
v_exp_f32 v136, v136
v_mfma_f32_16x16x32_bf16 v[116:119], a[188:191], v[164:167], v[116:119]
ds_read_b128 a[148:151], v193 offset:4096
v_cvt_pk_bf16_f32 v163, v146, v147
v_mfma_f32_16x16x32_bf16 v[8:11], a[160:163], v[168:171], v[8:11]
v_exp_f32 v137, v137
v_mfma_f32_16x16x32_bf16 v[24:27], a[164:167], v[168:171], v[24:27]
ds_read_b128 a[152:155], v194 offset:4096
v_add_f32 v253, v253, v132
v_mfma_f32_16x16x32_bf16 v[40:43], a[168:171], v[168:171], v[40:43]
v_exp_f32 v138, v138
v_mfma_f32_16x16x32_bf16 v[56:59], a[172:175], v[168:171], v[56:59]
ds_read_b128 a[156:159], v195 offset:4096
v_add_f32 v253, v253, v133
v_mfma_f32_16x16x32_bf16 v[72:75], a[176:179], v[168:171], v[72:75]
v_exp_f32 v139, v139
v_mfma_f32_16x16x32_bf16 v[88:91], a[180:183], v[168:171], v[88:91]
v_exp_f32 v152, v152
v_mfma_f32_16x16x32_bf16 v[104:107], a[184:187], v[168:171], v[104:107]
v_exp_f32 v153, v153
v_mfma_f32_16x16x32_bf16 v[120:123], a[188:191], v[168:171], v[120:123]
v_exp_f32 v154, v154
v_mfma_f32_16x16x32_bf16 v[12:15], a[160:163], v[172:175], v[12:15]
buffer_load_dwordx4 v207, s[12:15], s33 offen offset:3072 nt lds
v_cvt_pk_bf16_f32 v164, v132, v133
v_mfma_f32_16x16x32_bf16 v[28:31], a[164:167], v[172:175], v[28:31]
v_exp_f32 v155, v155
v_mfma_f32_16x16x32_bf16 v[44:47], a[168:171], v[172:175], v[44:47]
s_add_u32 s33, s33, 16384
v_exp_f32 v140, v140
v_mfma_f32_16x16x32_bf16 v[60:63], a[172:175], v[172:175], v[60:63]
v_exp_f32 v141, v141
v_mfma_f32_16x16x32_bf16 v[76:79], a[176:179], v[172:175], v[76:79]
s_add_u32 s30, s30, 16384
v_exp_f32 v142, v142
v_mfma_f32_16x16x32_bf16 v[92:95], a[180:183], v[172:175], v[92:95]
v_exp_f32 v143, v143
v_mfma_f32_16x16x32_bf16 v[108:111], a[184:187], v[172:175], v[108:111]
s_cmp_eq_u32 s30, 163840
s_cselect_b32 s30, 0, s30
v_add_f32 v253, v253, v134
v_mfma_f32_16x16x32_bf16 v[124:127], a[188:191], v[172:175], v[124:127]
s_waitcnt lgkmcnt(0)
v_exp_f32 v156, v156
v_mfma_f32_16x16x32_bf16 v[128:131], a[128:131], a[64:67], v[176:179]
s_waitcnt vmcnt(4)
s_barrier
s_cmp_lg_u32 s28, 0
s_cbranch_scc1 L_s0
s_mov_b32 s68, 0x10000
s_mov_b32 s69, 0x8000
L_cw_chk:
v_cmp_le_u32 vcc, s68, v250
s_sub_u32 s69, s69, 1
s_cmp_eq_u64 vcc, exec
s_cbranch_scc1 L_cw_ok
s_cmp_eq_u32 s69, 0
s_cbranch_scc1 L_cw_ok
s_sleep 4
buffer_load_dword v250, v251, s[20:23], s39 offen sc1
s_waitcnt vmcnt(0)
s_branch L_cw_chk
L_cw_ok:
s_mul_i32 s68, s54, 240
s_add_u32 s69, s68, 239
s_lshr_b32 s68, s68, 7
s_lshr_b32 s69, s69, 7
s_sub_u32 s69, s69, s68
s_add_u32 s69, s69, 1
s_lshl_b32 s69, s69, 3
s_lshl_b32 s68, s68, 3
v_lshrrev_b32 v218, 4, v214
v_add_u32 v215, s68, v218
v_mul_u32_u24 v216, 2185, v215
v_lshrrev_b32 v216, 16, v216
v_mul_u32_u24 v217, 30, v216
v_sub_u32 v215, v215, v217
v_lshl_add_u32 v215, v215, 3, v216
v_lshlrev_b32 v215, 7, v215
v_add_u32 v215, 35651584, v215
v_mov_b32 v216, 1
v_cmp_gt_u32 s[100:101], s69, v218
s_nop 1
s_mov_b64 exec, s[100:101]
buffer_atomic_add v216, v215, s[20:23], 0 offen sc1
s_mov_b64 exec, -1
L_s0:
v_exp_f32 v157, v157
v_mfma_f32_16x16x32_bf16 v[128:131], a[132:135], a[68:71], v[128:131]
ds_read_b64_tr_b16 a[160:161], v196 offset:8192
v_add_f32 v253, v253, v135
v_mfma_f32_16x16x32_bf16 v[128:131], a[136:139], a[72:75], v[128:131]
s_add_u32 m0, s30, s29
v_exp_f32 v158, v158
v_mfma_f32_16x16x32_bf16 v[128:131], a[140:143], a[76:79], v[128:131]
ds_read_b64_tr_b16 a[162:163], v196 offset:12288
v_cvt_pk_bf16_f32 v165, v134, v135
v_mfma_f32_16x16x32_bf16 v[144:147], a[144:147], a[64:67], v[176:179]
v_exp_f32 v159, v159
v_mfma_f32_16x16x32_bf16 v[144:147], a[148:151], a[68:71], v[144:147]
ds_read_b64_tr_b16 a[164:165], v197 offset:8192
v_add_f32 v253, v253, v148
v_mfma_f32_16x16x32_bf16 v[144:147], a[152:155], a[72:75], v[144:147]
v_add_f32 v253, v253, v149
v_cvt_pk_bf16_f32 v166, v148, v149
v_mfma_f32_16x16x32_bf16 v[144:147], a[156:159], a[76:79], v[144:147]
ds_read_b64_tr_b16 a[166:167], v197 offset:12288
v_add_f32 v253, v253, v150
v_add_f32 v253, v253, v151
v_cvt_pk_bf16_f32 v167, v150, v151
v_mfma_f32_16x16x32_bf16 v[132:135], a[128:131], a[80:83], v[180:183]
buffer_load_dwordx4 v208, s[16:19], s34 offen offset:0 nt lds
v_add_f32 v254, v254, v136
v_mfma_f32_16x16x32_bf16 v[132:135], a[132:135], a[84:87], v[132:135]
ds_read_b64_tr_b16 a[168:169], v198 offset:8192
v_add_f32 v254, v254, v137
v_mfma_f32_16x16x32_bf16 v[132:135], a[136:139], a[88:91], v[132:135]
v_exp_f32 v128, v128
v_mfma_f32_16x16x32_bf16 v[132:135], a[140:143], a[92:95], v[132:135]
ds_read_b64_tr_b16 a[170:171], v198 offset:12288
v_cvt_pk_bf16_f32 v168, v136, v137
v_mfma_f32_16x16x32_bf16 v[148:151], a[144:147], a[80:83], v[180:183]
v_exp_f32 v129, v129
v_mfma_f32_16x16x32_bf16 v[148:151], a[148:151], a[84:87], v[148:151]
ds_read_b64_tr_b16 a[172:173], v199 offset:8192
v_add_f32 v254, v254, v138
v_mfma_f32_16x16x32_bf16 v[148:151], a[152:155], a[88:91], v[148:151]
v_exp_f32 v130, v130
v_mfma_f32_16x16x32_bf16 v[148:151], a[156:159], a[92:95], v[148:151]
ds_read_b64_tr_b16 a[174:175], v199 offset:12288
v_add_f32 v254, v254, v139
v_cvt_pk_bf16_f32 v169, v138, v139
v_add_f32 v254, v254, v152
v_add_f32 v254, v254, v153
v_cvt_pk_bf16_f32 v170, v152, v153
v_add_f32 v254, v254, v154
v_add_f32 v254, v254, v155
v_cvt_pk_bf16_f32 v171, v154, v155
v_mfma_f32_16x16x32_bf16 v[136:139], a[128:131], a[96:99], v[184:187]
v_exp_f32 v131, v131
v_mfma_f32_16x16x32_bf16 v[136:139], a[132:135], a[100:103], v[136:139]
ds_read_b64_tr_b16 a[176:177], v200 offset:8192
v_add_f32 v255, v255, v140
v_mfma_f32_16x16x32_bf16 v[136:139], a[136:139], a[104:107], v[136:139]
v_exp_f32 v144, v144
v_mfma_f32_16x16x32_bf16 v[136:139], a[140:143], a[108:111], v[136:139]
ds_read_b64_tr_b16 a[178:179], v200 offset:12288
v_add_f32 v255, v255, v141
v_mfma_f32_16x16x32_bf16 v[152:155], a[144:147], a[96:99], v[184:187]
v_exp_f32 v145, v145
v_mfma_f32_16x16x32_bf16 v[152:155], a[148:151], a[100:103], v[152:155]
ds_read_b64_tr_b16 a[180:181], v201 offset:8192
v_cvt_pk_bf16_f32 v172, v140, v141
v_mfma_f32_16x16x32_bf16 v[152:155], a[152:155], a[104:107], v[152:155]
v_exp_f32 v146, v146
v_mfma_f32_16x16x32_bf16 v[152:155], a[156:159], a[108:111], v[152:155]
ds_read_b64_tr_b16 a[182:183], v201 offset:12288
v_add_f32 v255, v255, v142
v_add_f32 v255, v255, v143
v_cvt_pk_bf16_f32 v173, v142, v143
v_add_f32 v255, v255, v156
v_add_f32 v255, v255, v157
v_cvt_pk_bf16_f32 v174, v156, v157
v_add_f32 v255, v255, v158
v_add_f32 v255, v255, v159
v_cvt_pk_bf16_f32 v175, v158, v159
v_mfma_f32_16x16x32_bf16 v[140:143], a[128:131], a[112:115], v[188:191]
buffer_load_dwordx4 v209, s[16:19], s34 offen offset:1024 nt lds
v_add_f32 v252, v252, v128
v_mfma_f32_16x16x32_bf16 v[140:143], a[132:135], a[116:119], v[140:143]
ds_read_b64_tr_b16 a[184:185], v202 offset:8192
v_add_f32 v252, v252, v129
v_mfma_f32_16x16x32_bf16 v[140:143], a[136:139], a[120:123], v[140:143]
v_exp_f32 v147, v147
v_mfma_f32_16x16x32_bf16 v[140:143], a[140:143], a[124:127], v[140:143]
ds_read_b64_tr_b16 a[186:187], v202 offset:12288
v_add_f32 v252, v252, v130
v_mfma_f32_16x16x32_bf16 v[156:159], a[144:147], a[112:115], v[188:191]
s_waitcnt lgkmcnt(4)
v_exp_f32 v132, v132
v_mfma_f32_16x16x32_bf16 v[156:159], a[148:151], a[116:119], v[156:159]
ds_read_b64_tr_b16 a[188:189], v203 offset:8192
v_add_f32 v252, v252, v131
v_mfma_f32_16x16x32_bf16 v[156:159], a[152:155], a[120:123], v[156:159]
v_exp_f32 v133, v133
v_mfma_f32_16x16x32_bf16 v[156:159], a[156:159], a[124:127], v[156:159]
ds_read_b64_tr_b16 a[190:191], v203 offset:12288
v_add_f32 v252, v252, v144
v_mfma_f32_16x16x32_bf16 v[0:3], a[160:163], v[160:163], v[0:3]
v_exp_f32 v134, v134
v_mfma_f32_16x16x32_bf16 v[16:19], a[164:167], v[160:163], v[16:19]
v_exp_f32 v135, v135
v_mfma_f32_16x16x32_bf16 v[32:35], a[168:171], v[160:163], v[32:35]
v_exp_f32 v148, v148
v_mfma_f32_16x16x32_bf16 v[48:51], a[172:175], v[160:163], v[48:51]
v_exp_f32 v149, v149
v_mfma_f32_16x16x32_bf16 v[64:67], a[176:179], v[160:163], v[64:67]
s_waitcnt lgkmcnt(0)
v_exp_f32 v150, v150
v_mfma_f32_16x16x32_bf16 v[80:83], a[180:183], v[160:163], v[80:83]
ds_read_b128 a[128:131], v192 offset:8192
v_add_f32 v252, v252, v145
v_mfma_f32_16x16x32_bf16 v[96:99], a[184:187], v[160:163], v[96:99]
v_exp_f32 v151, v151
v_mfma_f32_16x16x32_bf16 v[112:115], a[188:191], v[160:163], v[112:115]
ds_read_b128 a[132:135], v193 offset:8192
v_add_f32 v252, v252, v146
v_mfma_f32_16x16x32_bf16 v[4:7], a[160:163], v[164:167], v[4:7]
buffer_load_dwordx4 v208, s[16:19], s34 offen offset:2048 nt lds
v_cvt_pk_bf16_f32 v160, v128, v129
v_mfma_f32_16x16x32_bf16 v[20:23], a[164:167], v[164:167], v[20:23]
ds_read_b128 a[136:139], v194 offset:8192
v_cvt_pk_bf16_f32 v161, v130, v131
v_mfma_f32_16x16x32_bf16 v[36:39], a[168:171], v[164:167], v[36:39]
v_exp_f32 v136, v136
v_mfma_f32_16x16x32_bf16 v[52:55], a[172:175], v[164:167], v[52:55]
ds_read_b128 a[140:143], v195 offset:8192
v_cvt_pk_bf16_f32 v162, v144, v145
v_mfma_f32_16x16x32_bf16 v[68:71], a[176:179], v[164:167], v[68:71]
v_exp_f32 v137, v137
v_mfma_f32_16x16x32_bf16 v[84:87], a[180:183], v[164:167], v[84:87]
ds_read_b128 a[144:147], v192 offset:12288
v_add_f32 v252, v252, v147
v_mfma_f32_16x16x32_bf16 v[100:103], a[184:187], v[164:167], v[100:103]
v_exp_f32 v138, v138
v_mfma_f32_16x16x32_bf16 v[116:119], a[188:191], v[164:167], v[116:119]
ds_read_b128 a[148:151], v193 offset:12288
v_cvt_pk_bf16_f32 v163, v146, v147
v_mfma_f32_16x16x32_bf16 v[8:11], a[160:163], v[168:171], v[8:11]
s_sub_u32 s37, s35, s49
s_mov_b32 s49, s35
v_add_f32 v253, v253, v132
v_mfma_f32_16x16x32_bf16 v[24:27], a[164:167], v[168:171], v[24:27]
ds_read_b128 a[152:155], v194 offset:12288
v_add_f32 v253, v253, v133
v_mfma_f32_16x16x32_bf16 v[40:43], a[168:171], v[168:171], v[40:43]
s_add_u32 s35, s35, 16384
v_exp_f32 v139, v139
v_mfma_f32_16x16x32_bf16 v[56:59], a[172:175], v[168:171], v[56:59]
ds_read_b128 a[156:159], v195 offset:12288
v_cvt_pk_bf16_f32 v164, v132, v133
v_mfma_f32_16x16x32_bf16 v[72:75], a[176:179], v[168:171], v[72:75]
s_cmp_eq_u32 s35, 163840
s_cselect_b32 s35, 0, s35
v_add_f32 v253, v253, v134
v_mfma_f32_16x16x32_bf16 v[88:91], a[180:183], v[168:171], v[88:91]
v_exp_f32 v152, v152
v_mfma_f32_16x16x32_bf16 v[104:107], a[184:187], v[168:171], v[104:107]
v_exp_f32 v153, v153
v_mfma_f32_16x16x32_bf16 v[120:123], a[188:191], v[168:171], v[120:123]
v_exp_f32 v154, v154
v_mfma_f32_16x16x32_bf16 v[12:15], a[160:163], v[172:175], v[12:15]
buffer_load_dwordx4 v209, s[16:19], s34 offen offset:3072 nt lds
v_add_f32 v253, v253, v135
v_mfma_f32_16x16x32_bf16 v[28:31], a[164:167], v[172:175], v[28:31]
v_exp_f32 v155, v155
v_mfma_f32_16x16x32_bf16 v[44:47], a[168:171], v[172:175], v[44:47]
s_add_u32 s34, s34, 16384
v_exp_f32 v140, v140
v_mfma_f32_16x16x32_bf16 v[60:63], a[172:175], v[172:175], v[60:63]
v_exp_f32 v141, v141
v_mfma_f32_16x16x32_bf16 v[76:79], a[176:179], v[172:175], v[76:79]
s_add_u32 s30, s30, 16384
v_exp_f32 v142, v142
v_mfma_f32_16x16x32_bf16 v[92:95], a[180:183], v[172:175], v[92:95]
v_exp_f32 v143, v143
v_mfma_f32_16x16x32_bf16 v[108:111], a[184:187], v[172:175], v[108:111]
s_cmp_eq_u32 s30, 163840
s_cselect_b32 s30, 0, s30
v_cvt_pk_bf16_f32 v165, v134, v135
v_mfma_f32_16x16x32_bf16 v[124:127], a[188:191], v[172:175], v[124:127]
s_waitcnt lgkmcnt(0)
v_exp_f32 v156, v156
v_add_u32 v196, s37, v196
v_add_u32 v197, s37, v197
v_add_u32 v198, s37, v198
v_add_u32 v199, s37, v199
v_add_u32 v200, s37, v200
v_add_u32 v201, s37, v201
v_add_u32 v202, s37, v202
v_add_u32 v203, s37, v203
v_mfma_f32_16x16x32_bf16 v[128:131], a[128:131], a[64:67], v[176:179]
s_barrier
v_exp_f32 v157, v157
v_mfma_f32_16x16x32_bf16 v[128:131], a[132:135], a[68:71], v[128:131]
ds_read_b64_tr_b16 a[160:161], v196 offset:0
v_add_f32 v253, v253, v148
v_mfma_f32_16x16x32_bf16 v[128:131], a[136:139], a[72:75], v[128:131]
s_add_u32 m0, s30, s29
v_exp_f32 v158, v158
v_mfma_f32_16x16x32_bf16 v[128:131], a[140:143], a[76:79], v[128:131]
ds_read_b64_tr_b16 a[162:163], v196 offset:4096
v_add_f32 v253, v253, v149
v_mfma_f32_16x16x32_bf16 v[144:147], a[144:147], a[64:67], v[176:179]
v_exp_f32 v159, v159
v_mfma_f32_16x16x32_bf16 v[144:147], a[148:151], a[68:71], v[144:147]
ds_read_b64_tr_b16 a[164:165], v197 offset:0
v_cvt_pk_bf16_f32 v166, v148, v149
v_mfma_f32_16x16x32_bf16 v[144:147], a[152:155], a[72:75], v[144:147]
v_add_f32 v253, v253, v150
v_add_f32 v253, v253, v151
v_mfma_f32_16x16x32_bf16 v[144:147], a[156:159], a[76:79], v[144:147]
ds_read_b64_tr_b16 a[166:167], v197 offset:4096
v_cvt_pk_bf16_f32 v167, v150, v151
v_mfma_f32_16x16x32_bf16 v[132:135], a[128:131], a[80:83], v[180:183]
buffer_load_dwordx4 v204, s[12:15], s33 offen offset:0 nt lds
v_add_f32 v254, v254, v136
v_mfma_f32_16x16x32_bf16 v[132:135], a[132:135], a[84:87], v[132:135]
ds_read_b64_tr_b16 a[168:169], v198 offset:0
v_add_f32 v254, v254, v137
v_mfma_f32_16x16x32_bf16 v[132:135], a[136:139], a[88:91], v[132:135]
v_exp_f32 v128, v128
v_mfma_f32_16x16x32_bf16 v[132:135], a[140:143], a[92:95], v[132:135]
ds_read_b64_tr_b16 a[170:171], v198 offset:4096
v_cvt_pk_bf16_f32 v168, v136, v137
v_mfma_f32_16x16x32_bf16 v[148:151], a[144:147], a[80:83], v[180:183]
v_exp_f32 v129, v129
v_mfma_f32_16x16x32_bf16 v[148:151], a[148:151], a[84:87], v[148:151]
ds_read_b64_tr_b16 a[172:173], v199 offset:0
v_add_f32 v254, v254, v138
v_mfma_f32_16x16x32_bf16 v[148:151], a[152:155], a[88:91], v[148:151]
v_exp_f32 v130, v130
v_mfma_f32_16x16x32_bf16 v[148:151], a[156:159], a[92:95], v[148:151]
ds_read_b64_tr_b16 a[174:175], v199 offset:4096
v_add_f32 v254, v254, v139
v_cvt_pk_bf16_f32 v169, v138, v139
v_add_f32 v254, v254, v152
v_add_f32 v254, v254, v153
v_cvt_pk_bf16_f32 v170, v152, v153
v_add_f32 v254, v254, v154
v_add_f32 v254, v254, v155
v_cvt_pk_bf16_f32 v171, v154, v155
v_mfma_f32_16x16x32_bf16 v[136:139], a[128:131], a[96:99], v[184:187]
v_exp_f32 v131, v131
v_mfma_f32_16x16x32_bf16 v[136:139], a[132:135], a[100:103], v[136:139]
ds_read_b64_tr_b16 a[176:177], v200 offset:0
v_add_f32 v255, v255, v140
v_mfma_f32_16x16x32_bf16 v[136:139], a[136:139], a[104:107], v[136:139]
v_exp_f32 v144, v144
v_mfma_f32_16x16x32_bf16 v[136:139], a[140:143], a[108:111], v[136:139]
ds_read_b64_tr_b16 a[178:179], v200 offset:4096
v_add_f32 v255, v255, v141
v_mfma_f32_16x16x32_bf16 v[152:155], a[144:147], a[96:99], v[184:187]
v_exp_f32 v145, v145
v_mfma_f32_16x16x32_bf16 v[152:155], a[148:151], a[100:103], v[152:155]
ds_read_b64_tr_b16 a[180:181], v201 offset:0
v_cvt_pk_bf16_f32 v172, v140, v141
v_mfma_f32_16x16x32_bf16 v[152:155], a[152:155], a[104:107], v[152:155]
v_exp_f32 v146, v146
v_mfma_f32_16x16x32_bf16 v[152:155], a[156:159], a[108:111], v[152:155]
ds_read_b64_tr_b16 a[182:183], v201 offset:4096
v_add_f32 v255, v255, v142
v_add_f32 v255, v255, v143
v_cvt_pk_bf16_f32 v173, v142, v143
v_add_f32 v255, v255, v156
v_add_f32 v255, v255, v157
v_cvt_pk_bf16_f32 v174, v156, v157
v_add_f32 v255, v255, v158
v_add_f32 v255, v255, v159
v_cvt_pk_bf16_f32 v175, v158, v159
v_mfma_f32_16x16x32_bf16 v[140:143], a[128:131], a[112:115], v[188:191]
buffer_load_dwordx4 v205, s[12:15], s33 offen offset:1024 nt lds
v_add_f32 v252, v252, v128
v_mfma_f32_16x16x32_bf16 v[140:143], a[132:135], a[116:119], v[140:143]
ds_read_b64_tr_b16 a[184:185], v202 offset:0
v_add_f32 v252, v252, v129
v_mfma_f32_16x16x32_bf16 v[140:143], a[136:139], a[120:123], v[140:143]
v_exp_f32 v147, v147
v_mfma_f32_16x16x32_bf16 v[140:143], a[140:143], a[124:127], v[140:143]
ds_read_b64_tr_b16 a[186:187], v202 offset:4096
v_add_f32 v252, v252, v130
v_mfma_f32_16x16x32_bf16 v[156:159], a[144:147], a[112:115], v[188:191]
s_waitcnt lgkmcnt(4)
v_exp_f32 v132, v132
v_mfma_f32_16x16x32_bf16 v[156:159], a[148:151], a[116:119], v[156:159]
ds_read_b64_tr_b16 a[188:189], v203 offset:0
v_add_f32 v252, v252, v131
v_mfma_f32_16x16x32_bf16 v[156:159], a[152:155], a[120:123], v[156:159]
v_exp_f32 v133, v133
v_mfma_f32_16x16x32_bf16 v[156:159], a[156:159], a[124:127], v[156:159]
ds_read_b64_tr_b16 a[190:191], v203 offset:4096
v_add_f32 v252, v252, v144
v_mfma_f32_16x16x32_bf16 v[0:3], a[160:163], v[160:163], v[0:3]
v_exp_f32 v134, v134
v_mfma_f32_16x16x32_bf16 v[16:19], a[164:167], v[160:163], v[16:19]
v_exp_f32 v135, v135
v_mfma_f32_16x16x32_bf16 v[32:35], a[168:171], v[160:163], v[32:35]
v_exp_f32 v148, v148
v_mfma_f32_16x16x32_bf16 v[48:51], a[172:175], v[160:163], v[48:51]
v_exp_f32 v149, v149
v_mfma_f32_16x16x32_bf16 v[64:67], a[176:179], v[160:163], v[64:67]
s_waitcnt lgkmcnt(0)
v_exp_f32 v150, v150
v_mfma_f32_16x16x32_bf16 v[80:83], a[180:183], v[160:163], v[80:83]
v_exp_f32 v151, v151
v_mfma_f32_16x16x32_bf16 v[96:99], a[184:187], v[160:163], v[96:99]
v_exp_f32 v136, v136
v_mfma_f32_16x16x32_bf16 v[112:115], a[188:191], v[160:163], v[112:115]
v_exp_f32 v137, v137
v_mfma_f32_16x16x32_bf16 v[4:7], a[160:163], v[164:167], v[4:7]
buffer_load_dwordx4 v206, s[12:15], s33 offen offset:2048 nt lds
v_cvt_pk_bf16_f32 v160, v128, v129
v_mfma_f32_16x16x32_bf16 v[20:23], a[164:167], v[164:167], v[20:23]
v_exp_f32 v138, v138
v_mfma_f32_16x16x32_bf16 v[36:39], a[168:171], v[164:167], v[36:39]
v_exp_f32 v139, v139
v_mfma_f32_16x16x32_bf16 v[52:55], a[172:175], v[164:167], v[52:55]
v_exp_f32 v152, v152
v_mfma_f32_16x16x32_bf16 v[68:71], a[176:179], v[164:167], v[68:71]
v_exp_f32 v153, v153
v_mfma_f32_16x16x32_bf16 v[84:87], a[180:183], v[164:167], v[84:87]
v_exp_f32 v154, v154
v_mfma_f32_16x16x32_bf16 v[100:103], a[184:187], v[164:167], v[100:103]
v_exp_f32 v155, v155
v_mfma_f32_16x16x32_bf16 v[116:119], a[188:191], v[164:167], v[116:119]
v_exp_f32 v140, v140
v_mfma_f32_16x16x32_bf16 v[8:11], a[160:163], v[168:171], v[8:11]
v_exp_f32 v141, v141
v_mfma_f32_16x16x32_bf16 v[24:27], a[164:167], v[168:171], v[24:27]
v_exp_f32 v142, v142
v_mfma_f32_16x16x32_bf16 v[40:43], a[168:171], v[168:171], v[40:43]
v_exp_f32 v143, v143
v_mfma_f32_16x16x32_bf16 v[56:59], a[172:175], v[168:171], v[56:59]
v_exp_f32 v156, v156
v_mfma_f32_16x16x32_bf16 v[72:75], a[176:179], v[168:171], v[72:75]
v_exp_f32 v157, v157
v_mfma_f32_16x16x32_bf16 v[88:91], a[180:183], v[168:171], v[88:91]
v_exp_f32 v158, v158
v_mfma_f32_16x16x32_bf16 v[104:107], a[184:187], v[168:171], v[104:107]
v_exp_f32 v159, v159
v_mfma_f32_16x16x32_bf16 v[120:123], a[188:191], v[168:171], v[120:123]
v_cvt_pk_bf16_f32 v161, v130, v131
v_add_f32 v252, v252, v145
v_mfma_f32_16x16x32_bf16 v[12:15], a[160:163], v[172:175], v[12:15]
buffer_load_dwordx4 v207, s[12:15], s33 offen offset:3072 nt lds
v_cvt_pk_bf16_f32 v162, v144, v145
v_mfma_f32_16x16x32_bf16 v[28:31], a[164:167], v[172:175], v[28:31]
v_add_f32 v252, v252, v146
v_add_f32 v252, v252, v147
v_mfma_f32_16x16x32_bf16 v[44:47], a[168:171], v[172:175], v[44:47]
s_add_u32 s33, s33, 16384
v_cvt_pk_bf16_f32 v163, v146, v147
v_add_f32 v253, v253, v132
v_mfma_f32_16x16x32_bf16 v[60:63], a[172:175], v[172:175], v[60:63]
v_add_f32 v253, v253, v133
v_cvt_pk_bf16_f32 v164, v132, v133
v_mfma_f32_16x16x32_bf16 v[76:79], a[176:179], v[172:175], v[76:79]
s_add_u32 s30, s30, 16384
v_add_f32 v253, v253, v134
v_add_f32 v253, v253, v135
v_mfma_f32_16x16x32_bf16 v[92:95], a[180:183], v[172:175], v[92:95]
v_cvt_pk_bf16_f32 v165, v134, v135
v_add_f32 v253, v253, v148
v_mfma_f32_16x16x32_bf16 v[108:111], a[184:187], v[172:175], v[108:111]
s_cmp_eq_u32 s30, 163840
s_cselect_b32 s30, 0, s30
v_add_f32 v253, v253, v149
v_mfma_f32_16x16x32_bf16 v[124:127], a[188:191], v[172:175], v[124:127]
v_cvt_pk_bf16_f32 v166, v148, v149
v_add_f32 v253, v253, v150
s_barrier
v_add_f32 v253, v253, v151
v_cvt_pk_bf16_f32 v167, v150, v151
v_add_f32 v254, v254, v136
v_add_f32 v254, v254, v137
ds_read_b64_tr_b16 a[160:161], v196 offset:8192
v_cvt_pk_bf16_f32 v168, v136, v137
v_add_f32 v254, v254, v138
v_add_f32 v254, v254, v139
v_cvt_pk_bf16_f32 v169, v138, v139
s_add_u32 m0, s30, s29
v_add_f32 v254, v254, v152
v_add_f32 v254, v254, v153
v_cvt_pk_bf16_f32 v170, v152, v153
v_add_f32 v254, v254, v154
ds_read_b64_tr_b16 a[162:163], v196 offset:12288
v_add_f32 v254, v254, v155
v_cvt_pk_bf16_f32 v171, v154, v155
v_add_f32 v255, v255, v140
v_add_f32 v255, v255, v141
v_cvt_pk_bf16_f32 v172, v140, v141
v_add_f32 v255, v255, v142
v_add_f32 v255, v255, v143
v_cvt_pk_bf16_f32 v173, v142, v143
ds_read_b64_tr_b16 a[164:165], v197 offset:8192
v_add_f32 v255, v255, v156
v_add_f32 v255, v255, v157
v_cvt_pk_bf16_f32 v174, v156, v157
v_add_f32 v255, v255, v158
v_add_f32 v255, v255, v159
v_cvt_pk_bf16_f32 v175, v158, v159
v_max3_f32 v246, v252, v253, v254
v_max_f32 v246, v246, v255
s_mov_b32 s38, 0x57800000
v_cmp_lt_f32 vcc, s38, v246
s_nop 1
s_cmp_lg_u64 vcc, 0
s_cbranch_scc1 L_slow1
L_back1:
ds_read_b64_tr_b16 a[166:167], v197 offset:12288
v_mov_b32 v246, v252
v_mov_b32 v247, v253
v_mov_b32 v248, v254
v_mov_b32 v249, v255
s_nop 0
v_permlane16_swap_b32 v252, v246
v_permlane16_swap_b32 v253, v247
v_permlane16_swap_b32 v254, v248
v_permlane16_swap_b32 v255, v249
s_nop 0
v_add_f32 v252, v252, v246
v_add_f32 v253, v253, v247
v_add_f32 v254, v254, v248
v_add_f32 v255, v255, v249
v_mov_b32 v246, v252
v_mov_b32 v247, v253
v_mov_b32 v248, v254
v_mov_b32 v249, v255
s_nop 0
v_permlane32_swap_b32 v252, v246
v_permlane32_swap_b32 v253, v247
v_permlane32_swap_b32 v254, v248
v_permlane32_swap_b32 v255, v249
s_nop 0
v_add_f32 v252, v252, v246
v_add_f32 v253, v253, v247
v_add_f32 v254, v254, v248
v_add_f32 v255, v255, v249
v_rcp_f32 v246, v252
v_rcp_f32 v247, v253
v_rcp_f32 v248, v254
v_rcp_f32 v249, v255
buffer_load_dwordx4 v208, s[16:19], s34 offen offset:0 nt lds
s_nop 3
ds_read_b64_tr_b16 a[168:169], v198 offset:8192
s_nop 3
s_nop 3
ds_read_b64_tr_b16 a[170:171], v198 offset:12288
s_nop 3
s_nop 3
ds_read_b64_tr_b16 a[172:173], v199 offset:8192
s_nop 3
s_nop 3
ds_read_b64_tr_b16 a[174:175], v199 offset:12288
s_nop 3
s_nop 3
ds_read_b64_tr_b16 a[176:177], v200 offset:8192
s_nop 3
s_nop 3
ds_read_b64_tr_b16 a[178:179], v200 offset:12288
s_nop 3
s_nop 3
ds_read_b64_tr_b16 a[180:181], v201 offset:8192
s_nop 3
s_nop 3
ds_read_b64_tr_b16 a[182:183], v201 offset:12288
s_nop 3
buffer_load_dwordx4 v209, s[16:19], s34 offen offset:1024 nt lds
s_nop 3
ds_read_b64_tr_b16 a[184:185], v202 offset:8192
s_nop 3
s_nop 3
ds_read_b64_tr_b16 a[186:187], v202 offset:12288
s_nop 3
s_waitcnt lgkmcnt(4)
s_nop 3
ds_read_b64_tr_b16 a[188:189], v203 offset:8192
s_nop 3
buffer_load_dword v250, v251, s[20:23], s39 offen sc1
s_nop 3
ds_read_b64_tr_b16 a[190:191], v203 offset:12288
s_nop 3
v_mfma_f32_16x16x32_bf16 v[0:3], a[160:163], v[160:163], v[0:3]
v_mfma_f32_16x16x32_bf16 v[16:19], a[164:167], v[160:163], v[16:19]
v_mfma_f32_16x16x32_bf16 v[32:35], a[168:171], v[160:163], v[32:35]
v_mfma_f32_16x16x32_bf16 v[48:51], a[172:175], v[160:163], v[48:51]
v_mfma_f32_16x16x32_bf16 v[64:67], a[176:179], v[160:163], v[64:67]
s_waitcnt lgkmcnt(0)
v_mfma_f32_16x16x32_bf16 v[80:83], a[180:183], v[160:163], v[80:83]
v_mfma_f32_16x16x32_bf16 v[96:99], a[184:187], v[160:163], v[96:99]
v_mfma_f32_16x16x32_bf16 v[112:115], a[188:191], v[160:163], v[112:115]
v_mfma_f32_16x16x32_bf16 v[4:7], a[160:163], v[164:167], v[4:7]
buffer_load_dwordx4 v208, s[16:19], s34 offen offset:2048 nt lds
v_mfma_f32_16x16x32_bf16 v[20:23], a[164:167], v[164:167], v[20:23]
v_mfma_f32_16x16x32_bf16 v[36:39], a[168:171], v[164:167], v[36:39]
v_mul_f32 v0, v0, v246
v_mul_f32 v1, v1, v246
v_mfma_f32_16x16x32_bf16 v[52:55], a[172:175], v[164:167], v[52:55]
v_mul_f32 v2, v2, v246
v_mul_f32 v3, v3, v246
v_mfma_f32_16x16x32_bf16 v[68:71], a[176:179], v[164:167], v[68:71]
v_cvt_pk_bf16_f32 v238, v0, v1
v_cvt_pk_bf16_f32 v239, v2, v3
v_mfma_f32_16x16x32_bf16 v[84:87], a[180:183], v[164:167], v[84:87]
v_mul_f32 v16, v16, v246
v_mul_f32 v17, v17, v246
v_mfma_f32_16x16x32_bf16 v[100:103], a[184:187], v[164:167], v[100:103]
v_mul_f32 v18, v18, v246
v_mul_f32 v19, v19, v246
v_mfma_f32_16x16x32_bf16 v[116:119], a[188:191], v[164:167], v[116:119]
v_cvt_pk_bf16_f32 v240, v16, v17
v_cvt_pk_bf16_f32 v241, v18, v19
v_mfma_f32_16x16x32_bf16 v[8:11], a[160:163], v[168:171], v[8:11]
s_add_u32 s64, s44, 4096
v_mul_f32 v32, v32, v246
v_mfma_f32_16x16x32_bf16 v[24:27], a[164:167], v[168:171], v[24:27]
buffer_store_dwordx4 v[238:241], v214, s[20:23], s64 offen offset:0 sc1
s_nop 1
v_mfma_f32_16x16x32_bf16 v[40:43], a[168:171], v[168:171], v[40:43]
v_mul_f32 v33, v33, v246
v_mul_f32 v34, v34, v246
v_mfma_f32_16x16x32_bf16 v[56:59], a[172:175], v[168:171], v[56:59]
v_mul_f32 v35, v35, v246
v_cvt_pk_bf16_f32 v242, v32, v33
v_mfma_f32_16x16x32_bf16 v[72:75], a[176:179], v[168:171], v[72:75]
v_cvt_pk_bf16_f32 v243, v34, v35
v_mul_f32 v48, v48, v246
v_mfma_f32_16x16x32_bf16 v[88:91], a[180:183], v[168:171], v[88:91]
v_mul_f32 v49, v49, v246
v_mul_f32 v50, v50, v246
v_mfma_f32_16x16x32_bf16 v[104:107], a[184:187], v[168:171], v[104:107]
v_mul_f32 v51, v51, v246
v_cvt_pk_bf16_f32 v244, v48, v49
v_mfma_f32_16x16x32_bf16 v[120:123], a[188:191], v[168:171], v[120:123]
v_cvt_pk_bf16_f32 v245, v50, v51
v_mul_f32 v64, v64, v246
v_mfma_f32_16x16x32_bf16 v[12:15], a[160:163], v[172:175], v[12:15]
buffer_load_dwordx4 v209, s[16:19], s34 offen offset:3072 nt lds
v_mul_f32 v65, v65, v246
v_mfma_f32_16x16x32_bf16 v[28:31], a[164:167], v[172:175], v[28:31]
buffer_store_dwordx4 v[242:245], v214, s[20:23], s64 offen offset:1024 sc1
s_nop 1
v_mfma_f32_16x16x32_bf16 v[44:47], a[168:171], v[172:175], v[44:47]
s_add_u32 s34, s34, 16384
v_mul_f32 v66, v66, v246
v_mul_f32 v67, v67, v246
v_mfma_f32_16x16x32_bf16 v[60:63], a[172:175], v[172:175], v[60:63]
v_cvt_pk_bf16_f32 v234, v64, v65
v_cvt_pk_bf16_f32 v235, v66, v67
v_mfma_f32_16x16x32_bf16 v[76:79], a[176:179], v[172:175], v[76:79]
s_add_u32 s30, s30, 16384
v_mul_f32 v80, v80, v246
v_mul_f32 v81, v81, v246
v_mfma_f32_16x16x32_bf16 v[92:95], a[180:183], v[172:175], v[92:95]
v_mul_f32 v82, v82, v246
v_mul_f32 v83, v83, v246
v_mfma_f32_16x16x32_bf16 v[108:111], a[184:187], v[172:175], v[108:111]
s_cmp_eq_u32 s30, 163840
s_cselect_b32 s30, 0, s30
v_cvt_pk_bf16_f32 v236, v80, v81
v_mfma_f32_16x16x32_bf16 v[124:127], a[188:191], v[172:175], v[124:127]
v_cvt_pk_bf16_f32 v237, v82, v83
v_mul_f32 v96, v96, v246
buffer_store_dwordx4 v[234:237], v214, s[20:23], s64 offen offset:2048 sc1
s_nop 1
v_mul_f32 v97, v97, v246
v_mul_f32 v98, v98, v246
v_mul_f32 v99, v99, v246
v_cvt_pk_bf16_f32 v238, v96, v97
v_cvt_pk_bf16_f32 v239, v98, v99
v_mul_f32 v112, v112, v246
v_mul_f32 v113, v113, v246
v_mul_f32 v114, v114, v246
v_mul_f32 v115, v115, v246
v_cvt_pk_bf16_f32 v240, v112, v113
v_cvt_pk_bf16_f32 v241, v114, v115
buffer_store_dwordx4 v[238:241], v214, s[20:23], s64 offen offset:3072 sc1
s_nop 1
v_mul_f32 v4, v4, v247
v_mul_f32 v5, v5, v247
v_mul_f32 v6, v6, v247
v_mul_f32 v7, v7, v247
v_cvt_pk_bf16_f32 v242, v4, v5
v_cvt_pk_bf16_f32 v243, v6, v7
v_mul_f32 v20, v20, v247
v_mul_f32 v21, v21, v247
v_mul_f32 v22, v22, v247
v_mul_f32 v23, v23, v247
v_cvt_pk_bf16_f32 v244, v20, v21
v_cvt_pk_bf16_f32 v245, v22, v23
s_add_u32 s65, s45, 4096
buffer_store_dwordx4 v[242:245], v214, s[20:23], s65 offen offset:0 sc1
s_nop 1
v_mul_f32 v36, v36, v247
v_mul_f32 v37, v37, v247
v_mul_f32 v38, v38, v247
v_mul_f32 v39, v39, v247
v_cvt_pk_bf16_f32 v234, v36, v37
v_cvt_pk_bf16_f32 v235, v38, v39
v_mul_f32 v52, v52, v247
v_mul_f32 v53, v53, v247
v_mul_f32 v54, v54, v247
v_mul_f32 v55, v55, v247
v_cvt_pk_bf16_f32 v236, v52, v53
v_cvt_pk_bf16_f32 v237, v54, v55
buffer_store_dwordx4 v[234:237], v214, s[20:23], s65 offen offset:1024 sc1
s_nop 1
v_mul_f32 v68, v68, v247
v_mul_f32 v69, v69, v247
v_mul_f32 v70, v70, v247
v_mul_f32 v71, v71, v247
v_cvt_pk_bf16_f32 v238, v68, v69
v_cvt_pk_bf16_f32 v239, v70, v71
v_mul_f32 v84, v84, v247
v_mul_f32 v85, v85, v247
v_mul_f32 v86, v86, v247
v_mul_f32 v87, v87, v247
v_cvt_pk_bf16_f32 v240, v84, v85
v_cvt_pk_bf16_f32 v241, v86, v87
buffer_store_dwordx4 v[238:241], v214, s[20:23], s65 offen offset:2048 sc1
s_nop 1
v_mul_f32 v100, v100, v247
v_mul_f32 v101, v101, v247
v_mul_f32 v102, v102, v247
v_mul_f32 v103, v103, v247
v_cvt_pk_bf16_f32 v242, v100, v101
v_cvt_pk_bf16_f32 v243, v102, v103
v_mul_f32 v116, v116, v247
v_mul_f32 v117, v117, v247
v_mul_f32 v118, v118, v247
v_mul_f32 v119, v119, v247
v_cvt_pk_bf16_f32 v244, v116, v117
v_cvt_pk_bf16_f32 v245, v118, v119
buffer_store_dwordx4 v[242:245], v214, s[20:23], s65 offen offset:3072 sc1
s_nop 1
v_mul_f32 v8, v8, v248
v_mul_f32 v9, v9, v248
v_mul_f32 v10, v10, v248
v_mul_f32 v11, v11, v248
v_cvt_pk_bf16_f32 v234, v8, v9
v_cvt_pk_bf16_f32 v235, v10, v11
v_mul_f32 v24, v24, v248
v_mul_f32 v25, v25, v248
v_mul_f32 v26, v26, v248
v_mul_f32 v27, v27, v248
v_cvt_pk_bf16_f32 v236, v24, v25
v_cvt_pk_bf16_f32 v237, v26, v27
s_add_u32 s66, s46, 4096
buffer_store_dwordx4 v[234:237], v214, s[20:23], s66 offen offset:0 sc1
s_nop 1
v_mul_f32 v40, v40, v248
v_mul_f32 v41, v41, v248
v_mul_f32 v42, v42, v248
v_mul_f32 v43, v43, v248
v_cvt_pk_bf16_f32 v238, v40, v41
v_cvt_pk_bf16_f32 v239, v42, v43
v_mul_f32 v56, v56, v248
v_mul_f32 v57, v57, v248
v_mul_f32 v58, v58, v248
v_mul_f32 v59, v59, v248
v_cvt_pk_bf16_f32 v240, v56, v57
v_cvt_pk_bf16_f32 v241, v58, v59
buffer_store_dwordx4 v[238:241], v214, s[20:23], s66 offen offset:1024 sc1
s_nop 1
v_mul_f32 v72, v72, v248
v_mul_f32 v73, v73, v248
v_mul_f32 v74, v74, v248
v_mul_f32 v75, v75, v248
v_cvt_pk_bf16_f32 v242, v72, v73
v_cvt_pk_bf16_f32 v243, v74, v75
v_mul_f32 v88, v88, v248
v_mul_f32 v89, v89, v248
v_mul_f32 v90, v90, v248
v_mul_f32 v91, v91, v248
v_cvt_pk_bf16_f32 v244, v88, v89
v_cvt_pk_bf16_f32 v245, v90, v91
buffer_store_dwordx4 v[242:245], v214, s[20:23], s66 offen offset:2048 sc1
s_nop 1
v_mul_f32 v104, v104, v248
v_mul_f32 v105, v105, v248
v_mul_f32 v106, v106, v248
v_mul_f32 v107, v107, v248
v_cvt_pk_bf16_f32 v234, v104, v105
v_cvt_pk_bf16_f32 v235, v106, v107
v_mul_f32 v120, v120, v248
v_mul_f32 v121, v121, v248
v_mul_f32 v122, v122, v248
v_mul_f32 v123, v123, v248
v_cvt_pk_bf16_f32 v236, v120, v121
v_cvt_pk_bf16_f32 v237, v122, v123
buffer_store_dwordx4 v[234:237], v214, s[20:23], s66 offen offset:3072 sc1
s_nop 1
s_nop 3
s_nop 3
v_mul_f32 v12, v12, v249
v_mul_f32 v13, v13, v249
v_mul_f32 v14, v14, v249
v_mul_f32 v15, v15, v249
v_cvt_pk_bf16_f32 v238, v12, v13
v_cvt_pk_bf16_f32 v239, v14, v15
v_mul_f32 v28, v28, v249
v_mul_f32 v29, v29, v249
v_mul_f32 v30, v30, v249
v_mul_f32 v31, v31, v249
v_cvt_pk_bf16_f32 v240, v28, v29
v_cvt_pk_bf16_f32 v241, v30, v31
s_add_u32 s67, s47, 4096
buffer_store_dwordx4 v[238:241], v214, s[20:23], s67 offen offset:0 sc1
s_nop 1
v_mul_f32 v44, v44, v249
v_mul_f32 v45, v45, v249
v_mul_f32 v46, v46, v249
v_mul_f32 v47, v47, v249
v_cvt_pk_bf16_f32 v242, v44, v45
v_cvt_pk_bf16_f32 v243, v46, v47
v_mul_f32 v60, v60, v249
v_mul_f32 v61, v61, v249
v_mul_f32 v62, v62, v249
v_mul_f32 v63, v63, v249
v_cvt_pk_bf16_f32 v244, v60, v61
v_cvt_pk_bf16_f32 v245, v62, v63
buffer_store_dwordx4 v[242:245], v214, s[20:23], s67 offen offset:1024 sc1
s_nop 1
v_mul_f32 v76, v76, v249
v_mul_f32 v77, v77, v249
v_mul_f32 v78, v78, v249
v_mul_f32 v79, v79, v249
v_cvt_pk_bf16_f32 v234, v76, v77
v_cvt_pk_bf16_f32 v235, v78, v79
v_mul_f32 v92, v92, v249
v_mul_f32 v93, v93, v249
v_mul_f32 v94, v94, v249
v_mul_f32 v95, v95, v249
v_cvt_pk_bf16_f32 v236, v92, v93
v_cvt_pk_bf16_f32 v237, v94, v95
buffer_store_dwordx4 v[234:237], v214, s[20:23], s67 offen offset:2048 sc1
s_nop 1
v_mul_f32 v108, v108, v249
v_mul_f32 v109, v109, v249
v_mul_f32 v110, v110, v249
v_mul_f32 v111, v111, v249
v_cvt_pk_bf16_f32 v238, v108, v109
v_cvt_pk_bf16_f32 v239, v110, v111
v_mul_f32 v124, v124, v249
v_mul_f32 v125, v125, v249
v_mul_f32 v126, v126, v249
v_mul_f32 v127, v127, v249
v_cvt_pk_bf16_f32 v240, v124, v125
v_cvt_pk_bf16_f32 v241, v126, v127
buffer_store_dwordx4 v[238:241], v214, s[20:23], s67 offen offset:3072 sc1
s_nop 1
s_mov_b32 s12, s96
s_and_b32 s13, s97, 0xffff
s_mov_b32 s14, 3932160
s_mov_b32 s15, 0x20000
s_mov_b32 s16, s28
s_mov_b32 s8, s20
s_mov_b32 s9, s21
s_mov_b32 s10, 35684352
s_mov_b32 s11, 0x20000
v_lshrrev_b32 v128, 4, v214
v_mov_b32 v131, v214
s_lshr_b32 s18, s2, 3
s_and_b32 s17, s2, 7
s_mul_i32 s17, s17, 30
s_add_u32 s17, s17, s18
s_cmp_lt_u32 s18, 30
s_cbranch_scc1 L_gt
s_waitcnt vmcnt(0)
s_barrier
s_cmp_lg_u32 s16, 0
s_cbranch_scc1 L_s1x
s_mov_b64 exec, s[100:101]
buffer_atomic_add v216, v215, s[8:11], 0 offen offset:4 sc1
s_mov_b64 exec, -1
L_s1x:
s_branch L_k1_done
L_gt:
s_lshr_b32 s18, s17, 3
s_and_b32 s19, s17, 7
s_lshl_b32 s20, s18, 7
s_mul_i32 s22, s20, 4370
s_lshr_b32 s22, s22, 20
s_add_u32 s20, s20, 127
s_mul_i32 s23, s20, 4370
s_lshr_b32 s23, s23, 20
s_sub_u32 s44, s23, s22
s_add_u32 s44, s44, 1
s_lshl_b32 s44, s44, 4
s_add_u32 s42, s44, 0x10000
v_lshrrev_b32 v129, 4, v128
v_and_b32 v130, 15, v128
s_lshl_b32 s20, s16, 15
s_mul_i32 s21, s18, 1048576
s_add_u32 s21, s21, s20
s_add_u32 s24, s21, 0
s_add_u32 s25, s21, 131072
s_add_u32 s26, s21, 262144
s_add_u32 s27, s21, 393216
s_add_u32 s28, s21, 524288
s_add_u32 s29, s21, 655360
s_add_u32 s30, s21, 786432
s_add_u32 s31, s21, 917504
s_mul_i32 s21, s19, 524288
s_add_u32 s21, s21, s20
s_add_u32 s32, s21, 31457280
s_add_u32 s33, s21, 31588352
s_add_u32 s34, s21, 31719424
s_add_u32 s35, s21, 31850496
s_waitcnt vmcnt(18)
s_mov_b32 s43, 0x8000
L_fl_chk:
v_cmp_le_u32 vcc, s42, v250
s_sub_u32 s43, s43, 1
s_cmp_eq_u64 vcc, exec
s_cbranch_scc1 L_fl_ok
s_cmp_eq_u32 s43, 0
s_cbranch_scc1 L_fl_ok
s_sleep 4
buffer_load_dword v250, v251, s[8:11], s39 offen sc1
s_waitcnt vmcnt(0)
s_branch L_fl_chk
L_fl_ok:
buffer_load_dwordx4 a[32:35], v131, s[8:11], s32 offen offset:0 sc1
buffer_load_dwordx4 a[0:3], v131, s[8:11], s24 offen offset:0 sc1
buffer_load_dwordx4 a[4:7], v131, s[8:11], s25 offen offset:0 sc1
buffer_load_dwordx4 a[8:11], v131, s[8:11], s26 offen offset:0 sc1
buffer_load_dwordx4 a[12:15], v131, s[8:11], s27 offen offset:0 sc1
buffer_load_dwordx4 a[16:19], v131, s[8:11], s28 offen offset:0 sc1
buffer_load_dwordx4 a[20:23], v131, s[8:11], s29 offen offset:0 sc1
buffer_load_dwordx4 a[24:27], v131, s[8:11], s30 offen offset:0 sc1
buffer_load_dwordx4 a[28:31], v131, s[8:11], s31 offen offset:0 sc1
buffer_load_dwordx4 a[36:39], v131, s[8:11], s33 offen offset:0 sc1
buffer_load_dwordx4 a[40:43], v131, s[8:11], s34 offen offset:0 sc1
buffer_load_dwordx4 a[44:47], v131, s[8:11], s35 offen offset:0 sc1
buffer_load_dwordx4 a[80:83], v131, s[8:11], s32 offen offset:1024 sc1
buffer_load_dwordx4 a[48:51], v131, s[8:11], s24 offen offset:1024 sc1
buffer_load_dwordx4 a[52:55], v131, s[8:11], s25 offen offset:1024 sc1
buffer_load_dwordx4 a[56:59], v131, s[8:11], s26 offen offset:1024 sc1
buffer_load_dwordx4 a[60:63], v131, s[8:11], s27 offen offset:1024 sc1
buffer_load_dwordx4 a[64:67], v131, s[8:11], s28 offen offset:1024 sc1
buffer_load_dwordx4 a[68:71], v131, s[8:11], s29 offen offset:1024 sc1
buffer_load_dwordx4 a[72:75], v131, s[8:11], s30 offen offset:1024 sc1
buffer_load_dwordx4 a[76:79], v131, s[8:11], s31 offen offset:1024 sc1
buffer_load_dwordx4 a[84:87], v131, s[8:11], s33 offen offset:1024 sc1
buffer_load_dwordx4 a[88:91], v131, s[8:11], s34 offen offset:1024 sc1
buffer_load_dwordx4 a[92:95], v131, s[8:11], s35 offen offset:1024 sc1
buffer_load_dwordx4 a[128:131], v131, s[8:11], s32 offen offset:2048 sc1
buffer_load_dwordx4 a[96:99], v131, s[8:11], s24 offen offset:2048 sc1
buffer_load_dwordx4 a[100:103], v131, s[8:11], s25 offen offset:2048 sc1
buffer_load_dwordx4 a[104:107], v131, s[8:11], s26 offen offset:2048 sc1
buffer_load_dwordx4 a[108:111], v131, s[8:11], s27 offen offset:2048 sc1
buffer_load_dwordx4 a[112:115], v131, s[8:11], s28 offen offset:2048 sc1
buffer_load_dwordx4 a[116:119], v131, s[8:11], s29 offen offset:2048 sc1
buffer_load_dwordx4 a[120:123], v131, s[8:11], s30 offen offset:2048 sc1
buffer_load_dwordx4 a[124:127], v131, s[8:11], s31 offen offset:2048 sc1
buffer_load_dwordx4 a[132:135], v131, s[8:11], s33 offen offset:2048 sc1
buffer_load_dwordx4 a[136:139], v131, s[8:11], s34 offen offset:2048 sc1
buffer_load_dwordx4 a[140:143], v131, s[8:11], s35 offen offset:2048 sc1
buffer_load_dwordx4 a[176:179], v131, s[8:11], s32 offen offset:3072 sc1
buffer_load_dwordx4 a[144:147], v131, s[8:11], s24 offen offset:3072 sc1
buffer_load_dwordx4 a[148:151], v131, s[8:11], s25 offen offset:3072 sc1
buffer_load_dwordx4 a[152:155], v131, s[8:11], s26 offen offset:3072 sc1
buffer_load_dwordx4 a[156:159], v131, s[8:11], s27 offen offset:3072 sc1
buffer_load_dwordx4 a[160:163], v131, s[8:11], s28 offen offset:3072 sc1
buffer_load_dwordx4 a[164:167], v131, s[8:11], s29 offen offset:3072 sc1
buffer_load_dwordx4 a[168:171], v131, s[8:11], s30 offen offset:3072 sc1
buffer_load_dwordx4 a[172:175], v131, s[8:11], s31 offen offset:3072 sc1
buffer_load_dwordx4 a[180:183], v131, s[8:11], s33 offen offset:3072 sc1
buffer_load_dwordx4 a[184:187], v131, s[8:11], s34 offen offset:3072 sc1
buffer_load_dwordx4 a[188:191], v131, s[8:11], s35 offen offset:3072 sc1
s_add_u32 s24, s24, 8192
s_add_u32 s25, s25, 8192
s_add_u32 s26, s26, 8192
s_add_u32 s27, s27, 8192
s_add_u32 s28, s28, 8192
s_add_u32 s29, s29, 8192
s_add_u32 s30, s30, 8192
s_add_u32 s31, s31, 8192
s_add_u32 s32, s32, 8192
s_add_u32 s33, s33, 8192
s_add_u32 s34, s34, 8192
s_add_u32 s35, s35, 8192
s_waitcnt vmcnt(46)
v_mfma_f32_16x16x32_bf16 v[0:3], a[32:35], a[0:3], 0
s_waitcnt vmcnt(45)
v_mfma_f32_16x16x32_bf16 v[4:7], a[32:35], a[4:7], 0
s_waitcnt vmcnt(44)
v_mfma_f32_16x16x32_bf16 v[8:11], a[32:35], a[8:11], 0
s_waitcnt vmcnt(43)
v_mfma_f32_16x16x32_bf16 v[12:15], a[32:35], a[12:15], 0
s_waitcnt vmcnt(42)
v_mfma_f32_16x16x32_bf16 v[16:19], a[32:35], a[16:19], 0
s_waitcnt vmcnt(41)
v_mfma_f32_16x16x32_bf16 v[20:23], a[32:35], a[20:23], 0
s_waitcnt vmcnt(40)
v_mfma_f32_16x16x32_bf16 v[24:27], a[32:35], a[24:27], 0
s_waitcnt vmcnt(39)
v_mfma_f32_16x16x32_bf16 v[28:31], a[32:35], a[28:31], 0
s_waitcnt vmcnt(38)
v_mfma_f32_16x16x32_bf16 v[32:35], a[36:39], a[0:3], 0
v_mfma_f32_16x16x32_bf16 v[36:39], a[36:39], a[4:7], 0
v_mfma_f32_16x16x32_bf16 v[40:43], a[36:39], a[8:11], 0
v_mfma_f32_16x16x32_bf16 v[44:47], a[36:39], a[12:15], 0
v_mfma_f32_16x16x32_bf16 v[48:51], a[36:39], a[16:19], 0
v_mfma_f32_16x16x32_bf16 v[52:55], a[36:39], a[20:23], 0
v_mfma_f32_16x16x32_bf16 v[56:59], a[36:39], a[24:27], 0
v_mfma_f32_16x16x32_bf16 v[60:63], a[36:39], a[28:31], 0
s_waitcnt vmcnt(37)
v_mfma_f32_16x16x32_bf16 v[64:67], a[40:43], a[0:3], 0
v_mfma_f32_16x16x32_bf16 v[68:71], a[40:43], a[4:7], 0
v_mfma_f32_16x16x32_bf16 v[72:75], a[40:43], a[8:11], 0
v_mfma_f32_16x16x32_bf16 v[76:79], a[40:43], a[12:15], 0
v_mfma_f32_16x16x32_bf16 v[80:83], a[40:43], a[16:19], 0
v_mfma_f32_16x16x32_bf16 v[84:87], a[40:43], a[20:23], 0
v_mfma_f32_16x16x32_bf16 v[88:91], a[40:43], a[24:27], 0
v_mfma_f32_16x16x32_bf16 v[92:95], a[40:43], a[28:31], 0
s_waitcnt vmcnt(36)
v_mfma_f32_16x16x32_bf16 v[96:99], a[44:47], a[0:3], 0
v_mfma_f32_16x16x32_bf16 v[100:103], a[44:47], a[4:7], 0
v_mfma_f32_16x16x32_bf16 v[104:107], a[44:47], a[8:11], 0
v_mfma_f32_16x16x32_bf16 v[108:111], a[44:47], a[12:15], 0
v_mfma_f32_16x16x32_bf16 v[112:115], a[44:47], a[16:19], 0
v_mfma_f32_16x16x32_bf16 v[116:119], a[44:47], a[20:23], 0
v_mfma_f32_16x16x32_bf16 v[120:123], a[44:47], a[24:27], 0
v_mfma_f32_16x16x32_bf16 v[124:127], a[44:47], a[28:31], 0
s_barrier
s_cmp_lg_u32 s16, 0
s_cbranch_scc1 L_s1
s_mov_b64 exec, s[100:101]
buffer_atomic_add v216, v215, s[8:11], 0 offen offset:4 sc1
s_mov_b64 exec, -1
L_s1:
s_waitcnt vmcnt(34)
v_mfma_f32_16x16x32_bf16 v[0:3], a[80:83], a[48:51], v[0:3]
buffer_load_dwordx4 a[32:35], v131, s[8:11], s32 offen offset:0 sc1
s_waitcnt vmcnt(34)
v_mfma_f32_16x16x32_bf16 v[4:7], a[80:83], a[52:55], v[4:7]
s_waitcnt vmcnt(33)
v_mfma_f32_16x16x32_bf16 v[8:11], a[80:83], a[56:59], v[8:11]
buffer_load_dwordx4 a[0:3], v131, s[8:11], s24 offen offset:0 sc1
s_waitcnt vmcnt(33)
v_mfma_f32_16x16x32_bf16 v[12:15], a[80:83], a[60:63], v[12:15]
s_waitcnt vmcnt(32)
v_mfma_f32_16x16x32_bf16 v[16:19], a[80:83], a[64:67], v[16:19]
buffer_load_dwordx4 a[4:7], v131, s[8:11], s25 offen offset:0 sc1
s_waitcnt vmcnt(32)
v_mfma_f32_16x16x32_bf16 v[20:23], a[80:83], a[68:71], v[20:23]
s_waitcnt vmcnt(31)
v_mfma_f32_16x16x32_bf16 v[24:27], a[80:83], a[72:75], v[24:27]
buffer_load_dwordx4 a[8:11], v131, s[8:11], s26 offen offset:0 sc1
s_waitcnt vmcnt(31)
v_mfma_f32_16x16x32_bf16 v[28:31], a[80:83], a[76:79], v[28:31]
s_waitcnt vmcnt(30)
v_mfma_f32_16x16x32_bf16 v[32:35], a[84:87], a[48:51], v[32:35]
buffer_load_dwordx4 a[12:15], v131, s[8:11], s27 offen offset:0 sc1
v_mfma_f32_16x16x32_bf16 v[36:39], a[84:87], a[52:55], v[36:39]
v_mfma_f32_16x16x32_bf16 v[40:43], a[84:87], a[56:59], v[40:43]
buffer_load_dwordx4 a[16:19], v131, s[8:11], s28 offen offset:0 sc1
v_mfma_f32_16x16x32_bf16 v[44:47], a[84:87], a[60:63], v[44:47]
v_mfma_f32_16x16x32_bf16 v[48:51], a[84:87], a[64:67], v[48:51]
buffer_load_dwordx4 a[20:23], v131, s[8:11], s29 offen offset:0 sc1
v_mfma_f32_16x16x32_bf16 v[52:55], a[84:87], a[68:71], v[52:55]
v_mfma_f32_16x16x32_bf16 v[56:59], a[84:87], a[72:75], v[56:59]
buffer_load_dwordx4 a[24:27], v131, s[8:11], s30 offen offset:0 sc1
v_mfma_f32_16x16x32_bf16 v[60:63], a[84:87], a[76:79], v[60:63]
s_waitcnt vmcnt(33)
v_mfma_f32_16x16x32_bf16 v[64:67], a[88:91], a[48:51], v[64:67]
buffer_load_dwordx4 a[28:31], v131, s[8:11], s31 offen offset:0 sc1
v_mfma_f32_16x16x32_bf16 v[68:71], a[88:91], a[52:55], v[68:71]
v_mfma_f32_16x16x32_bf16 v[72:75], a[88:91], a[56:59], v[72:75]
buffer_load_dwordx4 a[36:39], v131, s[8:11], s33 offen offset:0 sc1
v_mfma_f32_16x16x32_bf16 v[76:79], a[88:91], a[60:63], v[76:79]
v_mfma_f32_16x16x32_bf16 v[80:83], a[88:91], a[64:67], v[80:83]
buffer_load_dwordx4 a[40:43], v131, s[8:11], s34 offen offset:0 sc1
v_mfma_f32_16x16x32_bf16 v[84:87], a[88:91], a[68:71], v[84:87]
v_mfma_f32_16x16x32_bf16 v[88:91], a[88:91], a[72:75], v[88:91]
buffer_load_dwordx4 a[44:47], v131, s[8:11], s35 offen offset:0 sc1
v_mfma_f32_16x16x32_bf16 v[92:95], a[88:91], a[76:79], v[92:95]
s_waitcnt vmcnt(36)
v_mfma_f32_16x16x32_bf16 v[96:99], a[92:95], a[48:51], v[96:99]
v_mfma_f32_16x16x32_bf16 v[100:103], a[92:95], a[52:55], v[100:103]
v_mfma_f32_16x16x32_bf16 v[104:107], a[92:95], a[56:59], v[104:107]
v_mfma_f32_16x16x32_bf16 v[108:111], a[92:95], a[60:63], v[108:111]
v_mfma_f32_16x16x32_bf16 v[112:115], a[92:95], a[64:67], v[112:115]
v_mfma_f32_16x16x32_bf16 v[116:119], a[92:95], a[68:71], v[116:119]
v_mfma_f32_16x16x32_bf16 v[120:123], a[92:95], a[72:75], v[120:123]
v_mfma_f32_16x16x32_bf16 v[124:127], a[92:95], a[76:79], v[124:127]
s_waitcnt vmcnt(34)
v_mfma_f32_16x16x32_bf16 v[0:3], a[128:131], a[96:99], v[0:3]
buffer_load_dwordx4 a[80:83], v131, s[8:11], s32 offen offset:1024 sc1
s_waitcnt vmcnt(34)
v_mfma_f32_16x16x32_bf16 v[4:7], a[128:131], a[100:103], v[4:7]
s_waitcnt vmcnt(33)
v_mfma_f32_16x16x32_bf16 v[8:11], a[128:131], a[104:107], v[8:11]
buffer_load_dwordx4 a[48:51], v131, s[8:11], s24 offen offset:1024 sc1
s_waitcnt vmcnt(33)
v_mfma_f32_16x16x32_bf16 v[12:15], a[128:131], a[108:111], v[12:15]
s_waitcnt vmcnt(32)
v_mfma_f32_16x16x32_bf16 v[16:19], a[128:131], a[112:115], v[16:19]
buffer_load_dwordx4 a[52:55], v131, s[8:11], s25 offen offset:1024 sc1
s_waitcnt vmcnt(32)
v_mfma_f32_16x16x32_bf16 v[20:23], a[128:131], a[116:119], v[20:23]
s_waitcnt vmcnt(31)
v_mfma_f32_16x16x32_bf16 v[24:27], a[128:131], a[120:123], v[24:27]
buffer_load_dwordx4 a[56:59], v131, s[8:11], s26 offen offset:1024 sc1
s_waitcnt vmcnt(31)
v_mfma_f32_16x16x32_bf16 v[28:31], a[128:131], a[124:127], v[28:31]
s_waitcnt vmcnt(30)
v_mfma_f32_16x16x32_bf16 v[32:35], a[132:135], a[96:99], v[32:35]
buffer_load_dwordx4 a[60:63], v131, s[8:11], s27 offen offset:1024 sc1
v_mfma_f32_16x16x32_bf16 v[36:39], a[132:135], a[100:103], v[36:39]
v_mfma_f32_16x16x32_bf16 v[40:43], a[132:135], a[104:107], v[40:43]
buffer_load_dwordx4 a[64:67], v131, s[8:11], s28 offen offset:1024 sc1
v_mfma_f32_16x16x32_bf16 v[44:47], a[132:135], a[108:111], v[44:47]
v_mfma_f32_16x16x32_bf16 v[48:51], a[132:135], a[112:115], v[48:51]
buffer_load_dwordx4 a[68:71], v131, s[8:11], s29 offen offset:1024 sc1
v_mfma_f32_16x16x32_bf16 v[52:55], a[132:135], a[116:119], v[52:55]
v_mfma_f32_16x16x32_bf16 v[56:59], a[132:135], a[120:123], v[56:59]
buffer_load_dwordx4 a[72:75], v131, s[8:11], s30 offen offset:1024 sc1
v_mfma_f32_16x16x32_bf16 v[60:63], a[132:135], a[124:127], v[60:63]
s_waitcnt vmcnt(33)
v_mfma_f32_16x16x32_bf16 v[64:67], a[136:139], a[96:99], v[64:67]
buffer_load_dwordx4 a[76:79], v131, s[8:11], s31 offen offset:1024 sc1
v_mfma_f32_16x16x32_bf16 v[68:71], a[136:139], a[100:103], v[68:71]
v_mfma_f32_16x16x32_bf16 v[72:75], a[136:139], a[104:107], v[72:75]
buffer_load_dwordx4 a[84:87], v131, s[8:11], s33 offen offset:1024 sc1
v_mfma_f32_16x16x32_bf16 v[76:79], a[136:139], a[108:111], v[76:79]
v_mfma_f32_16x16x32_bf16 v[80:83], a[136:139], a[112:115], v[80:83]
buffer_load_dwordx4 a[88:91], v131, s[8:11], s34 offen offset:1024 sc1
v_mfma_f32_16x16x32_bf16 v[84:87], a[136:139], a[116:119], v[84:87]
v_mfma_f32_16x16x32_bf16 v[88:91], a[136:139], a[120:123], v[88:91]
buffer_load_dwordx4 a[92:95], v131, s[8:11], s35 offen offset:1024 sc1
v_mfma_f32_16x16x32_bf16 v[92:95], a[136:139], a[124:127], v[92:95]
s_waitcnt vmcnt(36)
v_mfma_f32_16x16x32_bf16 v[96:99], a[140:143], a[96:99], v[96:99]
v_mfma_f32_16x16x32_bf16 v[100:103], a[140:143], a[100:103], v[100:103]
v_mfma_f32_16x16x32_bf16 v[104:107], a[140:143], a[104:107], v[104:107]
v_mfma_f32_16x16x32_bf16 v[108:111], a[140:143], a[108:111], v[108:111]
v_mfma_f32_16x16x32_bf16 v[112:115], a[140:143], a[112:115], v[112:115]
v_mfma_f32_16x16x32_bf16 v[116:119], a[140:143], a[116:119], v[116:119]
v_mfma_f32_16x16x32_bf16 v[120:123], a[140:143], a[120:123], v[120:123]
v_mfma_f32_16x16x32_bf16 v[124:127], a[140:143], a[124:127], v[124:127]
s_waitcnt vmcnt(34)
v_mfma_f32_16x16x32_bf16 v[0:3], a[176:179], a[144:147], v[0:3]
buffer_load_dwordx4 a[128:131], v131, s[8:11], s32 offen offset:2048 sc1
s_waitcnt vmcnt(34)
v_mfma_f32_16x16x32_bf16 v[4:7], a[176:179], a[148:151], v[4:7]
s_waitcnt vmcnt(33)
v_mfma_f32_16x16x32_bf16 v[8:11], a[176:179], a[152:155], v[8:11]
buffer_load_dwordx4 a[96:99], v131, s[8:11], s24 offen offset:2048 sc1
s_waitcnt vmcnt(33)
v_mfma_f32_16x16x32_bf16 v[12:15], a[176:179], a[156:159], v[12:15]
s_waitcnt vmcnt(32)
v_mfma_f32_16x16x32_bf16 v[16:19], a[176:179], a[160:163], v[16:19]
buffer_load_dwordx4 a[100:103], v131, s[8:11], s25 offen offset:2048 sc1
s_waitcnt vmcnt(32)
v_mfma_f32_16x16x32_bf16 v[20:23], a[176:179], a[164:167], v[20:23]
s_waitcnt vmcnt(31)
v_mfma_f32_16x16x32_bf16 v[24:27], a[176:179], a[168:171], v[24:27]
buffer_load_dwordx4 a[104:107], v131, s[8:11], s26 offen offset:2048 sc1
s_waitcnt vmcnt(31)
v_mfma_f32_16x16x32_bf16 v[28:31], a[176:179], a[172:175], v[28:31]
s_waitcnt vmcnt(30)
v_mfma_f32_16x16x32_bf16 v[32:35], a[180:183], a[144:147], v[32:35]
buffer_load_dwordx4 a[108:111], v131, s[8:11], s27 offen offset:2048 sc1
v_mfma_f32_16x16x32_bf16 v[36:39], a[180:183], a[148:151], v[36:39]
v_mfma_f32_16x16x32_bf16 v[40:43], a[180:183], a[152:155], v[40:43]
buffer_load_dwordx4 a[112:115], v131, s[8:11], s28 offen offset:2048 sc1
v_mfma_f32_16x16x32_bf16 v[44:47], a[180:183], a[156:159], v[44:47]
v_mfma_f32_16x16x32_bf16 v[48:51], a[180:183], a[160:163], v[48:51]
buffer_load_dwordx4 a[116:119], v131, s[8:11], s29 offen offset:2048 sc1
v_mfma_f32_16x16x32_bf16 v[52:55], a[180:183], a[164:167], v[52:55]
v_mfma_f32_16x16x32_bf16 v[56:59], a[180:183], a[168:171], v[56:59]
buffer_load_dwordx4 a[120:123], v131, s[8:11], s30 offen offset:2048 sc1
v_mfma_f32_16x16x32_bf16 v[60:63], a[180:183], a[172:175], v[60:63]
s_waitcnt vmcnt(33)
v_mfma_f32_16x16x32_bf16 v[64:67], a[184:187], a[144:147], v[64:67]
buffer_load_dwordx4 a[124:127], v131, s[8:11], s31 offen offset:2048 sc1
v_mfma_f32_16x16x32_bf16 v[68:71], a[184:187], a[148:151], v[68:71]
v_mfma_f32_16x16x32_bf16 v[72:75], a[184:187], a[152:155], v[72:75]
buffer_load_dwordx4 a[132:135], v131, s[8:11], s33 offen offset:2048 sc1
v_mfma_f32_16x16x32_bf16 v[76:79], a[184:187], a[156:159], v[76:79]
v_mfma_f32_16x16x32_bf16 v[80:83], a[184:187], a[160:163], v[80:83]
buffer_load_dwordx4 a[136:139], v131, s[8:11], s34 offen offset:2048 sc1
v_mfma_f32_16x16x32_bf16 v[84:87], a[184:187], a[164:167], v[84:87]
v_mfma_f32_16x16x32_bf16 v[88:91], a[184:187], a[168:171], v[88:91]
buffer_load_dwordx4 a[140:143], v131, s[8:11], s35 offen offset:2048 sc1
v_mfma_f32_16x16x32_bf16 v[92:95], a[184:187], a[172:175], v[92:95]
s_waitcnt vmcnt(36)
v_mfma_f32_16x16x32_bf16 v[96:99], a[188:191], a[144:147], v[96:99]
v_mfma_f32_16x16x32_bf16 v[100:103], a[188:191], a[148:151], v[100:103]
v_mfma_f32_16x16x32_bf16 v[104:107], a[188:191], a[152:155], v[104:107]
v_mfma_f32_16x16x32_bf16 v[108:111], a[188:191], a[156:159], v[108:111]
v_mfma_f32_16x16x32_bf16 v[112:115], a[188:191], a[160:163], v[112:115]
v_mfma_f32_16x16x32_bf16 v[116:119], a[188:191], a[164:167], v[116:119]
v_mfma_f32_16x16x32_bf16 v[120:123], a[188:191], a[168:171], v[120:123]
v_mfma_f32_16x16x32_bf16 v[124:127], a[188:191], a[172:175], v[124:127]
s_waitcnt vmcnt(34)
v_mfma_f32_16x16x32_bf16 v[0:3], a[32:35], a[0:3], v[0:3]
buffer_load_dwordx4 a[176:179], v131, s[8:11], s32 offen offset:3072 sc1
s_waitcnt vmcnt(34)
v_mfma_f32_16x16x32_bf16 v[4:7], a[32:35], a[4:7], v[4:7]
s_waitcnt vmcnt(33)
v_mfma_f32_16x16x32_bf16 v[8:11], a[32:35], a[8:11], v[8:11]
buffer_load_dwordx4 a[144:147], v131, s[8:11], s24 offen offset:3072 sc1
s_waitcnt vmcnt(33)
v_mfma_f32_16x16x32_bf16 v[12:15], a[32:35], a[12:15], v[12:15]
s_waitcnt vmcnt(32)
v_mfma_f32_16x16x32_bf16 v[16:19], a[32:35], a[16:19], v[16:19]
buffer_load_dwordx4 a[148:151], v131, s[8:11], s25 offen offset:3072 sc1
s_waitcnt vmcnt(32)
v_mfma_f32_16x16x32_bf16 v[20:23], a[32:35], a[20:23], v[20:23]
s_waitcnt vmcnt(31)
v_mfma_f32_16x16x32_bf16 v[24:27], a[32:35], a[24:27], v[24:27]
buffer_load_dwordx4 a[152:155], v131, s[8:11], s26 offen offset:3072 sc1
s_waitcnt vmcnt(31)
v_mfma_f32_16x16x32_bf16 v[28:31], a[32:35], a[28:31], v[28:31]
s_waitcnt vmcnt(30)
v_mfma_f32_16x16x32_bf16 v[32:35], a[36:39], a[0:3], v[32:35]
buffer_load_dwordx4 a[156:159], v131, s[8:11], s27 offen offset:3072 sc1
v_mfma_f32_16x16x32_bf16 v[36:39], a[36:39], a[4:7], v[36:39]
v_mfma_f32_16x16x32_bf16 v[40:43], a[36:39], a[8:11], v[40:43]
buffer_load_dwordx4 a[160:163], v131, s[8:11], s28 offen offset:3072 sc1
v_mfma_f32_16x16x32_bf16 v[44:47], a[36:39], a[12:15], v[44:47]
v_mfma_f32_16x16x32_bf16 v[48:51], a[36:39], a[16:19], v[48:51]
buffer_load_dwordx4 a[164:167], v131, s[8:11], s29 offen offset:3072 sc1
v_mfma_f32_16x16x32_bf16 v[52:55], a[36:39], a[20:23], v[52:55]
v_mfma_f32_16x16x32_bf16 v[56:59], a[36:39], a[24:27], v[56:59]
buffer_load_dwordx4 a[168:171], v131, s[8:11], s30 offen offset:3072 sc1
v_mfma_f32_16x16x32_bf16 v[60:63], a[36:39], a[28:31], v[60:63]
s_waitcnt vmcnt(33)
v_mfma_f32_16x16x32_bf16 v[64:67], a[40:43], a[0:3], v[64:67]
buffer_load_dwordx4 a[172:175], v131, s[8:11], s31 offen offset:3072 sc1
v_mfma_f32_16x16x32_bf16 v[68:71], a[40:43], a[4:7], v[68:71]
v_mfma_f32_16x16x32_bf16 v[72:75], a[40:43], a[8:11], v[72:75]
buffer_load_dwordx4 a[180:183], v131, s[8:11], s33 offen offset:3072 sc1
v_mfma_f32_16x16x32_bf16 v[76:79], a[40:43], a[12:15], v[76:79]
v_mfma_f32_16x16x32_bf16 v[80:83], a[40:43], a[16:19], v[80:83]
buffer_load_dwordx4 a[184:187], v131, s[8:11], s34 offen offset:3072 sc1
v_mfma_f32_16x16x32_bf16 v[84:87], a[40:43], a[20:23], v[84:87]
v_mfma_f32_16x16x32_bf16 v[88:91], a[40:43], a[24:27], v[88:91]
buffer_load_dwordx4 a[188:191], v131, s[8:11], s35 offen offset:3072 sc1
v_mfma_f32_16x16x32_bf16 v[92:95], a[40:43], a[28:31], v[92:95]
s_waitcnt vmcnt(36)
v_mfma_f32_16x16x32_bf16 v[96:99], a[44:47], a[0:3], v[96:99]
s_add_u32 s24, s24, 8192
v_mfma_f32_16x16x32_bf16 v[100:103], a[44:47], a[4:7], v[100:103]
s_add_u32 s25, s25, 8192
v_mfma_f32_16x16x32_bf16 v[104:107], a[44:47], a[8:11], v[104:107]
s_add_u32 s26, s26, 8192
v_mfma_f32_16x16x32_bf16 v[108:111], a[44:47], a[12:15], v[108:111]
s_add_u32 s27, s27, 8192
v_mfma_f32_16x16x32_bf16 v[112:115], a[44:47], a[16:19], v[112:115]
s_add_u32 s28, s28, 8192
v_mfma_f32_16x16x32_bf16 v[116:119], a[44:47], a[20:23], v[116:119]
s_add_u32 s29, s29, 8192
v_mfma_f32_16x16x32_bf16 v[120:123], a[44:47], a[24:27], v[120:123]
s_add_u32 s30, s30, 8192
v_mfma_f32_16x16x32_bf16 v[124:127], a[44:47], a[28:31], v[124:127]
s_add_u32 s31, s31, 8192
s_add_u32 s32, s32, 8192
s_add_u32 s33, s33, 8192
s_add_u32 s34, s34, 8192
s_add_u32 s35, s35, 8192
s_waitcnt vmcnt(34)
v_mfma_f32_16x16x32_bf16 v[0:3], a[80:83], a[48:51], v[0:3]
buffer_load_dwordx4 a[32:35], v131, s[8:11], s32 offen offset:0 sc1
s_waitcnt vmcnt(34)
v_mfma_f32_16x16x32_bf16 v[4:7], a[80:83], a[52:55], v[4:7]
s_waitcnt vmcnt(33)
v_mfma_f32_16x16x32_bf16 v[8:11], a[80:83], a[56:59], v[8:11]
buffer_load_dwordx4 a[0:3], v131, s[8:11], s24 offen offset:0 sc1
s_waitcnt vmcnt(33)
v_mfma_f32_16x16x32_bf16 v[12:15], a[80:83], a[60:63], v[12:15]
s_waitcnt vmcnt(32)
v_mfma_f32_16x16x32_bf16 v[16:19], a[80:83], a[64:67], v[16:19]
buffer_load_dwordx4 a[4:7], v131, s[8:11], s25 offen offset:0 sc1
s_waitcnt vmcnt(32)
v_mfma_f32_16x16x32_bf16 v[20:23], a[80:83], a[68:71], v[20:23]
s_waitcnt vmcnt(31)
v_mfma_f32_16x16x32_bf16 v[24:27], a[80:83], a[72:75], v[24:27]
buffer_load_dwordx4 a[8:11], v131, s[8:11], s26 offen offset:0 sc1
s_waitcnt vmcnt(31)
v_mfma_f32_16x16x32_bf16 v[28:31], a[80:83], a[76:79], v[28:31]
s_waitcnt vmcnt(30)
v_mfma_f32_16x16x32_bf16 v[32:35], a[84:87], a[48:51], v[32:35]
buffer_load_dwordx4 a[12:15], v131, s[8:11], s27 offen offset:0 sc1
v_mfma_f32_16x16x32_bf16 v[36:39], a[84:87], a[52:55], v[36:39]
v_mfma_f32_16x16x32_bf16 v[40:43], a[84:87], a[56:59], v[40:43]
buffer_load_dwordx4 a[16:19], v131, s[8:11], s28 offen offset:0 sc1
v_mfma_f32_16x16x32_bf16 v[44:47], a[84:87], a[60:63], v[44:47]
v_mfma_f32_16x16x32_bf16 v[48:51], a[84:87], a[64:67], v[48:51]
buffer_load_dwordx4 a[20:23], v131, s[8:11], s29 offen offset:0 sc1
v_mfma_f32_16x16x32_bf16 v[52:55], a[84:87], a[68:71], v[52:55]
v_mfma_f32_16x16x32_bf16 v[56:59], a[84:87], a[72:75], v[56:59]
buffer_load_dwordx4 a[24:27], v131, s[8:11], s30 offen offset:0 sc1
v_mfma_f32_16x16x32_bf16 v[60:63], a[84:87], a[76:79], v[60:63]
s_waitcnt vmcnt(33)
v_mfma_f32_16x16x32_bf16 v[64:67], a[88:91], a[48:51], v[64:67]
buffer_load_dwordx4 a[28:31], v131, s[8:11], s31 offen offset:0 sc1
v_mfma_f32_16x16x32_bf16 v[68:71], a[88:91], a[52:55], v[68:71]
v_mfma_f32_16x16x32_bf16 v[72:75], a[88:91], a[56:59], v[72:75]
buffer_load_dwordx4 a[36:39], v131, s[8:11], s33 offen offset:0 sc1
v_mfma_f32_16x16x32_bf16 v[76:79], a[88:91], a[60:63], v[76:79]
v_mfma_f32_16x16x32_bf16 v[80:83], a[88:91], a[64:67], v[80:83]
buffer_load_dwordx4 a[40:43], v131, s[8:11], s34 offen offset:0 sc1
v_mfma_f32_16x16x32_bf16 v[84:87], a[88:91], a[68:71], v[84:87]
v_mfma_f32_16x16x32_bf16 v[88:91], a[88:91], a[72:75], v[88:91]
buffer_load_dwordx4 a[44:47], v131, s[8:11], s35 offen offset:0 sc1
v_mfma_f32_16x16x32_bf16 v[92:95], a[88:91], a[76:79], v[92:95]
s_waitcnt vmcnt(36)
v_mfma_f32_16x16x32_bf16 v[96:99], a[92:95], a[48:51], v[96:99]
v_mfma_f32_16x16x32_bf16 v[100:103], a[92:95], a[52:55], v[100:103]
v_mfma_f32_16x16x32_bf16 v[104:107], a[92:95], a[56:59], v[104:107]
v_mfma_f32_16x16x32_bf16 v[108:111], a[92:95], a[60:63], v[108:111]
v_mfma_f32_16x16x32_bf16 v[112:115], a[92:95], a[64:67], v[112:115]
v_mfma_f32_16x16x32_bf16 v[116:119], a[92:95], a[68:71], v[116:119]
v_mfma_f32_16x16x32_bf16 v[120:123], a[92:95], a[72:75], v[120:123]
v_mfma_f32_16x16x32_bf16 v[124:127], a[92:95], a[76:79], v[124:127]
s_waitcnt vmcnt(34)
v_mfma_f32_16x16x32_bf16 v[0:3], a[128:131], a[96:99], v[0:3]
buffer_load_dwordx4 a[80:83], v131, s[8:11], s32 offen offset:1024 sc1
s_waitcnt vmcnt(34)
v_mfma_f32_16x16x32_bf16 v[4:7], a[128:131], a[100:103], v[4:7]
s_waitcnt vmcnt(33)
v_mfma_f32_16x16x32_bf16 v[8:11], a[128:131], a[104:107], v[8:11]
buffer_load_dwordx4 a[48:51], v131, s[8:11], s24 offen offset:1024 sc1
s_waitcnt vmcnt(33)
v_mfma_f32_16x16x32_bf16 v[12:15], a[128:131], a[108:111], v[12:15]
s_waitcnt vmcnt(32)
v_mfma_f32_16x16x32_bf16 v[16:19], a[128:131], a[112:115], v[16:19]
buffer_load_dwordx4 a[52:55], v131, s[8:11], s25 offen offset:1024 sc1
s_waitcnt vmcnt(32)
v_mfma_f32_16x16x32_bf16 v[20:23], a[128:131], a[116:119], v[20:23]
s_waitcnt vmcnt(31)
v_mfma_f32_16x16x32_bf16 v[24:27], a[128:131], a[120:123], v[24:27]
buffer_load_dwordx4 a[56:59], v131, s[8:11], s26 offen offset:1024 sc1
s_waitcnt vmcnt(31)
v_mfma_f32_16x16x32_bf16 v[28:31], a[128:131], a[124:127], v[28:31]
s_waitcnt vmcnt(30)
v_mfma_f32_16x16x32_bf16 v[32:35], a[132:135], a[96:99], v[32:35]
buffer_load_dwordx4 a[60:63], v131, s[8:11], s27 offen offset:1024 sc1
v_mfma_f32_16x16x32_bf16 v[36:39], a[132:135], a[100:103], v[36:39]
v_mfma_f32_16x16x32_bf16 v[40:43], a[132:135], a[104:107], v[40:43]
buffer_load_dwordx4 a[64:67], v131, s[8:11], s28 offen offset:1024 sc1
v_mfma_f32_16x16x32_bf16 v[44:47], a[132:135], a[108:111], v[44:47]
v_mfma_f32_16x16x32_bf16 v[48:51], a[132:135], a[112:115], v[48:51]
buffer_load_dwordx4 a[68:71], v131, s[8:11], s29 offen offset:1024 sc1
v_mfma_f32_16x16x32_bf16 v[52:55], a[132:135], a[116:119], v[52:55]
v_mfma_f32_16x16x32_bf16 v[56:59], a[132:135], a[120:123], v[56:59]
buffer_load_dwordx4 a[72:75], v131, s[8:11], s30 offen offset:1024 sc1
v_mfma_f32_16x16x32_bf16 v[60:63], a[132:135], a[124:127], v[60:63]
s_waitcnt vmcnt(33)
v_mfma_f32_16x16x32_bf16 v[64:67], a[136:139], a[96:99], v[64:67]
buffer_load_dwordx4 a[76:79], v131, s[8:11], s31 offen offset:1024 sc1
v_mfma_f32_16x16x32_bf16 v[68:71], a[136:139], a[100:103], v[68:71]
v_mfma_f32_16x16x32_bf16 v[72:75], a[136:139], a[104:107], v[72:75]
buffer_load_dwordx4 a[84:87], v131, s[8:11], s33 offen offset:1024 sc1
v_mfma_f32_16x16x32_bf16 v[76:79], a[136:139], a[108:111], v[76:79]
v_mfma_f32_16x16x32_bf16 v[80:83], a[136:139], a[112:115], v[80:83]
buffer_load_dwordx4 a[88:91], v131, s[8:11], s34 offen offset:1024 sc1
v_mfma_f32_16x16x32_bf16 v[84:87], a[136:139], a[116:119], v[84:87]
v_mfma_f32_16x16x32_bf16 v[88:91], a[136:139], a[120:123], v[88:91]
buffer_load_dwordx4 a[92:95], v131, s[8:11], s35 offen offset:1024 sc1
v_mfma_f32_16x16x32_bf16 v[92:95], a[136:139], a[124:127], v[92:95]
s_waitcnt vmcnt(36)
v_mfma_f32_16x16x32_bf16 v[96:99], a[140:143], a[96:99], v[96:99]
v_mfma_f32_16x16x32_bf16 v[100:103], a[140:143], a[100:103], v[100:103]
v_mfma_f32_16x16x32_bf16 v[104:107], a[140:143], a[104:107], v[104:107]
v_mfma_f32_16x16x32_bf16 v[108:111], a[140:143], a[108:111], v[108:111]
v_mfma_f32_16x16x32_bf16 v[112:115], a[140:143], a[112:115], v[112:115]
v_mfma_f32_16x16x32_bf16 v[116:119], a[140:143], a[116:119], v[116:119]
v_mfma_f32_16x16x32_bf16 v[120:123], a[140:143], a[120:123], v[120:123]
v_mfma_f32_16x16x32_bf16 v[124:127], a[140:143], a[124:127], v[124:127]
s_waitcnt vmcnt(34)
v_mfma_f32_16x16x32_bf16 v[0:3], a[176:179], a[144:147], v[0:3]
buffer_load_dwordx4 a[128:131], v131, s[8:11], s32 offen offset:2048 sc1
s_waitcnt vmcnt(34)
v_mfma_f32_16x16x32_bf16 v[4:7], a[176:179], a[148:151], v[4:7]
s_waitcnt vmcnt(33)
v_mfma_f32_16x16x32_bf16 v[8:11], a[176:179], a[152:155], v[8:11]
buffer_load_dwordx4 a[96:99], v131, s[8:11], s24 offen offset:2048 sc1
s_waitcnt vmcnt(33)
v_mfma_f32_16x16x32_bf16 v[12:15], a[176:179], a[156:159], v[12:15]
s_waitcnt vmcnt(32)
v_mfma_f32_16x16x32_bf16 v[16:19], a[176:179], a[160:163], v[16:19]
buffer_load_dwordx4 a[100:103], v131, s[8:11], s25 offen offset:2048 sc1
s_waitcnt vmcnt(32)
v_mfma_f32_16x16x32_bf16 v[20:23], a[176:179], a[164:167], v[20:23]
s_waitcnt vmcnt(31)
v_mfma_f32_16x16x32_bf16 v[24:27], a[176:179], a[168:171], v[24:27]
buffer_load_dwordx4 a[104:107], v131, s[8:11], s26 offen offset:2048 sc1
s_waitcnt vmcnt(31)
v_mfma_f32_16x16x32_bf16 v[28:31], a[176:179], a[172:175], v[28:31]
s_waitcnt vmcnt(30)
v_mfma_f32_16x16x32_bf16 v[32:35], a[180:183], a[144:147], v[32:35]
buffer_load_dwordx4 a[108:111], v131, s[8:11], s27 offen offset:2048 sc1
v_mfma_f32_16x16x32_bf16 v[36:39], a[180:183], a[148:151], v[36:39]
v_mfma_f32_16x16x32_bf16 v[40:43], a[180:183], a[152:155], v[40:43]
buffer_load_dwordx4 a[112:115], v131, s[8:11], s28 offen offset:2048 sc1
v_mfma_f32_16x16x32_bf16 v[44:47], a[180:183], a[156:159], v[44:47]
v_mfma_f32_16x16x32_bf16 v[48:51], a[180:183], a[160:163], v[48:51]
buffer_load_dwordx4 a[116:119], v131, s[8:11], s29 offen offset:2048 sc1
v_mfma_f32_16x16x32_bf16 v[52:55], a[180:183], a[164:167], v[52:55]
v_mfma_f32_16x16x32_bf16 v[56:59], a[180:183], a[168:171], v[56:59]
buffer_load_dwordx4 a[120:123], v131, s[8:11], s30 offen offset:2048 sc1
v_mfma_f32_16x16x32_bf16 v[60:63], a[180:183], a[172:175], v[60:63]
s_waitcnt vmcnt(33)
v_mfma_f32_16x16x32_bf16 v[64:67], a[184:187], a[144:147], v[64:67]
buffer_load_dwordx4 a[124:127], v131, s[8:11], s31 offen offset:2048 sc1
v_mfma_f32_16x16x32_bf16 v[68:71], a[184:187], a[148:151], v[68:71]
v_mfma_f32_16x16x32_bf16 v[72:75], a[184:187], a[152:155], v[72:75]
buffer_load_dwordx4 a[132:135], v131, s[8:11], s33 offen offset:2048 sc1
v_mfma_f32_16x16x32_bf16 v[76:79], a[184:187], a[156:159], v[76:79]
v_mfma_f32_16x16x32_bf16 v[80:83], a[184:187], a[160:163], v[80:83]
buffer_load_dwordx4 a[136:139], v131, s[8:11], s34 offen offset:2048 sc1
v_mfma_f32_16x16x32_bf16 v[84:87], a[184:187], a[164:167], v[84:87]
v_mfma_f32_16x16x32_bf16 v[88:91], a[184:187], a[168:171], v[88:91]
buffer_load_dwordx4 a[140:143], v131, s[8:11], s35 offen offset:2048 sc1
v_mfma_f32_16x16x32_bf16 v[92:95], a[184:187], a[172:175], v[92:95]
s_waitcnt vmcnt(36)
v_mfma_f32_16x16x32_bf16 v[96:99], a[188:191], a[144:147], v[96:99]
v_mfma_f32_16x16x32_bf16 v[100:103], a[188:191], a[148:151], v[100:103]
v_mfma_f32_16x16x32_bf16 v[104:107], a[188:191], a[152:155], v[104:107]
v_mfma_f32_16x16x32_bf16 v[108:111], a[188:191], a[156:159], v[108:111]
v_mfma_f32_16x16x32_bf16 v[112:115], a[188:191], a[160:163], v[112:115]
v_mfma_f32_16x16x32_bf16 v[116:119], a[188:191], a[164:167], v[116:119]
v_mfma_f32_16x16x32_bf16 v[120:123], a[188:191], a[168:171], v[120:123]
v_mfma_f32_16x16x32_bf16 v[124:127], a[188:191], a[172:175], v[124:127]
s_waitcnt vmcnt(34)
v_mfma_f32_16x16x32_bf16 v[0:3], a[32:35], a[0:3], v[0:3]
buffer_load_dwordx4 a[176:179], v131, s[8:11], s32 offen offset:3072 sc1
s_waitcnt vmcnt(34)
v_mfma_f32_16x16x32_bf16 v[4:7], a[32:35], a[4:7], v[4:7]
s_waitcnt vmcnt(33)
v_mfma_f32_16x16x32_bf16 v[8:11], a[32:35], a[8:11], v[8:11]
buffer_load_dwordx4 a[144:147], v131, s[8:11], s24 offen offset:3072 sc1
s_waitcnt vmcnt(33)
v_mfma_f32_16x16x32_bf16 v[12:15], a[32:35], a[12:15], v[12:15]
s_waitcnt vmcnt(32)
v_mfma_f32_16x16x32_bf16 v[16:19], a[32:35], a[16:19], v[16:19]
buffer_load_dwordx4 a[148:151], v131, s[8:11], s25 offen offset:3072 sc1
s_waitcnt vmcnt(32)
v_mfma_f32_16x16x32_bf16 v[20:23], a[32:35], a[20:23], v[20:23]
s_waitcnt vmcnt(31)
v_mfma_f32_16x16x32_bf16 v[24:27], a[32:35], a[24:27], v[24:27]
buffer_load_dwordx4 a[152:155], v131, s[8:11], s26 offen offset:3072 sc1
s_waitcnt vmcnt(31)
v_mfma_f32_16x16x32_bf16 v[28:31], a[32:35], a[28:31], v[28:31]
s_waitcnt vmcnt(30)
v_mfma_f32_16x16x32_bf16 v[32:35], a[36:39], a[0:3], v[32:35]
buffer_load_dwordx4 a[156:159], v131, s[8:11], s27 offen offset:3072 sc1
v_mfma_f32_16x16x32_bf16 v[36:39], a[36:39], a[4:7], v[36:39]
v_mfma_f32_16x16x32_bf16 v[40:43], a[36:39], a[8:11], v[40:43]
buffer_load_dwordx4 a[160:163], v131, s[8:11], s28 offen offset:3072 sc1
v_mfma_f32_16x16x32_bf16 v[44:47], a[36:39], a[12:15], v[44:47]
v_mfma_f32_16x16x32_bf16 v[48:51], a[36:39], a[16:19], v[48:51]
buffer_load_dwordx4 a[164:167], v131, s[8:11], s29 offen offset:3072 sc1
v_mfma_f32_16x16x32_bf16 v[52:55], a[36:39], a[20:23], v[52:55]
v_mfma_f32_16x16x32_bf16 v[56:59], a[36:39], a[24:27], v[56:59]
buffer_load_dwordx4 a[168:171], v131, s[8:11], s30 offen offset:3072 sc1
v_mfma_f32_16x16x32_bf16 v[60:63], a[36:39], a[28:31], v[60:63]
s_waitcnt vmcnt(33)
v_mfma_f32_16x16x32_bf16 v[64:67], a[40:43], a[0:3], v[64:67]
buffer_load_dwordx4 a[172:175], v131, s[8:11], s31 offen offset:3072 sc1
v_mfma_f32_16x16x32_bf16 v[68:71], a[40:43], a[4:7], v[68:71]
v_mfma_f32_16x16x32_bf16 v[72:75], a[40:43], a[8:11], v[72:75]
buffer_load_dwordx4 a[180:183], v131, s[8:11], s33 offen offset:3072 sc1
v_mfma_f32_16x16x32_bf16 v[76:79], a[40:43], a[12:15], v[76:79]
v_mfma_f32_16x16x32_bf16 v[80:83], a[40:43], a[16:19], v[80:83]
buffer_load_dwordx4 a[184:187], v131, s[8:11], s34 offen offset:3072 sc1
v_mfma_f32_16x16x32_bf16 v[84:87], a[40:43], a[20:23], v[84:87]
v_mfma_f32_16x16x32_bf16 v[88:91], a[40:43], a[24:27], v[88:91]
buffer_load_dwordx4 a[188:191], v131, s[8:11], s35 offen offset:3072 sc1
v_mfma_f32_16x16x32_bf16 v[92:95], a[40:43], a[28:31], v[92:95]
s_waitcnt vmcnt(36)
v_mfma_f32_16x16x32_bf16 v[96:99], a[44:47], a[0:3], v[96:99]
s_add_u32 s24, s24, 8192
v_mfma_f32_16x16x32_bf16 v[100:103], a[44:47], a[4:7], v[100:103]
s_add_u32 s25, s25, 8192
v_mfma_f32_16x16x32_bf16 v[104:107], a[44:47], a[8:11], v[104:107]
s_add_u32 s26, s26, 8192
v_mfma_f32_16x16x32_bf16 v[108:111], a[44:47], a[12:15], v[108:111]
s_add_u32 s27, s27, 8192
v_mfma_f32_16x16x32_bf16 v[112:115], a[44:47], a[16:19], v[112:115]
s_add_u32 s28, s28, 8192
v_mfma_f32_16x16x32_bf16 v[116:119], a[44:47], a[20:23], v[116:119]
s_add_u32 s29, s29, 8192
v_mfma_f32_16x16x32_bf16 v[120:123], a[44:47], a[24:27], v[120:123]
s_add_u32 s30, s30, 8192
v_mfma_f32_16x16x32_bf16 v[124:127], a[44:47], a[28:31], v[124:127]
s_add_u32 s31, s31, 8192
s_add_u32 s32, s32, 8192
s_add_u32 s33, s33, 8192
s_add_u32 s34, s34, 8192
s_add_u32 s35, s35, 8192
s_waitcnt vmcnt(34)
v_mfma_f32_16x16x32_bf16 v[0:3], a[80:83], a[48:51], v[0:3]
buffer_load_dwordx4 a[32:35], v131, s[8:11], s32 offen offset:0 sc1
s_waitcnt vmcnt(34)
v_mfma_f32_16x16x32_bf16 v[4:7], a[80:83], a[52:55], v[4:7]
s_waitcnt vmcnt(33)
v_mfma_f32_16x16x32_bf16 v[8:11], a[80:83], a[56:59], v[8:11]
buffer_load_dwordx4 a[0:3], v131, s[8:11], s24 offen offset:0 sc1
s_waitcnt vmcnt(33)
v_mfma_f32_16x16x32_bf16 v[12:15], a[80:83], a[60:63], v[12:15]
s_waitcnt vmcnt(32)
v_mfma_f32_16x16x32_bf16 v[16:19], a[80:83], a[64:67], v[16:19]
buffer_load_dwordx4 a[4:7], v131, s[8:11], s25 offen offset:0 sc1
s_waitcnt vmcnt(32)
v_mfma_f32_16x16x32_bf16 v[20:23], a[80:83], a[68:71], v[20:23]
s_waitcnt vmcnt(31)
v_mfma_f32_16x16x32_bf16 v[24:27], a[80:83], a[72:75], v[24:27]
buffer_load_dwordx4 a[8:11], v131, s[8:11], s26 offen offset:0 sc1
s_waitcnt vmcnt(31)
v_mfma_f32_16x16x32_bf16 v[28:31], a[80:83], a[76:79], v[28:31]
s_waitcnt vmcnt(30)
v_mfma_f32_16x16x32_bf16 v[32:35], a[84:87], a[48:51], v[32:35]
buffer_load_dwordx4 a[12:15], v131, s[8:11], s27 offen offset:0 sc1
v_mfma_f32_16x16x32_bf16 v[36:39], a[84:87], a[52:55], v[36:39]
v_mfma_f32_16x16x32_bf16 v[40:43], a[84:87], a[56:59], v[40:43]
buffer_load_dwordx4 a[16:19], v131, s[8:11], s28 offen offset:0 sc1
v_mfma_f32_16x16x32_bf16 v[44:47], a[84:87], a[60:63], v[44:47]
v_mfma_f32_16x16x32_bf16 v[48:51], a[84:87], a[64:67], v[48:51]
buffer_load_dwordx4 a[20:23], v131, s[8:11], s29 offen offset:0 sc1
v_mfma_f32_16x16x32_bf16 v[52:55], a[84:87], a[68:71], v[52:55]
v_mfma_f32_16x16x32_bf16 v[56:59], a[84:87], a[72:75], v[56:59]
buffer_load_dwordx4 a[24:27], v131, s[8:11], s30 offen offset:0 sc1
v_mfma_f32_16x16x32_bf16 v[60:63], a[84:87], a[76:79], v[60:63]
s_waitcnt vmcnt(33)
v_mfma_f32_16x16x32_bf16 v[64:67], a[88:91], a[48:51], v[64:67]
buffer_load_dwordx4 a[28:31], v131, s[8:11], s31 offen offset:0 sc1
v_mfma_f32_16x16x32_bf16 v[68:71], a[88:91], a[52:55], v[68:71]
v_mfma_f32_16x16x32_bf16 v[72:75], a[88:91], a[56:59], v[72:75]
buffer_load_dwordx4 a[36:39], v131, s[8:11], s33 offen offset:0 sc1
v_mfma_f32_16x16x32_bf16 v[76:79], a[88:91], a[60:63], v[76:79]
v_mfma_f32_16x16x32_bf16 v[80:83], a[88:91], a[64:67], v[80:83]
buffer_load_dwordx4 a[40:43], v131, s[8:11], s34 offen offset:0 sc1
v_mfma_f32_16x16x32_bf16 v[84:87], a[88:91], a[68:71], v[84:87]
v_mfma_f32_16x16x32_bf16 v[88:91], a[88:91], a[72:75], v[88:91]
buffer_load_dwordx4 a[44:47], v131, s[8:11], s35 offen offset:0 sc1
v_mfma_f32_16x16x32_bf16 v[92:95], a[88:91], a[76:79], v[92:95]
s_waitcnt vmcnt(36)
v_mfma_f32_16x16x32_bf16 v[96:99], a[92:95], a[48:51], v[96:99]
v_mfma_f32_16x16x32_bf16 v[100:103], a[92:95], a[52:55], v[100:103]
buffer_load_dword v250, v251, s[8:11], s39 offen offset:4 sc1
v_mfma_f32_16x16x32_bf16 v[104:107], a[92:95], a[56:59], v[104:107]
v_mfma_f32_16x16x32_bf16 v[108:111], a[92:95], a[60:63], v[108:111]
v_mfma_f32_16x16x32_bf16 v[112:115], a[92:95], a[64:67], v[112:115]
v_mfma_f32_16x16x32_bf16 v[116:119], a[92:95], a[68:71], v[116:119]
v_mfma_f32_16x16x32_bf16 v[120:123], a[92:95], a[72:75], v[120:123]
v_mfma_f32_16x16x32_bf16 v[124:127], a[92:95], a[76:79], v[124:127]
s_waitcnt vmcnt(35)
v_mfma_f32_16x16x32_bf16 v[0:3], a[128:131], a[96:99], v[0:3]
buffer_load_dwordx4 a[80:83], v131, s[8:11], s32 offen offset:1024 sc1
s_waitcnt vmcnt(35)
v_mfma_f32_16x16x32_bf16 v[4:7], a[128:131], a[100:103], v[4:7]
s_waitcnt vmcnt(34)
v_mfma_f32_16x16x32_bf16 v[8:11], a[128:131], a[104:107], v[8:11]
buffer_load_dwordx4 a[48:51], v131, s[8:11], s24 offen offset:1024 sc1
s_waitcnt vmcnt(34)
v_mfma_f32_16x16x32_bf16 v[12:15], a[128:131], a[108:111], v[12:15]
s_waitcnt vmcnt(33)
v_mfma_f32_16x16x32_bf16 v[16:19], a[128:131], a[112:115], v[16:19]
buffer_load_dwordx4 a[52:55], v131, s[8:11], s25 offen offset:1024 sc1
s_waitcnt vmcnt(33)
v_mfma_f32_16x16x32_bf16 v[20:23], a[128:131], a[116:119], v[20:23]
s_waitcnt vmcnt(32)
v_mfma_f32_16x16x32_bf16 v[24:27], a[128:131], a[120:123], v[24:27]
buffer_load_dwordx4 a[56:59], v131, s[8:11], s26 offen offset:1024 sc1
s_waitcnt vmcnt(32)
v_mfma_f32_16x16x32_bf16 v[28:31], a[128:131], a[124:127], v[28:31]
s_waitcnt vmcnt(31)
v_mfma_f32_16x16x32_bf16 v[32:35], a[132:135], a[96:99], v[32:35]
buffer_load_dwordx4 a[60:63], v131, s[8:11], s27 offen offset:1024 sc1
v_mfma_f32_16x16x32_bf16 v[36:39], a[132:135], a[100:103], v[36:39]
v_mfma_f32_16x16x32_bf16 v[40:43], a[132:135], a[104:107], v[40:43]
buffer_load_dwordx4 a[64:67], v131, s[8:11], s28 offen offset:1024 sc1
v_mfma_f32_16x16x32_bf16 v[44:47], a[132:135], a[108:111], v[44:47]
v_mfma_f32_16x16x32_bf16 v[48:51], a[132:135], a[112:115], v[48:51]
buffer_load_dwordx4 a[68:71], v131, s[8:11], s29 offen offset:1024 sc1
v_mfma_f32_16x16x32_bf16 v[52:55], a[132:135], a[116:119], v[52:55]
v_mfma_f32_16x16x32_bf16 v[56:59], a[132:135], a[120:123], v[56:59]
buffer_load_dwordx4 a[72:75], v131, s[8:11], s30 offen offset:1024 sc1
v_mfma_f32_16x16x32_bf16 v[60:63], a[132:135], a[124:127], v[60:63]
s_waitcnt vmcnt(34)
v_mfma_f32_16x16x32_bf16 v[64:67], a[136:139], a[96:99], v[64:67]
buffer_load_dwordx4 a[76:79], v131, s[8:11], s31 offen offset:1024 sc1
v_mfma_f32_16x16x32_bf16 v[68:71], a[136:139], a[100:103], v[68:71]
v_mfma_f32_16x16x32_bf16 v[72:75], a[136:139], a[104:107], v[72:75]
buffer_load_dwordx4 a[84:87], v131, s[8:11], s33 offen offset:1024 sc1
v_mfma_f32_16x16x32_bf16 v[76:79], a[136:139], a[108:111], v[76:79]
v_mfma_f32_16x16x32_bf16 v[80:83], a[136:139], a[112:115], v[80:83]
buffer_load_dwordx4 a[88:91], v131, s[8:11], s34 offen offset:1024 sc1
v_mfma_f32_16x16x32_bf16 v[84:87], a[136:139], a[116:119], v[84:87]
v_mfma_f32_16x16x32_bf16 v[88:91], a[136:139], a[120:123], v[88:91]
buffer_load_dwordx4 a[92:95], v131, s[8:11], s35 offen offset:1024 sc1
v_mfma_f32_16x16x32_bf16 v[92:95], a[136:139], a[124:127], v[92:95]
s_waitcnt vmcnt(37)
v_mfma_f32_16x16x32_bf16 v[96:99], a[140:143], a[96:99], v[96:99]
v_mfma_f32_16x16x32_bf16 v[100:103], a[140:143], a[100:103], v[100:103]
v_mfma_f32_16x16x32_bf16 v[104:107], a[140:143], a[104:107], v[104:107]
v_mfma_f32_16x16x32_bf16 v[108:111], a[140:143], a[108:111], v[108:111]
v_mfma_f32_16x16x32_bf16 v[112:115], a[140:143], a[112:115], v[112:115]
v_mfma_f32_16x16x32_bf16 v[116:119], a[140:143], a[116:119], v[116:119]
v_mfma_f32_16x16x32_bf16 v[120:123], a[140:143], a[120:123], v[120:123]
v_mfma_f32_16x16x32_bf16 v[124:127], a[140:143], a[124:127], v[124:127]
s_waitcnt vmcnt(35)
v_mfma_f32_16x16x32_bf16 v[0:3], a[176:179], a[144:147], v[0:3]
buffer_load_dwordx4 a[128:131], v131, s[8:11], s32 offen offset:2048 sc1
s_waitcnt vmcnt(35)
v_mfma_f32_16x16x32_bf16 v[4:7], a[176:179], a[148:151], v[4:7]
s_waitcnt vmcnt(34)
v_mfma_f32_16x16x32_bf16 v[8:11], a[176:179], a[152:155], v[8:11]
buffer_load_dwordx4 a[96:99], v131, s[8:11], s24 offen offset:2048 sc1
s_waitcnt vmcnt(34)
v_mfma_f32_16x16x32_bf16 v[12:15], a[176:179], a[156:159], v[12:15]
s_waitcnt vmcnt(33)
v_mfma_f32_16x16x32_bf16 v[16:19], a[176:179], a[160:163], v[16:19]
buffer_load_dwordx4 a[100:103], v131, s[8:11], s25 offen offset:2048 sc1
s_waitcnt vmcnt(33)
v_mfma_f32_16x16x32_bf16 v[20:23], a[176:179], a[164:167], v[20:23]
s_waitcnt vmcnt(32)
v_mfma_f32_16x16x32_bf16 v[24:27], a[176:179], a[168:171], v[24:27]
buffer_load_dwordx4 a[104:107], v131, s[8:11], s26 offen offset:2048 sc1
s_waitcnt vmcnt(32)
v_mfma_f32_16x16x32_bf16 v[28:31], a[176:179], a[172:175], v[28:31]
s_waitcnt vmcnt(31)
v_mfma_f32_16x16x32_bf16 v[32:35], a[180:183], a[144:147], v[32:35]
buffer_load_dwordx4 a[108:111], v131, s[8:11], s27 offen offset:2048 sc1
v_mfma_f32_16x16x32_bf16 v[36:39], a[180:183], a[148:151], v[36:39]
v_mfma_f32_16x16x32_bf16 v[40:43], a[180:183], a[152:155], v[40:43]
buffer_load_dwordx4 a[112:115], v131, s[8:11], s28 offen offset:2048 sc1
v_mfma_f32_16x16x32_bf16 v[44:47], a[180:183], a[156:159], v[44:47]
v_mfma_f32_16x16x32_bf16 v[48:51], a[180:183], a[160:163], v[48:51]
buffer_load_dwordx4 a[116:119], v131, s[8:11], s29 offen offset:2048 sc1
v_mfma_f32_16x16x32_bf16 v[52:55], a[180:183], a[164:167], v[52:55]
v_mfma_f32_16x16x32_bf16 v[56:59], a[180:183], a[168:171], v[56:59]
buffer_load_dwordx4 a[120:123], v131, s[8:11], s30 offen offset:2048 sc1
v_mfma_f32_16x16x32_bf16 v[60:63], a[180:183], a[172:175], v[60:63]
s_waitcnt vmcnt(34)
v_mfma_f32_16x16x32_bf16 v[64:67], a[184:187], a[144:147], v[64:67]
buffer_load_dwordx4 a[124:127], v131, s[8:11], s31 offen offset:2048 sc1
v_mfma_f32_16x16x32_bf16 v[68:71], a[184:187], a[148:151], v[68:71]
v_mfma_f32_16x16x32_bf16 v[72:75], a[184:187], a[152:155], v[72:75]
buffer_load_dwordx4 a[132:135], v131, s[8:11], s33 offen offset:2048 sc1
v_mfma_f32_16x16x32_bf16 v[76:79], a[184:187], a[156:159], v[76:79]
v_mfma_f32_16x16x32_bf16 v[80:83], a[184:187], a[160:163], v[80:83]
buffer_load_dwordx4 a[136:139], v131, s[8:11], s34 offen offset:2048 sc1
v_mfma_f32_16x16x32_bf16 v[84:87], a[184:187], a[164:167], v[84:87]
v_mfma_f32_16x16x32_bf16 v[88:91], a[184:187], a[168:171], v[88:91]
buffer_load_dwordx4 a[140:143], v131, s[8:11], s35 offen offset:2048 sc1
v_mfma_f32_16x16x32_bf16 v[92:95], a[184:187], a[172:175], v[92:95]
s_waitcnt vmcnt(37)
v_mfma_f32_16x16x32_bf16 v[96:99], a[188:191], a[144:147], v[96:99]
v_mfma_f32_16x16x32_bf16 v[100:103], a[188:191], a[148:151], v[100:103]
v_mfma_f32_16x16x32_bf16 v[104:107], a[188:191], a[152:155], v[104:107]
v_mfma_f32_16x16x32_bf16 v[108:111], a[188:191], a[156:159], v[108:111]
v_mfma_f32_16x16x32_bf16 v[112:115], a[188:191], a[160:163], v[112:115]
v_mfma_f32_16x16x32_bf16 v[116:119], a[188:191], a[164:167], v[116:119]
v_mfma_f32_16x16x32_bf16 v[120:123], a[188:191], a[168:171], v[120:123]
v_mfma_f32_16x16x32_bf16 v[124:127], a[188:191], a[172:175], v[124:127]
s_waitcnt vmcnt(35)
v_mfma_f32_16x16x32_bf16 v[0:3], a[32:35], a[0:3], v[0:3]
buffer_load_dwordx4 a[176:179], v131, s[8:11], s32 offen offset:3072 sc1
s_waitcnt vmcnt(35)
v_mfma_f32_16x16x32_bf16 v[4:7], a[32:35], a[4:7], v[4:7]
s_waitcnt vmcnt(34)
v_mfma_f32_16x16x32_bf16 v[8:11], a[32:35], a[8:11], v[8:11]
buffer_load_dwordx4 a[144:147], v131, s[8:11], s24 offen offset:3072 sc1
s_waitcnt vmcnt(34)
v_mfma_f32_16x16x32_bf16 v[12:15], a[32:35], a[12:15], v[12:15]
s_waitcnt vmcnt(33)
v_mfma_f32_16x16x32_bf16 v[16:19], a[32:35], a[16:19], v[16:19]
buffer_load_dwordx4 a[148:151], v131, s[8:11], s25 offen offset:3072 sc1
s_waitcnt vmcnt(33)
v_mfma_f32_16x16x32_bf16 v[20:23], a[32:35], a[20:23], v[20:23]
s_waitcnt vmcnt(32)
v_mfma_f32_16x16x32_bf16 v[24:27], a[32:35], a[24:27], v[24:27]
buffer_load_dwordx4 a[152:155], v131, s[8:11], s26 offen offset:3072 sc1
s_waitcnt vmcnt(32)
v_mfma_f32_16x16x32_bf16 v[28:31], a[32:35], a[28:31], v[28:31]
s_waitcnt vmcnt(31)
v_mfma_f32_16x16x32_bf16 v[32:35], a[36:39], a[0:3], v[32:35]
buffer_load_dwordx4 a[156:159], v131, s[8:11], s27 offen offset:3072 sc1
v_mfma_f32_16x16x32_bf16 v[36:39], a[36:39], a[4:7], v[36:39]
v_mfma_f32_16x16x32_bf16 v[40:43], a[36:39], a[8:11], v[40:43]
buffer_load_dwordx4 a[160:163], v131, s[8:11], s28 offen offset:3072 sc1
v_mfma_f32_16x16x32_bf16 v[44:47], a[36:39], a[12:15], v[44:47]
v_mfma_f32_16x16x32_bf16 v[48:51], a[36:39], a[16:19], v[48:51]
buffer_load_dwordx4 a[164:167], v131, s[8:11], s29 offen offset:3072 sc1
v_mfma_f32_16x16x32_bf16 v[52:55], a[36:39], a[20:23], v[52:55]
v_mfma_f32_16x16x32_bf16 v[56:59], a[36:39], a[24:27], v[56:59]
buffer_load_dwordx4 a[168:171], v131, s[8:11], s30 offen offset:3072 sc1
v_mfma_f32_16x16x32_bf16 v[60:63], a[36:39], a[28:31], v[60:63]
s_waitcnt vmcnt(34)
v_mfma_f32_16x16x32_bf16 v[64:67], a[40:43], a[0:3], v[64:67]
buffer_load_dwordx4 a[172:175], v131, s[8:11], s31 offen offset:3072 sc1
v_mfma_f32_16x16x32_bf16 v[68:71], a[40:43], a[4:7], v[68:71]
v_mfma_f32_16x16x32_bf16 v[72:75], a[40:43], a[8:11], v[72:75]
buffer_load_dwordx4 a[180:183], v131, s[8:11], s33 offen offset:3072 sc1
v_mfma_f32_16x16x32_bf16 v[76:79], a[40:43], a[12:15], v[76:79]
v_mfma_f32_16x16x32_bf16 v[80:83], a[40:43], a[16:19], v[80:83]
buffer_load_dwordx4 a[184:187], v131, s[8:11], s34 offen offset:3072 sc1
v_mfma_f32_16x16x32_bf16 v[84:87], a[40:43], a[20:23], v[84:87]
v_mfma_f32_16x16x32_bf16 v[88:91], a[40:43], a[24:27], v[88:91]
buffer_load_dwordx4 a[188:191], v131, s[8:11], s35 offen offset:3072 sc1
v_mfma_f32_16x16x32_bf16 v[92:95], a[40:43], a[28:31], v[92:95]
s_waitcnt vmcnt(37)
v_mfma_f32_16x16x32_bf16 v[96:99], a[44:47], a[0:3], v[96:99]
s_sub_u32 s24, s24, 20480
v_mfma_f32_16x16x32_bf16 v[100:103], a[44:47], a[4:7], v[100:103]
s_sub_u32 s25, s25, 20480
v_mfma_f32_16x16x32_bf16 v[104:107], a[44:47], a[8:11], v[104:107]
s_sub_u32 s26, s26, 20480
v_mfma_f32_16x16x32_bf16 v[108:111], a[44:47], a[12:15], v[108:111]
s_sub_u32 s27, s27, 20480
v_mfma_f32_16x16x32_bf16 v[112:115], a[44:47], a[16:19], v[112:115]
s_sub_u32 s28, s28, 20480
v_mfma_f32_16x16x32_bf16 v[116:119], a[44:47], a[20:23], v[116:119]
s_sub_u32 s29, s29, 20480
v_mfma_f32_16x16x32_bf16 v[120:123], a[44:47], a[24:27], v[120:123]
s_sub_u32 s30, s30, 20480
v_mfma_f32_16x16x32_bf16 v[124:127], a[44:47], a[28:31], v[124:127]
s_sub_u32 s31, s31, 20480
s_sub_u32 s32, s32, 20480
s_sub_u32 s33, s33, 20480
s_sub_u32 s34, s34, 20480
s_sub_u32 s35, s35, 20480
s_waitcnt vmcnt(36)
s_mov_b32 s43, 0x8000
L_f1_chk:
v_cmp_le_u32 vcc, s44, v250
s_sub_u32 s43, s43, 1
s_cmp_eq_u64 vcc, exec
s_cbranch_scc1 L_f1_ok
s_cmp_eq_u32 s43, 0
s_cbranch_scc1 L_f1_ok
s_sleep 4
buffer_load_dword v250, v251, s[8:11], s39 offen offset:4 sc1
s_waitcnt vmcnt(0)
s_branch L_f1_chk
L_f1_ok:
s_waitcnt vmcnt(34)
v_mfma_f32_16x16x32_bf16 v[0:3], a[80:83], a[48:51], v[0:3]
buffer_load_dwordx4 a[32:35], v131, s[8:11], s32 offen offset:0 sc1
s_waitcnt vmcnt(34)
v_mfma_f32_16x16x32_bf16 v[4:7], a[80:83], a[52:55], v[4:7]
s_waitcnt vmcnt(33)
v_mfma_f32_16x16x32_bf16 v[8:11], a[80:83], a[56:59], v[8:11]
buffer_load_dwordx4 a[0:3], v131, s[8:11], s24 offen offset:0 sc1
s_waitcnt vmcnt(33)
v_mfma_f32_16x16x32_bf16 v[12:15], a[80:83], a[60:63], v[12:15]
s_waitcnt vmcnt(32)
v_mfma_f32_16x16x32_bf16 v[16:19], a[80:83], a[64:67], v[16:19]
buffer_load_dwordx4 a[4:7], v131, s[8:11], s25 offen offset:0 sc1
s_waitcnt vmcnt(32)
v_mfma_f32_16x16x32_bf16 v[20:23], a[80:83], a[68:71], v[20:23]
s_waitcnt vmcnt(31)
v_mfma_f32_16x16x32_bf16 v[24:27], a[80:83], a[72:75], v[24:27]
buffer_load_dwordx4 a[8:11], v131, s[8:11], s26 offen offset:0 sc1
s_waitcnt vmcnt(31)
v_mfma_f32_16x16x32_bf16 v[28:31], a[80:83], a[76:79], v[28:31]
s_waitcnt vmcnt(30)
v_mfma_f32_16x16x32_bf16 v[32:35], a[84:87], a[48:51], v[32:35]
buffer_load_dwordx4 a[12:15], v131, s[8:11], s27 offen offset:0 sc1
v_mfma_f32_16x16x32_bf16 v[36:39], a[84:87], a[52:55], v[36:39]
v_mfma_f32_16x16x32_bf16 v[40:43], a[84:87], a[56:59], v[40:43]
buffer_load_dwordx4 a[16:19], v131, s[8:11], s28 offen offset:0 sc1
v_mfma_f32_16x16x32_bf16 v[44:47], a[84:87], a[60:63], v[44:47]
v_mfma_f32_16x16x32_bf16 v[48:51], a[84:87], a[64:67], v[48:51]
buffer_load_dwordx4 a[20:23], v131, s[8:11], s29 offen offset:0 sc1
v_mfma_f32_16x16x32_bf16 v[52:55], a[84:87], a[68:71], v[52:55]
v_mfma_f32_16x16x32_bf16 v[56:59], a[84:87], a[72:75], v[56:59]
buffer_load_dwordx4 a[24:27], v131, s[8:11], s30 offen offset:0 sc1
v_mfma_f32_16x16x32_bf16 v[60:63], a[84:87], a[76:79], v[60:63]
s_waitcnt vmcnt(33)
v_mfma_f32_16x16x32_bf16 v[64:67], a[88:91], a[48:51], v[64:67]
buffer_load_dwordx4 a[28:31], v131, s[8:11], s31 offen offset:0 sc1
v_mfma_f32_16x16x32_bf16 v[68:71], a[88:91], a[52:55], v[68:71]
v_mfma_f32_16x16x32_bf16 v[72:75], a[88:91], a[56:59], v[72:75]
buffer_load_dwordx4 a[36:39], v131, s[8:11], s33 offen offset:0 sc1
v_mfma_f32_16x16x32_bf16 v[76:79], a[88:91], a[60:63], v[76:79]
v_mfma_f32_16x16x32_bf16 v[80:83], a[88:91], a[64:67], v[80:83]
buffer_load_dwordx4 a[40:43], v131, s[8:11], s34 offen offset:0 sc1
v_mfma_f32_16x16x32_bf16 v[84:87], a[88:91], a[68:71], v[84:87]
v_mfma_f32_16x16x32_bf16 v[88:91], a[88:91], a[72:75], v[88:91]
buffer_load_dwordx4 a[44:47], v131, s[8:11], s35 offen offset:0 sc1
v_mfma_f32_16x16x32_bf16 v[92:95], a[88:91], a[76:79], v[92:95]
s_waitcnt vmcnt(36)
v_mfma_f32_16x16x32_bf16 v[96:99], a[92:95], a[48:51], v[96:99]
v_mfma_f32_16x16x32_bf16 v[100:103], a[92:95], a[52:55], v[100:103]
v_mfma_f32_16x16x32_bf16 v[104:107], a[92:95], a[56:59], v[104:107]
v_mfma_f32_16x16x32_bf16 v[108:111], a[92:95], a[60:63], v[108:111]
v_mfma_f32_16x16x32_bf16 v[112:115], a[92:95], a[64:67], v[112:115]
v_mfma_f32_16x16x32_bf16 v[116:119], a[92:95], a[68:71], v[116:119]
v_mfma_f32_16x16x32_bf16 v[120:123], a[92:95], a[72:75], v[120:123]
v_mfma_f32_16x16x32_bf16 v[124:127], a[92:95], a[76:79], v[124:127]
s_waitcnt vmcnt(34)
v_mfma_f32_16x16x32_bf16 v[0:3], a[128:131], a[96:99], v[0:3]
buffer_load_dwordx4 a[80:83], v131, s[8:11], s32 offen offset:1024 sc1
s_waitcnt vmcnt(34)
v_mfma_f32_16x16x32_bf16 v[4:7], a[128:131], a[100:103], v[4:7]
s_waitcnt vmcnt(33)
v_mfma_f32_16x16x32_bf16 v[8:11], a[128:131], a[104:107], v[8:11]
buffer_load_dwordx4 a[48:51], v131, s[8:11], s24 offen offset:1024 sc1
s_waitcnt vmcnt(33)
v_mfma_f32_16x16x32_bf16 v[12:15], a[128:131], a[108:111], v[12:15]
s_waitcnt vmcnt(32)
v_mfma_f32_16x16x32_bf16 v[16:19], a[128:131], a[112:115], v[16:19]
buffer_load_dwordx4 a[52:55], v131, s[8:11], s25 offen offset:1024 sc1
s_waitcnt vmcnt(32)
v_mfma_f32_16x16x32_bf16 v[20:23], a[128:131], a[116:119], v[20:23]
s_waitcnt vmcnt(31)
v_mfma_f32_16x16x32_bf16 v[24:27], a[128:131], a[120:123], v[24:27]
buffer_load_dwordx4 a[56:59], v131, s[8:11], s26 offen offset:1024 sc1
s_waitcnt vmcnt(31)
v_mfma_f32_16x16x32_bf16 v[28:31], a[128:131], a[124:127], v[28:31]
s_waitcnt vmcnt(30)
v_mfma_f32_16x16x32_bf16 v[32:35], a[132:135], a[96:99], v[32:35]
buffer_load_dwordx4 a[60:63], v131, s[8:11], s27 offen offset:1024 sc1
v_mfma_f32_16x16x32_bf16 v[36:39], a[132:135], a[100:103], v[36:39]
v_mfma_f32_16x16x32_bf16 v[40:43], a[132:135], a[104:107], v[40:43]
buffer_load_dwordx4 a[64:67], v131, s[8:11], s28 offen offset:1024 sc1
v_mfma_f32_16x16x32_bf16 v[44:47], a[132:135], a[108:111], v[44:47]
v_mfma_f32_16x16x32_bf16 v[48:51], a[132:135], a[112:115], v[48:51]
buffer_load_dwordx4 a[68:71], v131, s[8:11], s29 offen offset:1024 sc1
v_mfma_f32_16x16x32_bf16 v[52:55], a[132:135], a[116:119], v[52:55]
v_mfma_f32_16x16x32_bf16 v[56:59], a[132:135], a[120:123], v[56:59]
buffer_load_dwordx4 a[72:75], v131, s[8:11], s30 offen offset:1024 sc1
v_mfma_f32_16x16x32_bf16 v[60:63], a[132:135], a[124:127], v[60:63]
s_waitcnt vmcnt(33)
v_mfma_f32_16x16x32_bf16 v[64:67], a[136:139], a[96:99], v[64:67]
buffer_load_dwordx4 a[76:79], v131, s[8:11], s31 offen offset:1024 sc1
v_mfma_f32_16x16x32_bf16 v[68:71], a[136:139], a[100:103], v[68:71]
v_mfma_f32_16x16x32_bf16 v[72:75], a[136:139], a[104:107], v[72:75]
buffer_load_dwordx4 a[84:87], v131, s[8:11], s33 offen offset:1024 sc1
v_mfma_f32_16x16x32_bf16 v[76:79], a[136:139], a[108:111], v[76:79]
v_mfma_f32_16x16x32_bf16 v[80:83], a[136:139], a[112:115], v[80:83]
buffer_load_dwordx4 a[88:91], v131, s[8:11], s34 offen offset:1024 sc1
v_mfma_f32_16x16x32_bf16 v[84:87], a[136:139], a[116:119], v[84:87]
v_mfma_f32_16x16x32_bf16 v[88:91], a[136:139], a[120:123], v[88:91]
buffer_load_dwordx4 a[92:95], v131, s[8:11], s35 offen offset:1024 sc1
v_mfma_f32_16x16x32_bf16 v[92:95], a[136:139], a[124:127], v[92:95]
s_waitcnt vmcnt(36)
v_mfma_f32_16x16x32_bf16 v[96:99], a[140:143], a[96:99], v[96:99]
v_mfma_f32_16x16x32_bf16 v[100:103], a[140:143], a[100:103], v[100:103]
v_mfma_f32_16x16x32_bf16 v[104:107], a[140:143], a[104:107], v[104:107]
v_mfma_f32_16x16x32_bf16 v[108:111], a[140:143], a[108:111], v[108:111]
v_mfma_f32_16x16x32_bf16 v[112:115], a[140:143], a[112:115], v[112:115]
v_mfma_f32_16x16x32_bf16 v[116:119], a[140:143], a[116:119], v[116:119]
v_mfma_f32_16x16x32_bf16 v[120:123], a[140:143], a[120:123], v[120:123]
v_mfma_f32_16x16x32_bf16 v[124:127], a[140:143], a[124:127], v[124:127]
s_waitcnt vmcnt(34)
v_mfma_f32_16x16x32_bf16 v[0:3], a[176:179], a[144:147], v[0:3]
buffer_load_dwordx4 a[128:131], v131, s[8:11], s32 offen offset:2048 sc1
s_waitcnt vmcnt(34)
v_mfma_f32_16x16x32_bf16 v[4:7], a[176:179], a[148:151], v[4:7]
s_waitcnt vmcnt(33)
v_mfma_f32_16x16x32_bf16 v[8:11], a[176:179], a[152:155], v[8:11]
buffer_load_dwordx4 a[96:99], v131, s[8:11], s24 offen offset:2048 sc1
s_waitcnt vmcnt(33)
v_mfma_f32_16x16x32_bf16 v[12:15], a[176:179], a[156:159], v[12:15]
s_waitcnt vmcnt(32)
v_mfma_f32_16x16x32_bf16 v[16:19], a[176:179], a[160:163], v[16:19]
buffer_load_dwordx4 a[100:103], v131, s[8:11], s25 offen offset:2048 sc1
s_waitcnt vmcnt(32)
v_mfma_f32_16x16x32_bf16 v[20:23], a[176:179], a[164:167], v[20:23]
s_waitcnt vmcnt(31)
v_mfma_f32_16x16x32_bf16 v[24:27], a[176:179], a[168:171], v[24:27]
buffer_load_dwordx4 a[104:107], v131, s[8:11], s26 offen offset:2048 sc1
s_waitcnt vmcnt(31)
v_mfma_f32_16x16x32_bf16 v[28:31], a[176:179], a[172:175], v[28:31]
s_waitcnt vmcnt(30)
v_mfma_f32_16x16x32_bf16 v[32:35], a[180:183], a[144:147], v[32:35]
buffer_load_dwordx4 a[108:111], v131, s[8:11], s27 offen offset:2048 sc1
v_mfma_f32_16x16x32_bf16 v[36:39], a[180:183], a[148:151], v[36:39]
v_mfma_f32_16x16x32_bf16 v[40:43], a[180:183], a[152:155], v[40:43]
buffer_load_dwordx4 a[112:115], v131, s[8:11], s28 offen offset:2048 sc1
v_mfma_f32_16x16x32_bf16 v[44:47], a[180:183], a[156:159], v[44:47]
v_mfma_f32_16x16x32_bf16 v[48:51], a[180:183], a[160:163], v[48:51]
buffer_load_dwordx4 a[116:119], v131, s[8:11], s29 offen offset:2048 sc1
v_mfma_f32_16x16x32_bf16 v[52:55], a[180:183], a[164:167], v[52:55]
v_mfma_f32_16x16x32_bf16 v[56:59], a[180:183], a[168:171], v[56:59]
buffer_load_dwordx4 a[120:123], v131, s[8:11], s30 offen offset:2048 sc1
v_mfma_f32_16x16x32_bf16 v[60:63], a[180:183], a[172:175], v[60:63]
s_waitcnt vmcnt(33)
v_mfma_f32_16x16x32_bf16 v[64:67], a[184:187], a[144:147], v[64:67]
buffer_load_dwordx4 a[124:127], v131, s[8:11], s31 offen offset:2048 sc1
v_mfma_f32_16x16x32_bf16 v[68:71], a[184:187], a[148:151], v[68:71]
v_mfma_f32_16x16x32_bf16 v[72:75], a[184:187], a[152:155], v[72:75]
buffer_load_dwordx4 a[132:135], v131, s[8:11], s33 offen offset:2048 sc1
v_mfma_f32_16x16x32_bf16 v[76:79], a[184:187], a[156:159], v[76:79]
v_mfma_f32_16x16x32_bf16 v[80:83], a[184:187], a[160:163], v[80:83]
buffer_load_dwordx4 a[136:139], v131, s[8:11], s34 offen offset:2048 sc1
v_mfma_f32_16x16x32_bf16 v[84:87], a[184:187], a[164:167], v[84:87]
v_mfma_f32_16x16x32_bf16 v[88:91], a[184:187], a[168:171], v[88:91]
buffer_load_dwordx4 a[140:143], v131, s[8:11], s35 offen offset:2048 sc1
v_mfma_f32_16x16x32_bf16 v[92:95], a[184:187], a[172:175], v[92:95]
s_waitcnt vmcnt(36)
v_mfma_f32_16x16x32_bf16 v[96:99], a[188:191], a[144:147], v[96:99]
v_mfma_f32_16x16x32_bf16 v[100:103], a[188:191], a[148:151], v[100:103]
v_mfma_f32_16x16x32_bf16 v[104:107], a[188:191], a[152:155], v[104:107]
v_mfma_f32_16x16x32_bf16 v[108:111], a[188:191], a[156:159], v[108:111]
v_mfma_f32_16x16x32_bf16 v[112:115], a[188:191], a[160:163], v[112:115]
v_mfma_f32_16x16x32_bf16 v[116:119], a[188:191], a[164:167], v[116:119]
v_mfma_f32_16x16x32_bf16 v[120:123], a[188:191], a[168:171], v[120:123]
v_mfma_f32_16x16x32_bf16 v[124:127], a[188:191], a[172:175], v[124:127]
s_mov_b32 s40, 3
L_loop3:
s_waitcnt vmcnt(34)
v_mfma_f32_16x16x32_bf16 v[0:3], a[32:35], a[0:3], v[0:3]
buffer_load_dwordx4 a[176:179], v131, s[8:11], s32 offen offset:3072 sc1
s_waitcnt vmcnt(34)
v_mfma_f32_16x16x32_bf16 v[4:7], a[32:35], a[4:7], v[4:7]
s_waitcnt vmcnt(33)
v_mfma_f32_16x16x32_bf16 v[8:11], a[32:35], a[8:11], v[8:11]
buffer_load_dwordx4 a[144:147], v131, s[8:11], s24 offen offset:3072 sc1
s_waitcnt vmcnt(33)
v_mfma_f32_16x16x32_bf16 v[12:15], a[32:35], a[12:15], v[12:15]
s_waitcnt vmcnt(32)
v_mfma_f32_16x16x32_bf16 v[16:19], a[32:35], a[16:19], v[16:19]
buffer_load_dwordx4 a[148:151], v131, s[8:11], s25 offen offset:3072 sc1
s_waitcnt vmcnt(32)
v_mfma_f32_16x16x32_bf16 v[20:23], a[32:35], a[20:23], v[20:23]
s_waitcnt vmcnt(31)
v_mfma_f32_16x16x32_bf16 v[24:27], a[32:35], a[24:27], v[24:27]
buffer_load_dwordx4 a[152:155], v131, s[8:11], s26 offen offset:3072 sc1
s_waitcnt vmcnt(31)
v_mfma_f32_16x16x32_bf16 v[28:31], a[32:35], a[28:31], v[28:31]
s_waitcnt vmcnt(30)
v_mfma_f32_16x16x32_bf16 v[32:35], a[36:39], a[0:3], v[32:35]
buffer_load_dwordx4 a[156:159], v131, s[8:11], s27 offen offset:3072 sc1
v_mfma_f32_16x16x32_bf16 v[36:39], a[36:39], a[4:7], v[36:39]
v_mfma_f32_16x16x32_bf16 v[40:43], a[36:39], a[8:11], v[40:43]
buffer_load_dwordx4 a[160:163], v131, s[8:11], s28 offen offset:3072 sc1
v_mfma_f32_16x16x32_bf16 v[44:47], a[36:39], a[12:15], v[44:47]
v_mfma_f32_16x16x32_bf16 v[48:51], a[36:39], a[16:19], v[48:51]
buffer_load_dwordx4 a[164:167], v131, s[8:11], s29 offen offset:3072 sc1
v_mfma_f32_16x16x32_bf16 v[52:55], a[36:39], a[20:23], v[52:55]
v_mfma_f32_16x16x32_bf16 v[56:59], a[36:39], a[24:27], v[56:59]
buffer_load_dwordx4 a[168:171], v131, s[8:11], s30 offen offset:3072 sc1
v_mfma_f32_16x16x32_bf16 v[60:63], a[36:39], a[28:31], v[60:63]
s_waitcnt vmcnt(33)
v_mfma_f32_16x16x32_bf16 v[64:67], a[40:43], a[0:3], v[64:67]
buffer_load_dwordx4 a[172:175], v131, s[8:11], s31 offen offset:3072 sc1
v_mfma_f32_16x16x32_bf16 v[68:71], a[40:43], a[4:7], v[68:71]
v_mfma_f32_16x16x32_bf16 v[72:75], a[40:43], a[8:11], v[72:75]
buffer_load_dwordx4 a[180:183], v131, s[8:11], s33 offen offset:3072 sc1
v_mfma_f32_16x16x32_bf16 v[76:79], a[40:43], a[12:15], v[76:79]
v_mfma_f32_16x16x32_bf16 v[80:83], a[40:43], a[16:19], v[80:83]
buffer_load_dwordx4 a[184:187], v131, s[8:11], s34 offen offset:3072 sc1
v_mfma_f32_16x16x32_bf16 v[84:87], a[40:43], a[20:23], v[84:87]
v_mfma_f32_16x16x32_bf16 v[88:91], a[40:43], a[24:27], v[88:91]
buffer_load_dwordx4 a[188:191], v131, s[8:11], s35 offen offset:3072 sc1
v_mfma_f32_16x16x32_bf16 v[92:95], a[40:43], a[28:31], v[92:95]
s_waitcnt vmcnt(36)
v_mfma_f32_16x16x32_bf16 v[96:99], a[44:47], a[0:3], v[96:99]
s_add_u32 s24, s24, 8192
v_mfma_f32_16x16x32_bf16 v[100:103], a[44:47], a[4:7], v[100:103]
s_add_u32 s25, s25, 8192
v_mfma_f32_16x16x32_bf16 v[104:107], a[44:47], a[8:11], v[104:107]
s_add_u32 s26, s26, 8192
v_mfma_f32_16x16x32_bf16 v[108:111], a[44:47], a[12:15], v[108:111]
s_add_u32 s27, s27, 8192
v_mfma_f32_16x16x32_bf16 v[112:115], a[44:47], a[16:19], v[112:115]
s_add_u32 s28, s28, 8192
v_mfma_f32_16x16x32_bf16 v[116:119], a[44:47], a[20:23], v[116:119]
s_add_u32 s29, s29, 8192
v_mfma_f32_16x16x32_bf16 v[120:123], a[44:47], a[24:27], v[120:123]
s_add_u32 s30, s30, 8192
v_mfma_f32_16x16x32_bf16 v[124:127], a[44:47], a[28:31], v[124:127]
s_add_u32 s31, s31, 8192
s_add_u32 s32, s32, 8192
s_add_u32 s33, s33, 8192
s_add_u32 s34, s34, 8192
s_add_u32 s35, s35, 8192
s_waitcnt vmcnt(34)
v_mfma_f32_16x16x32_bf16 v[0:3], a[80:83], a[48:51], v[0:3]
buffer_load_dwordx4 a[32:35], v131, s[8:11], s32 offen offset:0 sc1
s_waitcnt vmcnt(34)
v_mfma_f32_16x16x32_bf16 v[4:7], a[80:83], a[52:55], v[4:7]
s_waitcnt vmcnt(33)
v_mfma_f32_16x16x32_bf16 v[8:11], a[80:83], a[56:59], v[8:11]
buffer_load_dwordx4 a[0:3], v131, s[8:11], s24 offen offset:0 sc1
s_waitcnt vmcnt(33)
v_mfma_f32_16x16x32_bf16 v[12:15], a[80:83], a[60:63], v[12:15]
s_waitcnt vmcnt(32)
v_mfma_f32_16x16x32_bf16 v[16:19], a[80:83], a[64:67], v[16:19]
buffer_load_dwordx4 a[4:7], v131, s[8:11], s25 offen offset:0 sc1
s_waitcnt vmcnt(32)
v_mfma_f32_16x16x32_bf16 v[20:23], a[80:83], a[68:71], v[20:23]
s_waitcnt vmcnt(31)
v_mfma_f32_16x16x32_bf16 v[24:27], a[80:83], a[72:75], v[24:27]
buffer_load_dwordx4 a[8:11], v131, s[8:11], s26 offen offset:0 sc1
s_waitcnt vmcnt(31)
v_mfma_f32_16x16x32_bf16 v[28:31], a[80:83], a[76:79], v[28:31]
s_waitcnt vmcnt(30)
v_mfma_f32_16x16x32_bf16 v[32:35], a[84:87], a[48:51], v[32:35]
buffer_load_dwordx4 a[12:15], v131, s[8:11], s27 offen offset:0 sc1
v_mfma_f32_16x16x32_bf16 v[36:39], a[84:87], a[52:55], v[36:39]
v_mfma_f32_16x16x32_bf16 v[40:43], a[84:87], a[56:59], v[40:43]
buffer_load_dwordx4 a[16:19], v131, s[8:11], s28 offen offset:0 sc1
v_mfma_f32_16x16x32_bf16 v[44:47], a[84:87], a[60:63], v[44:47]
v_mfma_f32_16x16x32_bf16 v[48:51], a[84:87], a[64:67], v[48:51]
buffer_load_dwordx4 a[20:23], v131, s[8:11], s29 offen offset:0 sc1
v_mfma_f32_16x16x32_bf16 v[52:55], a[84:87], a[68:71], v[52:55]
v_mfma_f32_16x16x32_bf16 v[56:59], a[84:87], a[72:75], v[56:59]
buffer_load_dwordx4 a[24:27], v131, s[8:11], s30 offen offset:0 sc1
v_mfma_f32_16x16x32_bf16 v[60:63], a[84:87], a[76:79], v[60:63]
s_waitcnt vmcnt(33)
v_mfma_f32_16x16x32_bf16 v[64:67], a[88:91], a[48:51], v[64:67]
buffer_load_dwordx4 a[28:31], v131, s[8:11], s31 offen offset:0 sc1
v_mfma_f32_16x16x32_bf16 v[68:71], a[88:91], a[52:55], v[68:71]
v_mfma_f32_16x16x32_bf16 v[72:75], a[88:91], a[56:59], v[72:75]
buffer_load_dwordx4 a[36:39], v131, s[8:11], s33 offen offset:0 sc1
v_mfma_f32_16x16x32_bf16 v[76:79], a[88:91], a[60:63], v[76:79]
v_mfma_f32_16x16x32_bf16 v[80:83], a[88:91], a[64:67], v[80:83]
buffer_load_dwordx4 a[40:43], v131, s[8:11], s34 offen offset:0 sc1
v_mfma_f32_16x16x32_bf16 v[84:87], a[88:91], a[68:71], v[84:87]
v_mfma_f32_16x16x32_bf16 v[88:91], a[88:91], a[72:75], v[88:91]
buffer_load_dwordx4 a[44:47], v131, s[8:11], s35 offen offset:0 sc1
v_mfma_f32_16x16x32_bf16 v[92:95], a[88:91], a[76:79], v[92:95]
s_waitcnt vmcnt(36)
v_mfma_f32_16x16x32_bf16 v[96:99], a[92:95], a[48:51], v[96:99]
v_mfma_f32_16x16x32_bf16 v[100:103], a[92:95], a[52:55], v[100:103]
v_mfma_f32_16x16x32_bf16 v[104:107], a[92:95], a[56:59], v[104:107]
v_mfma_f32_16x16x32_bf16 v[108:111], a[92:95], a[60:63], v[108:111]
v_mfma_f32_16x16x32_bf16 v[112:115], a[92:95], a[64:67], v[112:115]
v_mfma_f32_16x16x32_bf16 v[116:119], a[92:95], a[68:71], v[116:119]
v_mfma_f32_16x16x32_bf16 v[120:123], a[92:95], a[72:75], v[120:123]
v_mfma_f32_16x16x32_bf16 v[124:127], a[92:95], a[76:79], v[124:127]
s_waitcnt vmcnt(34)
v_mfma_f32_16x16x32_bf16 v[0:3], a[128:131], a[96:99], v[0:3]
buffer_load_dwordx4 a[80:83], v131, s[8:11], s32 offen offset:1024 sc1
s_waitcnt vmcnt(34)
v_mfma_f32_16x16x32_bf16 v[4:7], a[128:131], a[100:103], v[4:7]
s_waitcnt vmcnt(33)
v_mfma_f32_16x16x32_bf16 v[8:11], a[128:131], a[104:107], v[8:11]
buffer_load_dwordx4 a[48:51], v131, s[8:11], s24 offen offset:1024 sc1
s_waitcnt vmcnt(33)
v_mfma_f32_16x16x32_bf16 v[12:15], a[128:131], a[108:111], v[12:15]
s_waitcnt vmcnt(32)
v_mfma_f32_16x16x32_bf16 v[16:19], a[128:131], a[112:115], v[16:19]
buffer_load_dwordx4 a[52:55], v131, s[8:11], s25 offen offset:1024 sc1
s_waitcnt vmcnt(32)
v_mfma_f32_16x16x32_bf16 v[20:23], a[128:131], a[116:119], v[20:23]
s_waitcnt vmcnt(31)
v_mfma_f32_16x16x32_bf16 v[24:27], a[128:131], a[120:123], v[24:27]
buffer_load_dwordx4 a[56:59], v131, s[8:11], s26 offen offset:1024 sc1
s_waitcnt vmcnt(31)
v_mfma_f32_16x16x32_bf16 v[28:31], a[128:131], a[124:127], v[28:31]
s_waitcnt vmcnt(30)
v_mfma_f32_16x16x32_bf16 v[32:35], a[132:135], a[96:99], v[32:35]
buffer_load_dwordx4 a[60:63], v131, s[8:11], s27 offen offset:1024 sc1
v_mfma_f32_16x16x32_bf16 v[36:39], a[132:135], a[100:103], v[36:39]
v_mfma_f32_16x16x32_bf16 v[40:43], a[132:135], a[104:107], v[40:43]
buffer_load_dwordx4 a[64:67], v131, s[8:11], s28 offen offset:1024 sc1
v_mfma_f32_16x16x32_bf16 v[44:47], a[132:135], a[108:111], v[44:47]
v_mfma_f32_16x16x32_bf16 v[48:51], a[132:135], a[112:115], v[48:51]
buffer_load_dwordx4 a[68:71], v131, s[8:11], s29 offen offset:1024 sc1
v_mfma_f32_16x16x32_bf16 v[52:55], a[132:135], a[116:119], v[52:55]
v_mfma_f32_16x16x32_bf16 v[56:59], a[132:135], a[120:123], v[56:59]
buffer_load_dwordx4 a[72:75], v131, s[8:11], s30 offen offset:1024 sc1
v_mfma_f32_16x16x32_bf16 v[60:63], a[132:135], a[124:127], v[60:63]
s_waitcnt vmcnt(33)
v_mfma_f32_16x16x32_bf16 v[64:67], a[136:139], a[96:99], v[64:67]
buffer_load_dwordx4 a[76:79], v131, s[8:11], s31 offen offset:1024 sc1
v_mfma_f32_16x16x32_bf16 v[68:71], a[136:139], a[100:103], v[68:71]
v_mfma_f32_16x16x32_bf16 v[72:75], a[136:139], a[104:107], v[72:75]
buffer_load_dwordx4 a[84:87], v131, s[8:11], s33 offen offset:1024 sc1
v_mfma_f32_16x16x32_bf16 v[76:79], a[136:139], a[108:111], v[76:79]
v_mfma_f32_16x16x32_bf16 v[80:83], a[136:139], a[112:115], v[80:83]
buffer_load_dwordx4 a[88:91], v131, s[8:11], s34 offen offset:1024 sc1
v_mfma_f32_16x16x32_bf16 v[84:87], a[136:139], a[116:119], v[84:87]
v_mfma_f32_16x16x32_bf16 v[88:91], a[136:139], a[120:123], v[88:91]
buffer_load_dwordx4 a[92:95], v131, s[8:11], s35 offen offset:1024 sc1
v_mfma_f32_16x16x32_bf16 v[92:95], a[136:139], a[124:127], v[92:95]
s_waitcnt vmcnt(36)
v_mfma_f32_16x16x32_bf16 v[96:99], a[140:143], a[96:99], v[96:99]
v_mfma_f32_16x16x32_bf16 v[100:103], a[140:143], a[100:103], v[100:103]
v_mfma_f32_16x16x32_bf16 v[104:107], a[140:143], a[104:107], v[104:107]
v_mfma_f32_16x16x32_bf16 v[108:111], a[140:143], a[108:111], v[108:111]
v_mfma_f32_16x16x32_bf16 v[112:115], a[140:143], a[112:115], v[112:115]
v_mfma_f32_16x16x32_bf16 v[116:119], a[140:143], a[116:119], v[116:119]
v_mfma_f32_16x16x32_bf16 v[120:123], a[140:143], a[120:123], v[120:123]
v_mfma_f32_16x16x32_bf16 v[124:127], a[140:143], a[124:127], v[124:127]
s_waitcnt vmcnt(34)
v_mfma_f32_16x16x32_bf16 v[0:3], a[176:179], a[144:147], v[0:3]
buffer_load_dwordx4 a[128:131], v131, s[8:11], s32 offen offset:2048 sc1
s_waitcnt vmcnt(34)
v_mfma_f32_16x16x32_bf16 v[4:7], a[176:179], a[148:151], v[4:7]
s_waitcnt vmcnt(33)
v_mfma_f32_16x16x32_bf16 v[8:11], a[176:179], a[152:155], v[8:11]
buffer_load_dwordx4 a[96:99], v131, s[8:11], s24 offen offset:2048 sc1
s_waitcnt vmcnt(33)
v_mfma_f32_16x16x32_bf16 v[12:15], a[176:179], a[156:159], v[12:15]
s_waitcnt vmcnt(32)
v_mfma_f32_16x16x32_bf16 v[16:19], a[176:179], a[160:163], v[16:19]
buffer_load_dwordx4 a[100:103], v131, s[8:11], s25 offen offset:2048 sc1
s_waitcnt vmcnt(32)
v_mfma_f32_16x16x32_bf16 v[20:23], a[176:179], a[164:167], v[20:23]
s_waitcnt vmcnt(31)
v_mfma_f32_16x16x32_bf16 v[24:27], a[176:179], a[168:171], v[24:27]
buffer_load_dwordx4 a[104:107], v131, s[8:11], s26 offen offset:2048 sc1
s_waitcnt vmcnt(31)
v_mfma_f32_16x16x32_bf16 v[28:31], a[176:179], a[172:175], v[28:31]
s_waitcnt vmcnt(30)
v_mfma_f32_16x16x32_bf16 v[32:35], a[180:183], a[144:147], v[32:35]
buffer_load_dwordx4 a[108:111], v131, s[8:11], s27 offen offset:2048 sc1
v_mfma_f32_16x16x32_bf16 v[36:39], a[180:183], a[148:151], v[36:39]
v_mfma_f32_16x16x32_bf16 v[40:43], a[180:183], a[152:155], v[40:43]
buffer_load_dwordx4 a[112:115], v131, s[8:11], s28 offen offset:2048 sc1
v_mfma_f32_16x16x32_bf16 v[44:47], a[180:183], a[156:159], v[44:47]
v_mfma_f32_16x16x32_bf16 v[48:51], a[180:183], a[160:163], v[48:51]
buffer_load_dwordx4 a[116:119], v131, s[8:11], s29 offen offset:2048 sc1
v_mfma_f32_16x16x32_bf16 v[52:55], a[180:183], a[164:167], v[52:55]
v_mfma_f32_16x16x32_bf16 v[56:59], a[180:183], a[168:171], v[56:59]
buffer_load_dwordx4 a[120:123], v131, s[8:11], s30 offen offset:2048 sc1
v_mfma_f32_16x16x32_bf16 v[60:63], a[180:183], a[172:175], v[60:63]
s_waitcnt vmcnt(33)
v_mfma_f32_16x16x32_bf16 v[64:67], a[184:187], a[144:147], v[64:67]
buffer_load_dwordx4 a[124:127], v131, s[8:11], s31 offen offset:2048 sc1
v_mfma_f32_16x16x32_bf16 v[68:71], a[184:187], a[148:151], v[68:71]
v_mfma_f32_16x16x32_bf16 v[72:75], a[184:187], a[152:155], v[72:75]
buffer_load_dwordx4 a[132:135], v131, s[8:11], s33 offen offset:2048 sc1
v_mfma_f32_16x16x32_bf16 v[76:79], a[184:187], a[156:159], v[76:79]
v_mfma_f32_16x16x32_bf16 v[80:83], a[184:187], a[160:163], v[80:83]
buffer_load_dwordx4 a[136:139], v131, s[8:11], s34 offen offset:2048 sc1
v_mfma_f32_16x16x32_bf16 v[84:87], a[184:187], a[164:167], v[84:87]
v_mfma_f32_16x16x32_bf16 v[88:91], a[184:187], a[168:171], v[88:91]
buffer_load_dwordx4 a[140:143], v131, s[8:11], s35 offen offset:2048 sc1
v_mfma_f32_16x16x32_bf16 v[92:95], a[184:187], a[172:175], v[92:95]
s_waitcnt vmcnt(36)
v_mfma_f32_16x16x32_bf16 v[96:99], a[188:191], a[144:147], v[96:99]
v_mfma_f32_16x16x32_bf16 v[100:103], a[188:191], a[148:151], v[100:103]
v_mfma_f32_16x16x32_bf16 v[104:107], a[188:191], a[152:155], v[104:107]
v_mfma_f32_16x16x32_bf16 v[108:111], a[188:191], a[156:159], v[108:111]
v_mfma_f32_16x16x32_bf16 v[112:115], a[188:191], a[160:163], v[112:115]
v_mfma_f32_16x16x32_bf16 v[116:119], a[188:191], a[164:167], v[116:119]
v_mfma_f32_16x16x32_bf16 v[120:123], a[188:191], a[168:171], v[120:123]
v_mfma_f32_16x16x32_bf16 v[124:127], a[188:191], a[172:175], v[124:127]
s_sub_u32 s40, s40, 1
s_cmp_lg_u32 s40, 0
s_cbranch_scc1 L_loop3
s_waitcnt vmcnt(34)
v_mfma_f32_16x16x32_bf16 v[0:3], a[32:35], a[0:3], v[0:3]
buffer_load_dwordx4 a[176:179], v131, s[8:11], s32 offen offset:3072 sc1
s_waitcnt vmcnt(34)
v_mfma_f32_16x16x32_bf16 v[4:7], a[32:35], a[4:7], v[4:7]
s_waitcnt vmcnt(33)
v_mfma_f32_16x16x32_bf16 v[8:11], a[32:35], a[8:11], v[8:11]
buffer_load_dwordx4 a[144:147], v131, s[8:11], s24 offen offset:3072 sc1
s_waitcnt vmcnt(33)
v_mfma_f32_16x16x32_bf16 v[12:15], a[32:35], a[12:15], v[12:15]
s_waitcnt vmcnt(32)
v_mfma_f32_16x16x32_bf16 v[16:19], a[32:35], a[16:19], v[16:19]
buffer_load_dwordx4 a[148:151], v131, s[8:11], s25 offen offset:3072 sc1
s_waitcnt vmcnt(32)
v_mfma_f32_16x16x32_bf16 v[20:23], a[32:35], a[20:23], v[20:23]
s_waitcnt vmcnt(31)
v_mfma_f32_16x16x32_bf16 v[24:27], a[32:35], a[24:27], v[24:27]
buffer_load_dwordx4 a[152:155], v131, s[8:11], s26 offen offset:3072 sc1
s_waitcnt vmcnt(31)
v_mfma_f32_16x16x32_bf16 v[28:31], a[32:35], a[28:31], v[28:31]
s_waitcnt vmcnt(30)
v_mfma_f32_16x16x32_bf16 v[32:35], a[36:39], a[0:3], v[32:35]
buffer_load_dwordx4 a[156:159], v131, s[8:11], s27 offen offset:3072 sc1
v_mfma_f32_16x16x32_bf16 v[36:39], a[36:39], a[4:7], v[36:39]
v_mfma_f32_16x16x32_bf16 v[40:43], a[36:39], a[8:11], v[40:43]
buffer_load_dwordx4 a[160:163], v131, s[8:11], s28 offen offset:3072 sc1
v_mfma_f32_16x16x32_bf16 v[44:47], a[36:39], a[12:15], v[44:47]
v_mfma_f32_16x16x32_bf16 v[48:51], a[36:39], a[16:19], v[48:51]
buffer_load_dwordx4 a[164:167], v131, s[8:11], s29 offen offset:3072 sc1
v_mfma_f32_16x16x32_bf16 v[52:55], a[36:39], a[20:23], v[52:55]
v_mfma_f32_16x16x32_bf16 v[56:59], a[36:39], a[24:27], v[56:59]
buffer_load_dwordx4 a[168:171], v131, s[8:11], s30 offen offset:3072 sc1
v_mfma_f32_16x16x32_bf16 v[60:63], a[36:39], a[28:31], v[60:63]
s_waitcnt vmcnt(33)
v_mfma_f32_16x16x32_bf16 v[64:67], a[40:43], a[0:3], v[64:67]
buffer_load_dwordx4 a[172:175], v131, s[8:11], s31 offen offset:3072 sc1
v_mfma_f32_16x16x32_bf16 v[68:71], a[40:43], a[4:7], v[68:71]
v_mfma_f32_16x16x32_bf16 v[72:75], a[40:43], a[8:11], v[72:75]
buffer_load_dwordx4 a[180:183], v131, s[8:11], s33 offen offset:3072 sc1
v_mfma_f32_16x16x32_bf16 v[76:79], a[40:43], a[12:15], v[76:79]
v_mfma_f32_16x16x32_bf16 v[80:83], a[40:43], a[16:19], v[80:83]
buffer_load_dwordx4 a[184:187], v131, s[8:11], s34 offen offset:3072 sc1
v_mfma_f32_16x16x32_bf16 v[84:87], a[40:43], a[20:23], v[84:87]
v_mfma_f32_16x16x32_bf16 v[88:91], a[40:43], a[24:27], v[88:91]
buffer_load_dwordx4 a[188:191], v131, s[8:11], s35 offen offset:3072 sc1
v_mfma_f32_16x16x32_bf16 v[92:95], a[40:43], a[28:31], v[92:95]
s_waitcnt vmcnt(36)
v_mfma_f32_16x16x32_bf16 v[96:99], a[44:47], a[0:3], v[96:99]
s_add_u32 s24, s24, 8192
v_mfma_f32_16x16x32_bf16 v[100:103], a[44:47], a[4:7], v[100:103]
s_add_u32 s25, s25, 8192
v_mfma_f32_16x16x32_bf16 v[104:107], a[44:47], a[8:11], v[104:107]
s_add_u32 s26, s26, 8192
v_mfma_f32_16x16x32_bf16 v[108:111], a[44:47], a[12:15], v[108:111]
s_add_u32 s27, s27, 8192
v_mfma_f32_16x16x32_bf16 v[112:115], a[44:47], a[16:19], v[112:115]
s_add_u32 s28, s28, 8192
v_mfma_f32_16x16x32_bf16 v[116:119], a[44:47], a[20:23], v[116:119]
s_add_u32 s29, s29, 8192
v_mfma_f32_16x16x32_bf16 v[120:123], a[44:47], a[24:27], v[120:123]
s_add_u32 s30, s30, 8192
v_mfma_f32_16x16x32_bf16 v[124:127], a[44:47], a[28:31], v[124:127]
s_add_u32 s31, s31, 8192
s_add_u32 s32, s32, 8192
s_add_u32 s33, s33, 8192
s_add_u32 s34, s34, 8192
s_add_u32 s35, s35, 8192
s_waitcnt vmcnt(34)
v_mfma_f32_16x16x32_bf16 v[0:3], a[80:83], a[48:51], v[0:3]
s_waitcnt vmcnt(33)
v_mfma_f32_16x16x32_bf16 v[4:7], a[80:83], a[52:55], v[4:7]
s_waitcnt vmcnt(32)
v_mfma_f32_16x16x32_bf16 v[8:11], a[80:83], a[56:59], v[8:11]
s_waitcnt vmcnt(31)
v_mfma_f32_16x16x32_bf16 v[12:15], a[80:83], a[60:63], v[12:15]
s_waitcnt vmcnt(30)
v_mfma_f32_16x16x32_bf16 v[16:19], a[80:83], a[64:67], v[16:19]
s_waitcnt vmcnt(29)
v_mfma_f32_16x16x32_bf16 v[20:23], a[80:83], a[68:71], v[20:23]
s_waitcnt vmcnt(28)
v_mfma_f32_16x16x32_bf16 v[24:27], a[80:83], a[72:75], v[24:27]
s_waitcnt vmcnt(27)
v_mfma_f32_16x16x32_bf16 v[28:31], a[80:83], a[76:79], v[28:31]
s_waitcnt vmcnt(26)
v_mfma_f32_16x16x32_bf16 v[32:35], a[84:87], a[48:51], v[32:35]
v_mfma_f32_16x16x32_bf16 v[36:39], a[84:87], a[52:55], v[36:39]
v_mfma_f32_16x16x32_bf16 v[40:43], a[84:87], a[56:59], v[40:43]
v_mfma_f32_16x16x32_bf16 v[44:47], a[84:87], a[60:63], v[44:47]
v_mfma_f32_16x16x32_bf16 v[48:51], a[84:87], a[64:67], v[48:51]
v_mfma_f32_16x16x32_bf16 v[52:55], a[84:87], a[68:71], v[52:55]
v_mfma_f32_16x16x32_bf16 v[56:59], a[84:87], a[72:75], v[56:59]
v_mfma_f32_16x16x32_bf16 v[60:63], a[84:87], a[76:79], v[60:63]
s_waitcnt vmcnt(25)
v_mfma_f32_16x16x32_bf16 v[64:67], a[88:91], a[48:51], v[64:67]
v_mfma_f32_16x16x32_bf16 v[68:71], a[88:91], a[52:55], v[68:71]
v_mfma_f32_16x16x32_bf16 v[72:75], a[88:91], a[56:59], v[72:75]
v_mfma_f32_16x16x32_bf16 v[76:79], a[88:91], a[60:63], v[76:79]
v_mfma_f32_16x16x32_bf16 v[80:83], a[88:91], a[64:67], v[80:83]
v_mfma_f32_16x16x32_bf16 v[84:87], a[88:91], a[68:71], v[84:87]
v_mfma_f32_16x16x32_bf16 v[88:91], a[88:91], a[72:75], v[88:91]
v_mfma_f32_16x16x32_bf16 v[92:95], a[88:91], a[76:79], v[92:95]
s_waitcnt vmcnt(24)
v_mfma_f32_16x16x32_bf16 v[96:99], a[92:95], a[48:51], v[96:99]
v_mfma_f32_16x16x32_bf16 v[100:103], a[92:95], a[52:55], v[100:103]
v_mfma_f32_16x16x32_bf16 v[104:107], a[92:95], a[56:59], v[104:107]
v_mfma_f32_16x16x32_bf16 v[108:111], a[92:95], a[60:63], v[108:111]
v_mfma_f32_16x16x32_bf16 v[112:115], a[92:95], a[64:67], v[112:115]
v_mfma_f32_16x16x32_bf16 v[116:119], a[92:95], a[68:71], v[116:119]
v_mfma_f32_16x16x32_bf16 v[120:123], a[92:95], a[72:75], v[120:123]
v_mfma_f32_16x16x32_bf16 v[124:127], a[92:95], a[76:79], v[124:127]
s_waitcnt vmcnt(22)
v_mfma_f32_16x16x32_bf16 v[0:3], a[128:131], a[96:99], v[0:3]
s_waitcnt vmcnt(21)
v_mfma_f32_16x16x32_bf16 v[4:7], a[128:131], a[100:103], v[4:7]
s_waitcnt vmcnt(20)
v_mfma_f32_16x16x32_bf16 v[8:11], a[128:131], a[104:107], v[8:11]
s_waitcnt vmcnt(19)
v_mfma_f32_16x16x32_bf16 v[12:15], a[128:131], a[108:111], v[12:15]
s_waitcnt vmcnt(18)
v_mfma_f32_16x16x32_bf16 v[16:19], a[128:131], a[112:115], v[16:19]
s_waitcnt vmcnt(17)
v_mfma_f32_16x16x32_bf16 v[20:23], a[128:131], a[116:119], v[20:23]
s_waitcnt vmcnt(16)
v_mfma_f32_16x16x32_bf16 v[24:27], a[128:131], a[120:123], v[24:27]
s_waitcnt vmcnt(15)
v_mfma_f32_16x16x32_bf16 v[28:31], a[128:131], a[124:127], v[28:31]
s_waitcnt vmcnt(14)
v_mfma_f32_16x16x32_bf16 v[32:35], a[132:135], a[96:99], v[32:35]
v_mfma_f32_16x16x32_bf16 v[36:39], a[132:135], a[100:103], v[36:39]
v_mfma_f32_16x16x32_bf16 v[40:43], a[132:135], a[104:107], v[40:43]
v_mfma_f32_16x16x32_bf16 v[44:47], a[132:135], a[108:111], v[44:47]
v_mfma_f32_16x16x32_bf16 v[48:51], a[132:135], a[112:115], v[48:51]
v_mfma_f32_16x16x32_bf16 v[52:55], a[132:135], a[116:119], v[52:55]
v_mfma_f32_16x16x32_bf16 v[56:59], a[132:135], a[120:123], v[56:59]
v_mfma_f32_16x16x32_bf16 v[60:63], a[132:135], a[124:127], v[60:63]
s_waitcnt vmcnt(13)
v_mfma_f32_16x16x32_bf16 v[64:67], a[136:139], a[96:99], v[64:67]
v_mfma_f32_16x16x32_bf16 v[68:71], a[136:139], a[100:103], v[68:71]
v_mfma_f32_16x16x32_bf16 v[72:75], a[136:139], a[104:107], v[72:75]
v_mfma_f32_16x16x32_bf16 v[76:79], a[136:139], a[108:111], v[76:79]
v_mfma_f32_16x16x32_bf16 v[80:83], a[136:139], a[112:115], v[80:83]
v_mfma_f32_16x16x32_bf16 v[84:87], a[136:139], a[116:119], v[84:87]
v_mfma_f32_16x16x32_bf16 v[88:91], a[136:139], a[120:123], v[88:91]
v_mfma_f32_16x16x32_bf16 v[92:95], a[136:139], a[124:127], v[92:95]
s_waitcnt vmcnt(12)
v_mfma_f32_16x16x32_bf16 v[96:99], a[140:143], a[96:99], v[96:99]
v_mfma_f32_16x16x32_bf16 v[100:103], a[140:143], a[100:103], v[100:103]
v_mfma_f32_16x16x32_bf16 v[104:107], a[140:143], a[104:107], v[104:107]
v_mfma_f32_16x16x32_bf16 v[108:111], a[140:143], a[108:111], v[108:111]
v_mfma_f32_16x16x32_bf16 v[112:115], a[140:143], a[112:115], v[112:115]
v_mfma_f32_16x16x32_bf16 v[116:119], a[140:143], a[116:119], v[116:119]
v_mfma_f32_16x16x32_bf16 v[120:123], a[140:143], a[120:123], v[120:123]
v_mfma_f32_16x16x32_bf16 v[124:127], a[140:143], a[124:127], v[124:127]
s_waitcnt vmcnt(10)
v_mfma_f32_16x16x32_bf16 v[0:3], a[176:179], a[144:147], v[0:3]
s_waitcnt vmcnt(9)
v_mfma_f32_16x16x32_bf16 v[4:7], a[176:179], a[148:151], v[4:7]
s_waitcnt vmcnt(8)
v_mfma_f32_16x16x32_bf16 v[8:11], a[176:179], a[152:155], v[8:11]
s_waitcnt vmcnt(7)
v_mfma_f32_16x16x32_bf16 v[12:15], a[176:179], a[156:159], v[12:15]
s_waitcnt vmcnt(6)
v_mfma_f32_16x16x32_bf16 v[16:19], a[176:179], a[160:163], v[16:19]
s_waitcnt vmcnt(5)
v_mfma_f32_16x16x32_bf16 v[20:23], a[176:179], a[164:167], v[20:23]
s_waitcnt vmcnt(4)
v_mfma_f32_16x16x32_bf16 v[24:27], a[176:179], a[168:171], v[24:27]
s_waitcnt vmcnt(3)
v_mfma_f32_16x16x32_bf16 v[28:31], a[176:179], a[172:175], v[28:31]
s_waitcnt vmcnt(2)
v_mfma_f32_16x16x32_bf16 v[32:35], a[180:183], a[144:147], v[32:35]
v_mfma_f32_16x16x32_bf16 v[36:39], a[180:183], a[148:151], v[36:39]
v_mfma_f32_16x16x32_bf16 v[40:43], a[180:183], a[152:155], v[40:43]
v_mfma_f32_16x16x32_bf16 v[44:47], a[180:183], a[156:159], v[44:47]
v_mfma_f32_16x16x32_bf16 v[48:51], a[180:183], a[160:163], v[48:51]
v_mfma_f32_16x16x32_bf16 v[52:55], a[180:183], a[164:167], v[52:55]
v_mfma_f32_16x16x32_bf16 v[56:59], a[180:183], a[168:171], v[56:59]
v_mfma_f32_16x16x32_bf16 v[60:63], a[180:183], a[172:175], v[60:63]
s_waitcnt vmcnt(1)
v_mfma_f32_16x16x32_bf16 v[64:67], a[184:187], a[144:147], v[64:67]
v_mfma_f32_16x16x32_bf16 v[68:71], a[184:187], a[148:151], v[68:71]
v_mfma_f32_16x16x32_bf16 v[72:75], a[184:187], a[152:155], v[72:75]
v_mfma_f32_16x16x32_bf16 v[76:79], a[184:187], a[156:159], v[76:79]
v_mfma_f32_16x16x32_bf16 v[80:83], a[184:187], a[160:163], v[80:83]
v_mfma_f32_16x16x32_bf16 v[84:87], a[184:187], a[164:167], v[84:87]
v_mfma_f32_16x16x32_bf16 v[88:91], a[184:187], a[168:171], v[88:91]
v_mfma_f32_16x16x32_bf16 v[92:95], a[184:187], a[172:175], v[92:95]
s_waitcnt vmcnt(0)
v_mfma_f32_16x16x32_bf16 v[96:99], a[188:191], a[144:147], v[96:99]
v_mfma_f32_16x16x32_bf16 v[100:103], a[188:191], a[148:151], v[100:103]
v_mfma_f32_16x16x32_bf16 v[104:107], a[188:191], a[152:155], v[104:107]
v_mfma_f32_16x16x32_bf16 v[108:111], a[188:191], a[156:159], v[108:111]
v_mfma_f32_16x16x32_bf16 v[112:115], a[188:191], a[160:163], v[112:115]
v_mfma_f32_16x16x32_bf16 v[116:119], a[188:191], a[164:167], v[116:119]
v_mfma_f32_16x16x32_bf16 v[120:123], a[188:191], a[168:171], v[120:123]
v_mfma_f32_16x16x32_bf16 v[124:127], a[188:191], a[172:175], v[124:127]
s_nop 7
s_nop 7
s_lshl_b32 s20, s16, 13
v_add_u32 v132, s20, v131
v_add_u32 v133, 0x10000, v132
ds_write_b128 v132, v[0:3] offset:0
ds_write_b128 v132, v[4:7] offset:1024
ds_write_b128 v132, v[32:35] offset:2048
ds_write_b128 v132, v[36:39] offset:3072
ds_write_b128 v132, v[64:67] offset:4096
ds_write_b128 v132, v[68:71] offset:5120
ds_write_b128 v132, v[96:99] offset:6144
ds_write_b128 v132, v[100:103] offset:7168
ds_write_b128 v132, v[8:11] offset:32768
ds_write_b128 v132, v[12:15] offset:33792
ds_write_b128 v132, v[40:43] offset:34816
ds_write_b128 v132, v[44:47] offset:35840
ds_write_b128 v132, v[72:75] offset:36864
ds_write_b128 v132, v[76:79] offset:37888
ds_write_b128 v132, v[104:107] offset:38912
ds_write_b128 v132, v[108:111] offset:39936
ds_write_b128 v133, v[16:19] offset:0
ds_write_b128 v133, v[20:23] offset:1024
ds_write_b128 v133, v[48:51] offset:2048
ds_write_b128 v133, v[52:55] offset:3072
ds_write_b128 v133, v[80:83] offset:4096
ds_write_b128 v133, v[84:87] offset:5120
ds_write_b128 v133, v[112:115] offset:6144
ds_write_b128 v133, v[116:119] offset:7168
ds_write_b128 v133, v[24:27] offset:32768
ds_write_b128 v133, v[28:31] offset:33792
ds_write_b128 v133, v[56:59] offset:34816
ds_write_b128 v133, v[60:63] offset:35840
ds_write_b128 v133, v[88:91] offset:36864
ds_write_b128 v133, v[92:95] offset:37888
ds_write_b128 v133, v[120:123] offset:38912
ds_write_b128 v133, v[124:127] offset:39936
s_waitcnt lgkmcnt(0)
s_barrier
s_lshl_b32 s20, s16, 15
v_add_u32 v132, s20, v131
ds_read_b128 v[0:3], v132 offset:0
ds_read_b128 v[32:35], v132 offset:8192
ds_read_b128 v[64:67], v132 offset:16384
ds_read_b128 v[96:99], v132 offset:24576
ds_read_b128 v[4:7], v132 offset:1024
ds_read_b128 v[36:39], v132 offset:9216
ds_read_b128 v[68:71], v132 offset:17408
ds_read_b128 v[100:103], v132 offset:25600
ds_read_b128 v[8:11], v132 offset:2048
ds_read_b128 v[40:43], v132 offset:10240
ds_read_b128 v[72:75], v132 offset:18432
ds_read_b128 v[104:107], v132 offset:26624
ds_read_b128 v[12:15], v132 offset:3072
ds_read_b128 v[44:47], v132 offset:11264
ds_read_b128 v[76:79], v132 offset:19456
ds_read_b128 v[108:111], v132 offset:27648
ds_read_b128 v[16:19], v132 offset:4096
ds_read_b128 v[48:51], v132 offset:12288
ds_read_b128 v[80:83], v132 offset:20480
ds_read_b128 v[112:115], v132 offset:28672
ds_read_b128 v[20:23], v132 offset:5120
ds_read_b128 v[52:55], v132 offset:13312
ds_read_b128 v[84:87], v132 offset:21504
ds_read_b128 v[116:119], v132 offset:29696
ds_read_b128 v[24:27], v132 offset:6144
ds_read_b128 v[56:59], v132 offset:14336
ds_read_b128 v[88:91], v132 offset:22528
ds_read_b128 v[120:123], v132 offset:30720
ds_read_b128 v[28:31], v132 offset:7168
ds_read_b128 v[60:63], v132 offset:15360
ds_read_b128 v[92:95], v132 offset:23552
ds_read_b128 v[124:127], v132 offset:31744
v_lshlrev_b32 v132, 10, v130
v_lshl_add_u32 v132, v129, 4, v132
s_lshl_b32 s20, s18, 17
s_lshl_b32 s21, s16, 15
s_add_u32 s20, s20, s21
s_lshl_b32 s21, s19, 7
s_add_u32 s20, s20, s21
s_waitcnt lgkmcnt(15)
v_add_f32 v0, v0, v32
v_add_f32 v64, v64, v96
v_add_f32 v1, v1, v33
v_add_f32 v65, v65, v97
v_add_f32 v2, v2, v34
v_add_f32 v66, v66, v98
v_add_f32 v3, v3, v35
v_add_f32 v67, v67, v99
v_add_f32 v0, v0, v64
v_add_f32 v1, v1, v65
v_add_f32 v2, v2, v66
v_add_f32 v3, v3, v67
v_add_f32 v4, v4, v36
v_add_f32 v68, v68, v100
v_add_f32 v5, v5, v37
v_add_f32 v69, v69, v101
v_add_f32 v6, v6, v38
v_add_f32 v70, v70, v102
v_add_f32 v7, v7, v39
v_add_f32 v71, v71, v103
v_add_f32 v4, v4, v68
v_add_f32 v5, v5, v69
v_add_f32 v6, v6, v70
v_add_f32 v7, v7, v71
v_add_f32 v8, v8, v40
v_add_f32 v72, v72, v104
v_add_f32 v9, v9, v41
v_add_f32 v73, v73, v105
v_add_f32 v10, v10, v42
v_add_f32 v74, v74, v106
v_add_f32 v11, v11, v43
v_add_f32 v75, v75, v107
v_add_f32 v8, v8, v72
v_add_f32 v9, v9, v73
v_add_f32 v10, v10, v74
v_add_f32 v11, v11, v75
v_add_f32 v12, v12, v44
v_add_f32 v76, v76, v108
v_add_f32 v13, v13, v45
v_add_f32 v77, v77, v109
v_add_f32 v14, v14, v46
v_add_f32 v78, v78, v110
v_add_f32 v15, v15, v47
v_add_f32 v79, v79, v111
v_add_f32 v12, v12, v76
v_add_f32 v13, v13, v77
v_add_f32 v14, v14, v78
v_add_f32 v15, v15, v79
s_waitcnt lgkmcnt(12)
v_add_f32 v16, v16, v48
v_add_f32 v80, v80, v112
v_add_f32 v17, v17, v49
v_add_f32 v81, v81, v113
v_add_f32 v18, v18, v50
v_add_f32 v82, v82, v114
v_add_f32 v19, v19, v51
v_add_f32 v83, v83, v115
v_add_f32 v16, v16, v80
v_add_f32 v17, v17, v81
v_add_f32 v18, v18, v82
v_add_f32 v19, v19, v83
s_waitcnt lgkmcnt(8)
v_add_f32 v20, v20, v52
v_add_f32 v84, v84, v116
v_add_f32 v21, v21, v53
v_add_f32 v85, v85, v117
v_add_f32 v22, v22, v54
v_add_f32 v86, v86, v118
v_add_f32 v23, v23, v55
v_add_f32 v87, v87, v119
v_add_f32 v20, v20, v84
v_add_f32 v21, v21, v85
v_add_f32 v22, v22, v86
v_add_f32 v23, v23, v87
s_waitcnt lgkmcnt(4)
v_add_f32 v24, v24, v56
v_add_f32 v88, v88, v120
v_add_f32 v25, v25, v57
v_add_f32 v89, v89, v121
v_add_f32 v26, v26, v58
v_add_f32 v90, v90, v122
v_add_f32 v27, v27, v59
v_add_f32 v91, v91, v123
v_add_f32 v24, v24, v88
v_add_f32 v25, v25, v89
v_add_f32 v26, v26, v90
v_add_f32 v27, v27, v91
s_waitcnt lgkmcnt(0)
v_add_f32 v28, v28, v60
v_add_f32 v92, v92, v124
v_add_f32 v29, v29, v61
v_add_f32 v93, v93, v125
v_add_f32 v30, v30, v62
v_add_f32 v94, v94, v126
v_add_f32 v31, v31, v63
v_add_f32 v95, v95, v127
v_add_f32 v28, v28, v92
v_add_f32 v29, v29, v93
v_add_f32 v30, v30, v94
v_add_f32 v31, v31, v95
v_cvt_pk_bf16_f32 v32, v0, v1
v_cvt_pk_bf16_f32 v33, v2, v3
v_cvt_pk_bf16_f32 v34, v8, v9
v_cvt_pk_bf16_f32 v35, v10, v11
s_add_u32 s21, s20, 0
buffer_store_dwordx4 v[32:35], v132, s[12:15], s21 offen offset:0
v_cvt_pk_bf16_f32 v36, v16, v17
v_cvt_pk_bf16_f32 v37, v18, v19
v_cvt_pk_bf16_f32 v38, v24, v25
v_cvt_pk_bf16_f32 v39, v26, v27
s_add_u32 s21, s20, 0
buffer_store_dwordx4 v[36:39], v132, s[12:15], s21 offen offset:64
v_cvt_pk_bf16_f32 v40, v4, v5
v_cvt_pk_bf16_f32 v41, v6, v7
v_cvt_pk_bf16_f32 v42, v12, v13
v_cvt_pk_bf16_f32 v43, v14, v15
s_add_u32 s21, s20, 16384
buffer_store_dwordx4 v[40:43], v132, s[12:15], s21 offen offset:0
v_cvt_pk_bf16_f32 v44, v20, v21
v_cvt_pk_bf16_f32 v45, v22, v23
v_cvt_pk_bf16_f32 v46, v28, v29
v_cvt_pk_bf16_f32 v47, v30, v31
s_add_u32 s21, s20, 16384
buffer_store_dwordx4 v[44:47], v132, s[12:15], s21 offen offset:64
s_endpgm
L_slow0:
s_nop 15
s_waitcnt vmcnt(0)
v_lshrrev_b32 v230, 4, v214
v_and_b32 v231, 15, v230
v_lshrrev_b32 v230, 4, v230
v_lshlrev_b32 v234, 8, v231
v_lshl_add_u32 v234, v230, 4, v234
v_lshlrev_b32 v235, 10, v230
v_lshl_add_u32 v235, v231, 1, v235
v_mov_b32 v226, 0xff7fffff
v_mov_b32 v227, 0xff7fffff
v_mov_b32 v228, 0xff7fffff
v_mov_b32 v229, 0xff7fffff
s_mov_b32 s65, 0
s_mov_b32 s64, 32
L_sl0_p1:
buffer_load_dwordx4 a[192:195], v234, s[12:15], s65 offen offset:0
buffer_load_dwordx4 a[196:199], v234, s[12:15], s65 offen offset:64
buffer_load_dwordx4 a[200:203], v234, s[12:15], s65 offen offset:128
buffer_load_dwordx4 a[204:207], v234, s[12:15], s65 offen offset:192
s_waitcnt vmcnt(0)
v_mfma_f32_16x16x32_bf16 v[176:179], a[192:195], a[0:3], 0
v_mfma_f32_16x16x32_bf16 v[176:179], a[196:199], a[4:7], v[176:179]
v_mfma_f32_16x16x32_bf16 v[176:179], a[200:203], a[8:11], v[176:179]
v_mfma_f32_16x16x32_bf16 v[176:179], a[204:207], a[12:15], v[176:179]
v_mfma_f32_16x16x32_bf16 v[180:183], a[192:195], a[16:19], 0
v_mfma_f32_16x16x32_bf16 v[180:183], a[196:199], a[20:23], v[180:183]
v_mfma_f32_16x16x32_bf16 v[180:183], a[200:203], a[24:27], v[180:183]
v_mfma_f32_16x16x32_bf16 v[180:183], a[204:207], a[28:31], v[180:183]
v_mfma_f32_16x16x32_bf16 v[184:187], a[192:195], a[32:35], 0
v_mfma_f32_16x16x32_bf16 v[184:187], a[196:199], a[36:39], v[184:187]
v_mfma_f32_16x16x32_bf16 v[184:187], a[200:203], a[40:43], v[184:187]
v_mfma_f32_16x16x32_bf16 v[184:187], a[204:207], a[44:47], v[184:187]
v_mfma_f32_16x16x32_bf16 v[188:191], a[192:195], a[48:51], 0
v_mfma_f32_16x16x32_bf16 v[188:191], a[196:199], a[52:55], v[188:191]
v_mfma_f32_16x16x32_bf16 v[188:191], a[200:203], a[56:59], v[188:191]
v_mfma_f32_16x16x32_bf16 v[188:191], a[204:207], a[60:63], v[188:191]
s_nop 15
s_add_u32 s65, s65, 4096
v_max3_f32 v226, v226, v176, v177
v_max3_f32 v226, v226, v178, v179
v_max3_f32 v227, v227, v180, v181
v_max3_f32 v227, v227, v182, v183
v_max3_f32 v228, v228, v184, v185
v_max3_f32 v228, v228, v186, v187
v_max3_f32 v229, v229, v188, v189
v_max3_f32 v229, v229, v190, v191
s_sub_u32 s64, s64, 1
s_cmp_lg_u32 s64, 0
s_cbranch_scc1 L_sl0_p1
v_mov_b32 v230, v226
v_mov_b32 v231, v227
v_mov_b32 v232, v228
v_mov_b32 v233, v229
s_nop 1
v_permlane16_swap_b32 v226, v230
v_permlane16_swap_b32 v227, v231
v_permlane16_swap_b32 v228, v232
v_permlane16_swap_b32 v229, v233
s_nop 1
v_max_f32 v226, v226, v230
v_max_f32 v227, v227, v231
v_max_f32 v228, v228, v232
v_max_f32 v229, v229, v233
v_mov_b32 v230, v226
v_mov_b32 v231, v227
v_mov_b32 v232, v228
v_mov_b32 v233, v229
s_nop 1
v_permlane32_swap_b32 v226, v230
v_permlane32_swap_b32 v227, v231
v_permlane32_swap_b32 v228, v232
v_permlane32_swap_b32 v229, v233
s_nop 1
v_max_f32 v226, v226, v230
v_max_f32 v227, v227, v231
v_max_f32 v228, v228, v232
v_max_f32 v229, v229, v233
v_max_f32 v229, s53, v229
v_mov_b32 v0, 0
v_mov_b32 v1, 0
v_mov_b32 v2, 0
v_mov_b32 v3, 0
v_mov_b32 v4, 0
v_mov_b32 v5, 0
v_mov_b32 v6, 0
v_mov_b32 v7, 0
v_mov_b32 v8, 0
v_mov_b32 v9, 0
v_mov_b32 v10, 0
v_mov_b32 v11, 0
v_mov_b32 v12, 0
v_mov_b32 v13, 0
v_mov_b32 v14, 0
v_mov_b32 v15, 0
v_mov_b32 v16, 0
v_mov_b32 v17, 0
v_mov_b32 v18, 0
v_mov_b32 v19, 0
v_mov_b32 v20, 0
v_mov_b32 v21, 0
v_mov_b32 v22, 0
v_mov_b32 v23, 0
v_mov_b32 v24, 0
v_mov_b32 v25, 0
v_mov_b32 v26, 0
v_mov_b32 v27, 0
v_mov_b32 v28, 0
v_mov_b32 v29, 0
v_mov_b32 v30, 0
v_mov_b32 v31, 0
v_mov_b32 v32, 0
v_mov_b32 v33, 0
v_mov_b32 v34, 0
v_mov_b32 v35, 0
v_mov_b32 v36, 0
v_mov_b32 v37, 0
v_mov_b32 v38, 0
v_mov_b32 v39, 0
v_mov_b32 v40, 0
v_mov_b32 v41, 0
v_mov_b32 v42, 0
v_mov_b32 v43, 0
v_mov_b32 v44, 0
v_mov_b32 v45, 0
v_mov_b32 v46, 0
v_mov_b32 v47, 0
v_mov_b32 v48, 0
v_mov_b32 v49, 0
v_mov_b32 v50, 0
v_mov_b32 v51, 0
v_mov_b32 v52, 0
v_mov_b32 v53, 0
v_mov_b32 v54, 0
v_mov_b32 v55, 0
v_mov_b32 v56, 0
v_mov_b32 v57, 0
v_mov_b32 v58, 0
v_mov_b32 v59, 0
v_mov_b32 v60, 0
v_mov_b32 v61, 0
v_mov_b32 v62, 0
v_mov_b32 v63, 0
v_mov_b32 v64, 0
v_mov_b32 v65, 0
v_mov_b32 v66, 0
v_mov_b32 v67, 0
v_mov_b32 v68, 0
v_mov_b32 v69, 0
v_mov_b32 v70, 0
v_mov_b32 v71, 0
v_mov_b32 v72, 0
v_mov_b32 v73, 0
v_mov_b32 v74, 0
v_mov_b32 v75, 0
v_mov_b32 v76, 0
v_mov_b32 v77, 0
v_mov_b32 v78, 0
v_mov_b32 v79, 0
v_mov_b32 v80, 0
v_mov_b32 v81, 0
v_mov_b32 v82, 0
v_mov_b32 v83, 0
v_mov_b32 v84, 0
v_mov_b32 v85, 0
v_mov_b32 v86, 0
v_mov_b32 v87, 0
v_mov_b32 v88, 0
v_mov_b32 v89, 0
v_mov_b32 v90, 0
v_mov_b32 v91, 0
v_mov_b32 v92, 0
v_mov_b32 v93, 0
v_mov_b32 v94, 0
v_mov_b32 v95, 0
v_mov_b32 v96, 0
v_mov_b32 v97, 0
v_mov_b32 v98, 0
v_mov_b32 v99, 0
v_mov_b32 v100, 0
v_mov_b32 v101, 0
v_mov_b32 v102, 0
v_mov_b32 v103, 0
v_mov_b32 v104, 0
v_mov_b32 v105, 0
v_mov_b32 v106, 0
v_mov_b32 v107, 0
v_mov_b32 v108, 0
v_mov_b32 v109, 0
v_mov_b32 v110, 0
v_mov_b32 v111, 0
v_mov_b32 v112, 0
v_mov_b32 v113, 0
v_mov_b32 v114, 0
v_mov_b32 v115, 0
v_mov_b32 v116, 0
v_mov_b32 v117, 0
v_mov_b32 v118, 0
v_mov_b32 v119, 0
v_mov_b32 v120, 0
v_mov_b32 v121, 0
v_mov_b32 v122, 0
v_mov_b32 v123, 0
v_mov_b32 v124, 0
v_mov_b32 v125, 0
v_mov_b32 v126, 0
v_mov_b32 v127, 0
v_mov_b32 v210, 0
v_mov_b32 v211, 0
v_mov_b32 v212, 0
v_mov_b32 v213, 0
s_mov_b32 s65, 0
s_mov_b32 s64, 16
L_sl0_p2:
s_mov_b32 s66, s65
buffer_load_dwordx4 a[192:195], v234, s[12:15], s65 offen offset:0
buffer_load_dwordx4 a[196:199], v234, s[12:15], s65 offen offset:64
buffer_load_dwordx4 a[200:203], v234, s[12:15], s65 offen offset:128
buffer_load_dwordx4 a[204:207], v234, s[12:15], s65 offen offset:192
s_waitcnt vmcnt(0)
v_mfma_f32_16x16x32_bf16 v[176:179], a[192:195], a[0:3], 0
v_mfma_f32_16x16x32_bf16 v[176:179], a[196:199], a[4:7], v[176:179]
v_mfma_f32_16x16x32_bf16 v[176:179], a[200:203], a[8:11], v[176:179]
v_mfma_f32_16x16x32_bf16 v[176:179], a[204:207], a[12:15], v[176:179]
v_mfma_f32_16x16x32_bf16 v[180:183], a[192:195], a[16:19], 0
v_mfma_f32_16x16x32_bf16 v[180:183], a[196:199], a[20:23], v[180:183]
v_mfma_f32_16x16x32_bf16 v[180:183], a[200:203], a[24:27], v[180:183]
v_mfma_f32_16x16x32_bf16 v[180:183], a[204:207], a[28:31], v[180:183]
v_mfma_f32_16x16x32_bf16 v[184:187], a[192:195], a[32:35], 0
v_mfma_f32_16x16x32_bf16 v[184:187], a[196:199], a[36:39], v[184:187]
v_mfma_f32_16x16x32_bf16 v[184:187], a[200:203], a[40:43], v[184:187]
v_mfma_f32_16x16x32_bf16 v[184:187], a[204:207], a[44:47], v[184:187]
v_mfma_f32_16x16x32_bf16 v[188:191], a[192:195], a[48:51], 0
v_mfma_f32_16x16x32_bf16 v[188:191], a[196:199], a[52:55], v[188:191]
v_mfma_f32_16x16x32_bf16 v[188:191], a[200:203], a[56:59], v[188:191]
v_mfma_f32_16x16x32_bf16 v[188:191], a[204:207], a[60:63], v[188:191]
s_nop 15
s_add_u32 s65, s65, 4096
v_sub_f32 v176, v176, v226
v_sub_f32 v177, v177, v226
v_sub_f32 v178, v178, v226
v_sub_f32 v179, v179, v226
v_exp_f32 v176, v176
v_exp_f32 v177, v177
v_exp_f32 v178, v178
v_exp_f32 v179, v179
s_nop 0
v_add_f32 v210, v210, v176
v_add_f32 v210, v210, v177
v_add_f32 v210, v210, v178
v_add_f32 v210, v210, v179
v_cvt_pk_bf16_f32 v160, v176, v177
v_cvt_pk_bf16_f32 v161, v178, v179
v_sub_f32 v180, v180, v227
v_sub_f32 v181, v181, v227
v_sub_f32 v182, v182, v227
v_sub_f32 v183, v183, v227
v_exp_f32 v180, v180
v_exp_f32 v181, v181
v_exp_f32 v182, v182
v_exp_f32 v183, v183
s_nop 0
v_add_f32 v211, v211, v180
v_add_f32 v211, v211, v181
v_add_f32 v211, v211, v182
v_add_f32 v211, v211, v183
v_cvt_pk_bf16_f32 v164, v180, v181
v_cvt_pk_bf16_f32 v165, v182, v183
v_sub_f32 v184, v184, v228
v_sub_f32 v185, v185, v228
v_sub_f32 v186, v186, v228
v_sub_f32 v187, v187, v228
v_exp_f32 v184, v184
v_exp_f32 v185, v185
v_exp_f32 v186, v186
v_exp_f32 v187, v187
s_nop 0
v_add_f32 v212, v212, v184
v_add_f32 v212, v212, v185
v_add_f32 v212, v212, v186
v_add_f32 v212, v212, v187
v_cvt_pk_bf16_f32 v168, v184, v185
v_cvt_pk_bf16_f32 v169, v186, v187
v_sub_f32 v188, v188, v229
v_sub_f32 v189, v189, v229
v_sub_f32 v190, v190, v229
v_sub_f32 v191, v191, v229
v_exp_f32 v188, v188
v_exp_f32 v189, v189
v_exp_f32 v190, v190
v_exp_f32 v191, v191
s_nop 0
v_add_f32 v213, v213, v188
v_add_f32 v213, v213, v189
v_add_f32 v213, v213, v190
v_add_f32 v213, v213, v191
v_cvt_pk_bf16_f32 v172, v188, v189
v_cvt_pk_bf16_f32 v173, v190, v191
buffer_load_dwordx4 a[192:195], v234, s[12:15], s65 offen offset:0
buffer_load_dwordx4 a[196:199], v234, s[12:15], s65 offen offset:64
buffer_load_dwordx4 a[200:203], v234, s[12:15], s65 offen offset:128
buffer_load_dwordx4 a[204:207], v234, s[12:15], s65 offen offset:192
s_waitcnt vmcnt(0)
v_mfma_f32_16x16x32_bf16 v[176:179], a[192:195], a[0:3], 0
v_mfma_f32_16x16x32_bf16 v[176:179], a[196:199], a[4:7], v[176:179]
v_mfma_f32_16x16x32_bf16 v[176:179], a[200:203], a[8:11], v[176:179]
v_mfma_f32_16x16x32_bf16 v[176:179], a[204:207], a[12:15], v[176:179]
v_mfma_f32_16x16x32_bf16 v[180:183], a[192:195], a[16:19], 0
v_mfma_f32_16x16x32_bf16 v[180:183], a[196:199], a[20:23], v[180:183]
v_mfma_f32_16x16x32_bf16 v[180:183], a[200:203], a[24:27], v[180:183]
v_mfma_f32_16x16x32_bf16 v[180:183], a[204:207], a[28:31], v[180:183]
v_mfma_f32_16x16x32_bf16 v[184:187], a[192:195], a[32:35], 0
v_mfma_f32_16x16x32_bf16 v[184:187], a[196:199], a[36:39], v[184:187]
v_mfma_f32_16x16x32_bf16 v[184:187], a[200:203], a[40:43], v[184:187]
v_mfma_f32_16x16x32_bf16 v[184:187], a[204:207], a[44:47], v[184:187]
v_mfma_f32_16x16x32_bf16 v[188:191], a[192:195], a[48:51], 0
v_mfma_f32_16x16x32_bf16 v[188:191], a[196:199], a[52:55], v[188:191]
v_mfma_f32_16x16x32_bf16 v[188:191], a[200:203], a[56:59], v[188:191]
v_mfma_f32_16x16x32_bf16 v[188:191], a[204:207], a[60:63], v[188:191]
s_nop 15
s_add_u32 s65, s65, 4096
v_sub_f32 v176, v176, v226
v_sub_f32 v177, v177, v226
v_sub_f32 v178, v178, v226
v_sub_f32 v179, v179, v226
v_exp_f32 v176, v176
v_exp_f32 v177, v177
v_exp_f32 v178, v178
v_exp_f32 v179, v179
s_nop 0
v_add_f32 v210, v210, v176
v_add_f32 v210, v210, v177
v_add_f32 v210, v210, v178
v_add_f32 v210, v210, v179
v_cvt_pk_bf16_f32 v162, v176, v177
v_cvt_pk_bf16_f32 v163, v178, v179
v_sub_f32 v180, v180, v227
v_sub_f32 v181, v181, v227
v_sub_f32 v182, v182, v227
v_sub_f32 v183, v183, v227
v_exp_f32 v180, v180
v_exp_f32 v181, v181
v_exp_f32 v182, v182
v_exp_f32 v183, v183
s_nop 0
v_add_f32 v211, v211, v180
v_add_f32 v211, v211, v181
v_add_f32 v211, v211, v182
v_add_f32 v211, v211, v183
v_cvt_pk_bf16_f32 v166, v180, v181
v_cvt_pk_bf16_f32 v167, v182, v183
v_sub_f32 v184, v184, v228
v_sub_f32 v185, v185, v228
v_sub_f32 v186, v186, v228
v_sub_f32 v187, v187, v228
v_exp_f32 v184, v184
v_exp_f32 v185, v185
v_exp_f32 v186, v186
v_exp_f32 v187, v187
s_nop 0
v_add_f32 v212, v212, v184
v_add_f32 v212, v212, v185
v_add_f32 v212, v212, v186
v_add_f32 v212, v212, v187
v_cvt_pk_bf16_f32 v170, v184, v185
v_cvt_pk_bf16_f32 v171, v186, v187
v_sub_f32 v188, v188, v229
v_sub_f32 v189, v189, v229
v_sub_f32 v190, v190, v229
v_sub_f32 v191, v191, v229
v_exp_f32 v188, v188
v_exp_f32 v189, v189
v_exp_f32 v190, v190
v_exp_f32 v191, v191
s_nop 0
v_add_f32 v213, v213, v188
v_add_f32 v213, v213, v189
v_add_f32 v213, v213, v190
v_add_f32 v213, v213, v191
v_cvt_pk_bf16_f32 v174, v188, v189
v_cvt_pk_bf16_f32 v175, v190, v191
s_sub_u32 s64, s64, 1
s_cmp_eq_u32 s64, 0
s_cbranch_scc1 L_sl0_end
s_add_u32 s67, s66, 4096
buffer_load_ushort v242, v235, s[16:19], s66 offen offset:0
buffer_load_ushort v243, v235, s[16:19], s66 offen offset:256
buffer_load_ushort v244, v235, s[16:19], s66 offen offset:512
buffer_load_ushort v245, v235, s[16:19], s66 offen offset:768
buffer_load_ushort v246, v235, s[16:19], s67 offen offset:0
buffer_load_ushort v247, v235, s[16:19], s67 offen offset:256
buffer_load_ushort v248, v235, s[16:19], s67 offen offset:512
buffer_load_ushort v249, v235, s[16:19], s67 offen offset:768
s_waitcnt vmcnt(0)
v_lshl_or_b32 v238, v243, 16, v242
v_lshl_or_b32 v239, v245, 16, v244
v_lshl_or_b32 v240, v247, 16, v246
v_lshl_or_b32 v241, v249, 16, v248
s_nop 1
v_mfma_f32_16x16x32_bf16 v[0:3], v[238:241], v[160:163], v[0:3]
v_mfma_f32_16x16x32_bf16 v[4:7], v[238:241], v[164:167], v[4:7]
v_mfma_f32_16x16x32_bf16 v[8:11], v[238:241], v[168:171], v[8:11]
v_mfma_f32_16x16x32_bf16 v[12:15], v[238:241], v[172:175], v[12:15]
s_nop 7
buffer_load_ushort v242, v235, s[16:19], s66 offen offset:32
buffer_load_ushort v243, v235, s[16:19], s66 offen offset:288
buffer_load_ushort v244, v235, s[16:19], s66 offen offset:544
buffer_load_ushort v245, v235, s[16:19], s66 offen offset:800
buffer_load_ushort v246, v235, s[16:19], s67 offen offset:32
buffer_load_ushort v247, v235, s[16:19], s67 offen offset:288
buffer_load_ushort v248, v235, s[16:19], s67 offen offset:544
buffer_load_ushort v249, v235, s[16:19], s67 offen offset:800
s_waitcnt vmcnt(0)
v_lshl_or_b32 v238, v243, 16, v242
v_lshl_or_b32 v239, v245, 16, v244
v_lshl_or_b32 v240, v247, 16, v246
v_lshl_or_b32 v241, v249, 16, v248
s_nop 1
v_mfma_f32_16x16x32_bf16 v[16:19], v[238:241], v[160:163], v[16:19]
v_mfma_f32_16x16x32_bf16 v[20:23], v[238:241], v[164:167], v[20:23]
v_mfma_f32_16x16x32_bf16 v[24:27], v[238:241], v[168:171], v[24:27]
v_mfma_f32_16x16x32_bf16 v[28:31], v[238:241], v[172:175], v[28:31]
s_nop 7
buffer_load_ushort v242, v235, s[16:19], s66 offen offset:64
buffer_load_ushort v243, v235, s[16:19], s66 offen offset:320
buffer_load_ushort v244, v235, s[16:19], s66 offen offset:576
buffer_load_ushort v245, v235, s[16:19], s66 offen offset:832
buffer_load_ushort v246, v235, s[16:19], s67 offen offset:64
buffer_load_ushort v247, v235, s[16:19], s67 offen offset:320
buffer_load_ushort v248, v235, s[16:19], s67 offen offset:576
buffer_load_ushort v249, v235, s[16:19], s67 offen offset:832
s_waitcnt vmcnt(0)
v_lshl_or_b32 v238, v243, 16, v242
v_lshl_or_b32 v239, v245, 16, v244
v_lshl_or_b32 v240, v247, 16, v246
v_lshl_or_b32 v241, v249, 16, v248
s_nop 1
v_mfma_f32_16x16x32_bf16 v[32:35], v[238:241], v[160:163], v[32:35]
v_mfma_f32_16x16x32_bf16 v[36:39], v[238:241], v[164:167], v[36:39]
v_mfma_f32_16x16x32_bf16 v[40:43], v[238:241], v[168:171], v[40:43]
v_mfma_f32_16x16x32_bf16 v[44:47], v[238:241], v[172:175], v[44:47]
s_nop 7
buffer_load_ushort v242, v235, s[16:19], s66 offen offset:96
buffer_load_ushort v243, v235, s[16:19], s66 offen offset:352
buffer_load_ushort v244, v235, s[16:19], s66 offen offset:608
buffer_load_ushort v245, v235, s[16:19], s66 offen offset:864
buffer_load_ushort v246, v235, s[16:19], s67 offen offset:96
buffer_load_ushort v247, v235, s[16:19], s67 offen offset:352
buffer_load_ushort v248, v235, s[16:19], s67 offen offset:608
buffer_load_ushort v249, v235, s[16:19], s67 offen offset:864
s_waitcnt vmcnt(0)
v_lshl_or_b32 v238, v243, 16, v242
v_lshl_or_b32 v239, v245, 16, v244
v_lshl_or_b32 v240, v247, 16, v246
v_lshl_or_b32 v241, v249, 16, v248
s_nop 1
v_mfma_f32_16x16x32_bf16 v[48:51], v[238:241], v[160:163], v[48:51]
v_mfma_f32_16x16x32_bf16 v[52:55], v[238:241], v[164:167], v[52:55]
v_mfma_f32_16x16x32_bf16 v[56:59], v[238:241], v[168:171], v[56:59]
v_mfma_f32_16x16x32_bf16 v[60:63], v[238:241], v[172:175], v[60:63]
s_nop 7
buffer_load_ushort v242, v235, s[16:19], s66 offen offset:128
buffer_load_ushort v243, v235, s[16:19], s66 offen offset:384
buffer_load_ushort v244, v235, s[16:19], s66 offen offset:640
buffer_load_ushort v245, v235, s[16:19], s66 offen offset:896
buffer_load_ushort v246, v235, s[16:19], s67 offen offset:128
buffer_load_ushort v247, v235, s[16:19], s67 offen offset:384
buffer_load_ushort v248, v235, s[16:19], s67 offen offset:640
buffer_load_ushort v249, v235, s[16:19], s67 offen offset:896
s_waitcnt vmcnt(0)
v_lshl_or_b32 v238, v243, 16, v242
v_lshl_or_b32 v239, v245, 16, v244
v_lshl_or_b32 v240, v247, 16, v246
v_lshl_or_b32 v241, v249, 16, v248
s_nop 1
v_mfma_f32_16x16x32_bf16 v[64:67], v[238:241], v[160:163], v[64:67]
v_mfma_f32_16x16x32_bf16 v[68:71], v[238:241], v[164:167], v[68:71]
v_mfma_f32_16x16x32_bf16 v[72:75], v[238:241], v[168:171], v[72:75]
v_mfma_f32_16x16x32_bf16 v[76:79], v[238:241], v[172:175], v[76:79]
s_nop 7
buffer_load_ushort v242, v235, s[16:19], s66 offen offset:160
buffer_load_ushort v243, v235, s[16:19], s66 offen offset:416
buffer_load_ushort v244, v235, s[16:19], s66 offen offset:672
buffer_load_ushort v245, v235, s[16:19], s66 offen offset:928
buffer_load_ushort v246, v235, s[16:19], s67 offen offset:160
buffer_load_ushort v247, v235, s[16:19], s67 offen offset:416
buffer_load_ushort v248, v235, s[16:19], s67 offen offset:672
buffer_load_ushort v249, v235, s[16:19], s67 offen offset:928
s_waitcnt vmcnt(0)
v_lshl_or_b32 v238, v243, 16, v242
v_lshl_or_b32 v239, v245, 16, v244
v_lshl_or_b32 v240, v247, 16, v246
v_lshl_or_b32 v241, v249, 16, v248
s_nop 1
v_mfma_f32_16x16x32_bf16 v[80:83], v[238:241], v[160:163], v[80:83]
v_mfma_f32_16x16x32_bf16 v[84:87], v[238:241], v[164:167], v[84:87]
v_mfma_f32_16x16x32_bf16 v[88:91], v[238:241], v[168:171], v[88:91]
v_mfma_f32_16x16x32_bf16 v[92:95], v[238:241], v[172:175], v[92:95]
s_nop 7
buffer_load_ushort v242, v235, s[16:19], s66 offen offset:192
buffer_load_ushort v243, v235, s[16:19], s66 offen offset:448
buffer_load_ushort v244, v235, s[16:19], s66 offen offset:704
buffer_load_ushort v245, v235, s[16:19], s66 offen offset:960
buffer_load_ushort v246, v235, s[16:19], s67 offen offset:192
buffer_load_ushort v247, v235, s[16:19], s67 offen offset:448
buffer_load_ushort v248, v235, s[16:19], s67 offen offset:704
buffer_load_ushort v249, v235, s[16:19], s67 offen offset:960
s_waitcnt vmcnt(0)
v_lshl_or_b32 v238, v243, 16, v242
v_lshl_or_b32 v239, v245, 16, v244
v_lshl_or_b32 v240, v247, 16, v246
v_lshl_or_b32 v241, v249, 16, v248
s_nop 1
v_mfma_f32_16x16x32_bf16 v[96:99], v[238:241], v[160:163], v[96:99]
v_mfma_f32_16x16x32_bf16 v[100:103], v[238:241], v[164:167], v[100:103]
v_mfma_f32_16x16x32_bf16 v[104:107], v[238:241], v[168:171], v[104:107]
v_mfma_f32_16x16x32_bf16 v[108:111], v[238:241], v[172:175], v[108:111]
s_nop 7
buffer_load_ushort v242, v235, s[16:19], s66 offen offset:224
buffer_load_ushort v243, v235, s[16:19], s66 offen offset:480
buffer_load_ushort v244, v235, s[16:19], s66 offen offset:736
buffer_load_ushort v245, v235, s[16:19], s66 offen offset:992
buffer_load_ushort v246, v235, s[16:19], s67 offen offset:224
buffer_load_ushort v247, v235, s[16:19], s67 offen offset:480
buffer_load_ushort v248, v235, s[16:19], s67 offen offset:736
buffer_load_ushort v249, v235, s[16:19], s67 offen offset:992
s_waitcnt vmcnt(0)
v_lshl_or_b32 v238, v243, 16, v242
v_lshl_or_b32 v239, v245, 16, v244
v_lshl_or_b32 v240, v247, 16, v246
v_lshl_or_b32 v241, v249, 16, v248
s_nop 1
v_mfma_f32_16x16x32_bf16 v[112:115], v[238:241], v[160:163], v[112:115]
v_mfma_f32_16x16x32_bf16 v[116:119], v[238:241], v[164:167], v[116:119]
v_mfma_f32_16x16x32_bf16 v[120:123], v[238:241], v[168:171], v[120:123]
v_mfma_f32_16x16x32_bf16 v[124:127], v[238:241], v[172:175], v[124:127]
s_nop 7
s_branch L_sl0_p2
L_sl0_end:
s_nop 15
s_branch L_back0
L_slow1:
s_nop 15
s_waitcnt vmcnt(0)
v_lshrrev_b32 v230, 4, v214
v_and_b32 v231, 15, v230
v_lshrrev_b32 v230, 4, v230
v_lshlrev_b32 v234, 8, v231
v_lshl_add_u32 v234, v230, 4, v234
v_lshlrev_b32 v235, 10, v230
v_lshl_add_u32 v235, v231, 1, v235
v_mov_b32 v226, 0xff7fffff
v_mov_b32 v227, 0xff7fffff
v_mov_b32 v228, 0xff7fffff
v_mov_b32 v229, 0xff7fffff
s_mov_b32 s65, 131072
s_mov_b32 s64, 32
L_sl1_p1:
buffer_load_dwordx4 a[0:3], v234, s[12:15], s65 offen offset:0
buffer_load_dwordx4 a[4:7], v234, s[12:15], s65 offen offset:64
buffer_load_dwordx4 a[8:11], v234, s[12:15], s65 offen offset:128
buffer_load_dwordx4 a[12:15], v234, s[12:15], s65 offen offset:192
s_waitcnt vmcnt(0)
v_mfma_f32_16x16x32_bf16 v[176:179], a[0:3], a[64:67], 0
v_mfma_f32_16x16x32_bf16 v[176:179], a[4:7], a[68:71], v[176:179]
v_mfma_f32_16x16x32_bf16 v[176:179], a[8:11], a[72:75], v[176:179]
v_mfma_f32_16x16x32_bf16 v[176:179], a[12:15], a[76:79], v[176:179]
v_mfma_f32_16x16x32_bf16 v[180:183], a[0:3], a[80:83], 0
v_mfma_f32_16x16x32_bf16 v[180:183], a[4:7], a[84:87], v[180:183]
v_mfma_f32_16x16x32_bf16 v[180:183], a[8:11], a[88:91], v[180:183]
v_mfma_f32_16x16x32_bf16 v[180:183], a[12:15], a[92:95], v[180:183]
v_mfma_f32_16x16x32_bf16 v[184:187], a[0:3], a[96:99], 0
v_mfma_f32_16x16x32_bf16 v[184:187], a[4:7], a[100:103], v[184:187]
v_mfma_f32_16x16x32_bf16 v[184:187], a[8:11], a[104:107], v[184:187]
v_mfma_f32_16x16x32_bf16 v[184:187], a[12:15], a[108:111], v[184:187]
v_mfma_f32_16x16x32_bf16 v[188:191], a[0:3], a[112:115], 0
v_mfma_f32_16x16x32_bf16 v[188:191], a[4:7], a[116:119], v[188:191]
v_mfma_f32_16x16x32_bf16 v[188:191], a[8:11], a[120:123], v[188:191]
v_mfma_f32_16x16x32_bf16 v[188:191], a[12:15], a[124:127], v[188:191]
s_nop 15
s_add_u32 s65, s65, 4096
v_max3_f32 v226, v226, v176, v177
v_max3_f32 v226, v226, v178, v179
v_max3_f32 v227, v227, v180, v181
v_max3_f32 v227, v227, v182, v183
v_max3_f32 v228, v228, v184, v185
v_max3_f32 v228, v228, v186, v187
v_max3_f32 v229, v229, v188, v189
v_max3_f32 v229, v229, v190, v191
s_sub_u32 s64, s64, 1
s_cmp_lg_u32 s64, 0
s_cbranch_scc1 L_sl1_p1
v_mov_b32 v230, v226
v_mov_b32 v231, v227
v_mov_b32 v232, v228
v_mov_b32 v233, v229
s_nop 1
v_permlane16_swap_b32 v226, v230
v_permlane16_swap_b32 v227, v231
v_permlane16_swap_b32 v228, v232
v_permlane16_swap_b32 v229, v233
s_nop 1
v_max_f32 v226, v226, v230
v_max_f32 v227, v227, v231
v_max_f32 v228, v228, v232
v_max_f32 v229, v229, v233
v_mov_b32 v230, v226
v_mov_b32 v231, v227
v_mov_b32 v232, v228
v_mov_b32 v233, v229
s_nop 1
v_permlane32_swap_b32 v226, v230
v_permlane32_swap_b32 v227, v231
v_permlane32_swap_b32 v228, v232
v_permlane32_swap_b32 v229, v233
s_nop 1
v_max_f32 v226, v226, v230
v_max_f32 v227, v227, v231
v_max_f32 v228, v228, v232
v_max_f32 v229, v229, v233
v_max_f32 v229, s53, v229
v_mov_b32 v0, 0
v_mov_b32 v1, 0
v_mov_b32 v2, 0
v_mov_b32 v3, 0
v_mov_b32 v4, 0
v_mov_b32 v5, 0
v_mov_b32 v6, 0
v_mov_b32 v7, 0
v_mov_b32 v8, 0
v_mov_b32 v9, 0
v_mov_b32 v10, 0
v_mov_b32 v11, 0
v_mov_b32 v12, 0
v_mov_b32 v13, 0
v_mov_b32 v14, 0
v_mov_b32 v15, 0
v_mov_b32 v16, 0
v_mov_b32 v17, 0
v_mov_b32 v18, 0
v_mov_b32 v19, 0
v_mov_b32 v20, 0
v_mov_b32 v21, 0
v_mov_b32 v22, 0
v_mov_b32 v23, 0
v_mov_b32 v24, 0
v_mov_b32 v25, 0
v_mov_b32 v26, 0
v_mov_b32 v27, 0
v_mov_b32 v28, 0
v_mov_b32 v29, 0
v_mov_b32 v30, 0
v_mov_b32 v31, 0
v_mov_b32 v32, 0
v_mov_b32 v33, 0
v_mov_b32 v34, 0
v_mov_b32 v35, 0
v_mov_b32 v36, 0
v_mov_b32 v37, 0
v_mov_b32 v38, 0
v_mov_b32 v39, 0
v_mov_b32 v40, 0
v_mov_b32 v41, 0
v_mov_b32 v42, 0
v_mov_b32 v43, 0
v_mov_b32 v44, 0
v_mov_b32 v45, 0
v_mov_b32 v46, 0
v_mov_b32 v47, 0
v_mov_b32 v48, 0
v_mov_b32 v49, 0
v_mov_b32 v50, 0
v_mov_b32 v51, 0
v_mov_b32 v52, 0
v_mov_b32 v53, 0
v_mov_b32 v54, 0
v_mov_b32 v55, 0
v_mov_b32 v56, 0
v_mov_b32 v57, 0
v_mov_b32 v58, 0
v_mov_b32 v59, 0
v_mov_b32 v60, 0
v_mov_b32 v61, 0
v_mov_b32 v62, 0
v_mov_b32 v63, 0
v_mov_b32 v64, 0
v_mov_b32 v65, 0
v_mov_b32 v66, 0
v_mov_b32 v67, 0
v_mov_b32 v68, 0
v_mov_b32 v69, 0
v_mov_b32 v70, 0
v_mov_b32 v71, 0
v_mov_b32 v72, 0
v_mov_b32 v73, 0
v_mov_b32 v74, 0
v_mov_b32 v75, 0
v_mov_b32 v76, 0
v_mov_b32 v77, 0
v_mov_b32 v78, 0
v_mov_b32 v79, 0
v_mov_b32 v80, 0
v_mov_b32 v81, 0
v_mov_b32 v82, 0
v_mov_b32 v83, 0
v_mov_b32 v84, 0
v_mov_b32 v85, 0
v_mov_b32 v86, 0
v_mov_b32 v87, 0
v_mov_b32 v88, 0
v_mov_b32 v89, 0
v_mov_b32 v90, 0
v_mov_b32 v91, 0
v_mov_b32 v92, 0
v_mov_b32 v93, 0
v_mov_b32 v94, 0
v_mov_b32 v95, 0
v_mov_b32 v96, 0
v_mov_b32 v97, 0
v_mov_b32 v98, 0
v_mov_b32 v99, 0
v_mov_b32 v100, 0
v_mov_b32 v101, 0
v_mov_b32 v102, 0
v_mov_b32 v103, 0
v_mov_b32 v104, 0
v_mov_b32 v105, 0
v_mov_b32 v106, 0
v_mov_b32 v107, 0
v_mov_b32 v108, 0
v_mov_b32 v109, 0
v_mov_b32 v110, 0
v_mov_b32 v111, 0
v_mov_b32 v112, 0
v_mov_b32 v113, 0
v_mov_b32 v114, 0
v_mov_b32 v115, 0
v_mov_b32 v116, 0
v_mov_b32 v117, 0
v_mov_b32 v118, 0
v_mov_b32 v119, 0
v_mov_b32 v120, 0
v_mov_b32 v121, 0
v_mov_b32 v122, 0
v_mov_b32 v123, 0
v_mov_b32 v124, 0
v_mov_b32 v125, 0
v_mov_b32 v126, 0
v_mov_b32 v127, 0
v_mov_b32 v252, 0
v_mov_b32 v253, 0
v_mov_b32 v254, 0
v_mov_b32 v255, 0
s_mov_b32 s65, 131072
s_mov_b32 s64, 16
L_sl1_p2:
s_mov_b32 s66, s65
buffer_load_dwordx4 a[0:3], v234, s[12:15], s65 offen offset:0
buffer_load_dwordx4 a[4:7], v234, s[12:15], s65 offen offset:64
buffer_load_dwordx4 a[8:11], v234, s[12:15], s65 offen offset:128
buffer_load_dwordx4 a[12:15], v234, s[12:15], s65 offen offset:192
s_waitcnt vmcnt(0)
v_mfma_f32_16x16x32_bf16 v[176:179], a[0:3], a[64:67], 0
v_mfma_f32_16x16x32_bf16 v[176:179], a[4:7], a[68:71], v[176:179]
v_mfma_f32_16x16x32_bf16 v[176:179], a[8:11], a[72:75], v[176:179]
v_mfma_f32_16x16x32_bf16 v[176:179], a[12:15], a[76:79], v[176:179]
v_mfma_f32_16x16x32_bf16 v[180:183], a[0:3], a[80:83], 0
v_mfma_f32_16x16x32_bf16 v[180:183], a[4:7], a[84:87], v[180:183]
v_mfma_f32_16x16x32_bf16 v[180:183], a[8:11], a[88:91], v[180:183]
v_mfma_f32_16x16x32_bf16 v[180:183], a[12:15], a[92:95], v[180:183]
v_mfma_f32_16x16x32_bf16 v[184:187], a[0:3], a[96:99], 0
v_mfma_f32_16x16x32_bf16 v[184:187], a[4:7], a[100:103], v[184:187]
v_mfma_f32_16x16x32_bf16 v[184:187], a[8:11], a[104:107], v[184:187]
v_mfma_f32_16x16x32_bf16 v[184:187], a[12:15], a[108:111], v[184:187]
v_mfma_f32_16x16x32_bf16 v[188:191], a[0:3], a[112:115], 0
v_mfma_f32_16x16x32_bf16 v[188:191], a[4:7], a[116:119], v[188:191]
v_mfma_f32_16x16x32_bf16 v[188:191], a[8:11], a[120:123], v[188:191]
v_mfma_f32_16x16x32_bf16 v[188:191], a[12:15], a[124:127], v[188:191]
s_nop 15
s_add_u32 s65, s65, 4096
v_sub_f32 v176, v176, v226
v_sub_f32 v177, v177, v226
v_sub_f32 v178, v178, v226
v_sub_f32 v179, v179, v226
v_exp_f32 v176, v176
v_exp_f32 v177, v177
v_exp_f32 v178, v178
v_exp_f32 v179, v179
s_nop 0
v_add_f32 v252, v252, v176
v_add_f32 v252, v252, v177
v_add_f32 v252, v252, v178
v_add_f32 v252, v252, v179
v_cvt_pk_bf16_f32 v160, v176, v177
v_cvt_pk_bf16_f32 v161, v178, v179
v_sub_f32 v180, v180, v227
v_sub_f32 v181, v181, v227
v_sub_f32 v182, v182, v227
v_sub_f32 v183, v183, v227
v_exp_f32 v180, v180
v_exp_f32 v181, v181
v_exp_f32 v182, v182
v_exp_f32 v183, v183
s_nop 0
v_add_f32 v253, v253, v180
v_add_f32 v253, v253, v181
v_add_f32 v253, v253, v182
v_add_f32 v253, v253, v183
v_cvt_pk_bf16_f32 v164, v180, v181
v_cvt_pk_bf16_f32 v165, v182, v183
v_sub_f32 v184, v184, v228
v_sub_f32 v185, v185, v228
v_sub_f32 v186, v186, v228
v_sub_f32 v187, v187, v228
v_exp_f32 v184, v184
v_exp_f32 v185, v185
v_exp_f32 v186, v186
v_exp_f32 v187, v187
s_nop 0
v_add_f32 v254, v254, v184
v_add_f32 v254, v254, v185
v_add_f32 v254, v254, v186
v_add_f32 v254, v254, v187
v_cvt_pk_bf16_f32 v168, v184, v185
v_cvt_pk_bf16_f32 v169, v186, v187
v_sub_f32 v188, v188, v229
v_sub_f32 v189, v189, v229
v_sub_f32 v190, v190, v229
v_sub_f32 v191, v191, v229
v_exp_f32 v188, v188
v_exp_f32 v189, v189
v_exp_f32 v190, v190
v_exp_f32 v191, v191
s_nop 0
v_add_f32 v255, v255, v188
v_add_f32 v255, v255, v189
v_add_f32 v255, v255, v190
v_add_f32 v255, v255, v191
v_cvt_pk_bf16_f32 v172, v188, v189
v_cvt_pk_bf16_f32 v173, v190, v191
buffer_load_dwordx4 a[0:3], v234, s[12:15], s65 offen offset:0
buffer_load_dwordx4 a[4:7], v234, s[12:15], s65 offen offset:64
buffer_load_dwordx4 a[8:11], v234, s[12:15], s65 offen offset:128
buffer_load_dwordx4 a[12:15], v234, s[12:15], s65 offen offset:192
s_waitcnt vmcnt(0)
v_mfma_f32_16x16x32_bf16 v[176:179], a[0:3], a[64:67], 0
v_mfma_f32_16x16x32_bf16 v[176:179], a[4:7], a[68:71], v[176:179]
v_mfma_f32_16x16x32_bf16 v[176:179], a[8:11], a[72:75], v[176:179]
v_mfma_f32_16x16x32_bf16 v[176:179], a[12:15], a[76:79], v[176:179]
v_mfma_f32_16x16x32_bf16 v[180:183], a[0:3], a[80:83], 0
v_mfma_f32_16x16x32_bf16 v[180:183], a[4:7], a[84:87], v[180:183]
v_mfma_f32_16x16x32_bf16 v[180:183], a[8:11], a[88:91], v[180:183]
v_mfma_f32_16x16x32_bf16 v[180:183], a[12:15], a[92:95], v[180:183]
v_mfma_f32_16x16x32_bf16 v[184:187], a[0:3], a[96:99], 0
v_mfma_f32_16x16x32_bf16 v[184:187], a[4:7], a[100:103], v[184:187]
v_mfma_f32_16x16x32_bf16 v[184:187], a[8:11], a[104:107], v[184:187]
v_mfma_f32_16x16x32_bf16 v[184:187], a[12:15], a[108:111], v[184:187]
v_mfma_f32_16x16x32_bf16 v[188:191], a[0:3], a[112:115], 0
v_mfma_f32_16x16x32_bf16 v[188:191], a[4:7], a[116:119], v[188:191]
v_mfma_f32_16x16x32_bf16 v[188:191], a[8:11], a[120:123], v[188:191]
v_mfma_f32_16x16x32_bf16 v[188:191], a[12:15], a[124:127], v[188:191]
s_nop 15
s_add_u32 s65, s65, 4096
v_sub_f32 v176, v176, v226
v_sub_f32 v177, v177, v226
v_sub_f32 v178, v178, v226
v_sub_f32 v179, v179, v226
v_exp_f32 v176, v176
v_exp_f32 v177, v177
v_exp_f32 v178, v178
v_exp_f32 v179, v179
s_nop 0
v_add_f32 v252, v252, v176
v_add_f32 v252, v252, v177
v_add_f32 v252, v252, v178
v_add_f32 v252, v252, v179
v_cvt_pk_bf16_f32 v162, v176, v177
v_cvt_pk_bf16_f32 v163, v178, v179
v_sub_f32 v180, v180, v227
v_sub_f32 v181, v181, v227
v_sub_f32 v182, v182, v227
v_sub_f32 v183, v183, v227
v_exp_f32 v180, v180
v_exp_f32 v181, v181
v_exp_f32 v182, v182
v_exp_f32 v183, v183
s_nop 0
v_add_f32 v253, v253, v180
v_add_f32 v253, v253, v181
v_add_f32 v253, v253, v182
v_add_f32 v253, v253, v183
v_cvt_pk_bf16_f32 v166, v180, v181
v_cvt_pk_bf16_f32 v167, v182, v183
v_sub_f32 v184, v184, v228
v_sub_f32 v185, v185, v228
v_sub_f32 v186, v186, v228
v_sub_f32 v187, v187, v228
v_exp_f32 v184, v184
v_exp_f32 v185, v185
v_exp_f32 v186, v186
v_exp_f32 v187, v187
s_nop 0
v_add_f32 v254, v254, v184
v_add_f32 v254, v254, v185
v_add_f32 v254, v254, v186
v_add_f32 v254, v254, v187
v_cvt_pk_bf16_f32 v170, v184, v185
v_cvt_pk_bf16_f32 v171, v186, v187
v_sub_f32 v188, v188, v229
v_sub_f32 v189, v189, v229
v_sub_f32 v190, v190, v229
v_sub_f32 v191, v191, v229
v_exp_f32 v188, v188
v_exp_f32 v189, v189
v_exp_f32 v190, v190
v_exp_f32 v191, v191
s_nop 0
v_add_f32 v255, v255, v188
v_add_f32 v255, v255, v189
v_add_f32 v255, v255, v190
v_add_f32 v255, v255, v191
v_cvt_pk_bf16_f32 v174, v188, v189
v_cvt_pk_bf16_f32 v175, v190, v191
s_sub_u32 s64, s64, 1
s_cmp_eq_u32 s64, 0
s_cbranch_scc1 L_sl1_end
s_add_u32 s67, s66, 4096
buffer_load_ushort v242, v235, s[16:19], s66 offen offset:0
buffer_load_ushort v243, v235, s[16:19], s66 offen offset:256
buffer_load_ushort v244, v235, s[16:19], s66 offen offset:512
buffer_load_ushort v245, v235, s[16:19], s66 offen offset:768
buffer_load_ushort v246, v235, s[16:19], s67 offen offset:0
buffer_load_ushort v247, v235, s[16:19], s67 offen offset:256
buffer_load_ushort v248, v235, s[16:19], s67 offen offset:512
buffer_load_ushort v249, v235, s[16:19], s67 offen offset:768
s_waitcnt vmcnt(0)
v_lshl_or_b32 v238, v243, 16, v242
v_lshl_or_b32 v239, v245, 16, v244
v_lshl_or_b32 v240, v247, 16, v246
v_lshl_or_b32 v241, v249, 16, v248
s_nop 1
v_mfma_f32_16x16x32_bf16 v[0:3], v[238:241], v[160:163], v[0:3]
v_mfma_f32_16x16x32_bf16 v[4:7], v[238:241], v[164:167], v[4:7]
v_mfma_f32_16x16x32_bf16 v[8:11], v[238:241], v[168:171], v[8:11]
v_mfma_f32_16x16x32_bf16 v[12:15], v[238:241], v[172:175], v[12:15]
s_nop 7
buffer_load_ushort v242, v235, s[16:19], s66 offen offset:32
buffer_load_ushort v243, v235, s[16:19], s66 offen offset:288
buffer_load_ushort v244, v235, s[16:19], s66 offen offset:544
buffer_load_ushort v245, v235, s[16:19], s66 offen offset:800
buffer_load_ushort v246, v235, s[16:19], s67 offen offset:32
buffer_load_ushort v247, v235, s[16:19], s67 offen offset:288
buffer_load_ushort v248, v235, s[16:19], s67 offen offset:544
buffer_load_ushort v249, v235, s[16:19], s67 offen offset:800
s_waitcnt vmcnt(0)
v_lshl_or_b32 v238, v243, 16, v242
v_lshl_or_b32 v239, v245, 16, v244
v_lshl_or_b32 v240, v247, 16, v246
v_lshl_or_b32 v241, v249, 16, v248
s_nop 1
v_mfma_f32_16x16x32_bf16 v[16:19], v[238:241], v[160:163], v[16:19]
v_mfma_f32_16x16x32_bf16 v[20:23], v[238:241], v[164:167], v[20:23]
v_mfma_f32_16x16x32_bf16 v[24:27], v[238:241], v[168:171], v[24:27]
v_mfma_f32_16x16x32_bf16 v[28:31], v[238:241], v[172:175], v[28:31]
s_nop 7
buffer_load_ushort v242, v235, s[16:19], s66 offen offset:64
buffer_load_ushort v243, v235, s[16:19], s66 offen offset:320
buffer_load_ushort v244, v235, s[16:19], s66 offen offset:576
buffer_load_ushort v245, v235, s[16:19], s66 offen offset:832
buffer_load_ushort v246, v235, s[16:19], s67 offen offset:64
buffer_load_ushort v247, v235, s[16:19], s67 offen offset:320
buffer_load_ushort v248, v235, s[16:19], s67 offen offset:576
buffer_load_ushort v249, v235, s[16:19], s67 offen offset:832
s_waitcnt vmcnt(0)
v_lshl_or_b32 v238, v243, 16, v242
v_lshl_or_b32 v239, v245, 16, v244
v_lshl_or_b32 v240, v247, 16, v246
v_lshl_or_b32 v241, v249, 16, v248
s_nop 1
v_mfma_f32_16x16x32_bf16 v[32:35], v[238:241], v[160:163], v[32:35]
v_mfma_f32_16x16x32_bf16 v[36:39], v[238:241], v[164:167], v[36:39]
v_mfma_f32_16x16x32_bf16 v[40:43], v[238:241], v[168:171], v[40:43]
v_mfma_f32_16x16x32_bf16 v[44:47], v[238:241], v[172:175], v[44:47]
s_nop 7
buffer_load_ushort v242, v235, s[16:19], s66 offen offset:96
buffer_load_ushort v243, v235, s[16:19], s66 offen offset:352
buffer_load_ushort v244, v235, s[16:19], s66 offen offset:608
buffer_load_ushort v245, v235, s[16:19], s66 offen offset:864
buffer_load_ushort v246, v235, s[16:19], s67 offen offset:96
buffer_load_ushort v247, v235, s[16:19], s67 offen offset:352
buffer_load_ushort v248, v235, s[16:19], s67 offen offset:608
buffer_load_ushort v249, v235, s[16:19], s67 offen offset:864
s_waitcnt vmcnt(0)
v_lshl_or_b32 v238, v243, 16, v242
v_lshl_or_b32 v239, v245, 16, v244
v_lshl_or_b32 v240, v247, 16, v246
v_lshl_or_b32 v241, v249, 16, v248
s_nop 1
v_mfma_f32_16x16x32_bf16 v[48:51], v[238:241], v[160:163], v[48:51]
v_mfma_f32_16x16x32_bf16 v[52:55], v[238:241], v[164:167], v[52:55]
v_mfma_f32_16x16x32_bf16 v[56:59], v[238:241], v[168:171], v[56:59]
v_mfma_f32_16x16x32_bf16 v[60:63], v[238:241], v[172:175], v[60:63]
s_nop 7
buffer_load_ushort v242, v235, s[16:19], s66 offen offset:128
buffer_load_ushort v243, v235, s[16:19], s66 offen offset:384
buffer_load_ushort v244, v235, s[16:19], s66 offen offset:640
buffer_load_ushort v245, v235, s[16:19], s66 offen offset:896
buffer_load_ushort v246, v235, s[16:19], s67 offen offset:128
buffer_load_ushort v247, v235, s[16:19], s67 offen offset:384
buffer_load_ushort v248, v235, s[16:19], s67 offen offset:640
buffer_load_ushort v249, v235, s[16:19], s67 offen offset:896
s_waitcnt vmcnt(0)
v_lshl_or_b32 v238, v243, 16, v242
v_lshl_or_b32 v239, v245, 16, v244
v_lshl_or_b32 v240, v247, 16, v246
v_lshl_or_b32 v241, v249, 16, v248
s_nop 1
v_mfma_f32_16x16x32_bf16 v[64:67], v[238:241], v[160:163], v[64:67]
v_mfma_f32_16x16x32_bf16 v[68:71], v[238:241], v[164:167], v[68:71]
v_mfma_f32_16x16x32_bf16 v[72:75], v[238:241], v[168:171], v[72:75]
v_mfma_f32_16x16x32_bf16 v[76:79], v[238:241], v[172:175], v[76:79]
s_nop 7
buffer_load_ushort v242, v235, s[16:19], s66 offen offset:160
buffer_load_ushort v243, v235, s[16:19], s66 offen offset:416
buffer_load_ushort v244, v235, s[16:19], s66 offen offset:672
buffer_load_ushort v245, v235, s[16:19], s66 offen offset:928
buffer_load_ushort v246, v235, s[16:19], s67 offen offset:160
buffer_load_ushort v247, v235, s[16:19], s67 offen offset:416
buffer_load_ushort v248, v235, s[16:19], s67 offen offset:672
buffer_load_ushort v249, v235, s[16:19], s67 offen offset:928
s_waitcnt vmcnt(0)
v_lshl_or_b32 v238, v243, 16, v242
v_lshl_or_b32 v239, v245, 16, v244
v_lshl_or_b32 v240, v247, 16, v246
v_lshl_or_b32 v241, v249, 16, v248
s_nop 1
v_mfma_f32_16x16x32_bf16 v[80:83], v[238:241], v[160:163], v[80:83]
v_mfma_f32_16x16x32_bf16 v[84:87], v[238:241], v[164:167], v[84:87]
v_mfma_f32_16x16x32_bf16 v[88:91], v[238:241], v[168:171], v[88:91]
v_mfma_f32_16x16x32_bf16 v[92:95], v[238:241], v[172:175], v[92:95]
s_nop 7
buffer_load_ushort v242, v235, s[16:19], s66 offen offset:192
buffer_load_ushort v243, v235, s[16:19], s66 offen offset:448
buffer_load_ushort v244, v235, s[16:19], s66 offen offset:704
buffer_load_ushort v245, v235, s[16:19], s66 offen offset:960
buffer_load_ushort v246, v235, s[16:19], s67 offen offset:192
buffer_load_ushort v247, v235, s[16:19], s67 offen offset:448
buffer_load_ushort v248, v235, s[16:19], s67 offen offset:704
buffer_load_ushort v249, v235, s[16:19], s67 offen offset:960
s_waitcnt vmcnt(0)
v_lshl_or_b32 v238, v243, 16, v242
v_lshl_or_b32 v239, v245, 16, v244
v_lshl_or_b32 v240, v247, 16, v246
v_lshl_or_b32 v241, v249, 16, v248
s_nop 1
v_mfma_f32_16x16x32_bf16 v[96:99], v[238:241], v[160:163], v[96:99]
v_mfma_f32_16x16x32_bf16 v[100:103], v[238:241], v[164:167], v[100:103]
v_mfma_f32_16x16x32_bf16 v[104:107], v[238:241], v[168:171], v[104:107]
v_mfma_f32_16x16x32_bf16 v[108:111], v[238:241], v[172:175], v[108:111]
s_nop 7
buffer_load_ushort v242, v235, s[16:19], s66 offen offset:224
buffer_load_ushort v243, v235, s[16:19], s66 offen offset:480
buffer_load_ushort v244, v235, s[16:19], s66 offen offset:736
buffer_load_ushort v245, v235, s[16:19], s66 offen offset:992
buffer_load_ushort v246, v235, s[16:19], s67 offen offset:224
buffer_load_ushort v247, v235, s[16:19], s67 offen offset:480
buffer_load_ushort v248, v235, s[16:19], s67 offen offset:736
buffer_load_ushort v249, v235, s[16:19], s67 offen offset:992
s_waitcnt vmcnt(0)
v_lshl_or_b32 v238, v243, 16, v242
v_lshl_or_b32 v239, v245, 16, v244
v_lshl_or_b32 v240, v247, 16, v246
v_lshl_or_b32 v241, v249, 16, v248
s_nop 1
v_mfma_f32_16x16x32_bf16 v[112:115], v[238:241], v[160:163], v[112:115]
v_mfma_f32_16x16x32_bf16 v[116:119], v[238:241], v[164:167], v[116:119]
v_mfma_f32_16x16x32_bf16 v[120:123], v[238:241], v[168:171], v[120:123]
v_mfma_f32_16x16x32_bf16 v[124:127], v[238:241], v[172:175], v[124:127]
s_nop 7
s_branch L_sl1_p2
L_sl1_end:
s_nop 15
s_branch L_back1
L_k1_done:
s_endpgm
L_text_end:
.section .rodata,"a"
.p2align 6
.amdhsa_kernel standalone__gqa_block_cached__near_ridge_kernel
  .amdhsa_next_free_vgpr 512
  .amdhsa_next_free_sgpr 102
  .amdhsa_accum_offset 256
  .amdhsa_group_segment_fixed_size 0
  .amdhsa_kernarg_size 64
  .amdhsa_user_sgpr_count 2
  .amdhsa_user_sgpr_kernarg_segment_ptr 1
  .amdhsa_system_sgpr_workgroup_id_x 1
.end_amdhsa_kernel
```
